```python
import torch

def _softmax(x, axis=-1):
    return torch.softmax(x, dim=axis)
def _gelu(x):
    return torch.nn.functional.gelu(x, approximate="tanh")
def _silu(x):
    return torch.nn.functional.silu(x)
def _sigmoid(x):
    return torch.sigmoid(x)
def _layernorm(x, axis=-1, eps=1e-5):
    m = x.mean(dim=axis, keepdim=True)
    v = x.var(dim=axis, keepdim=True, unbiased=False)
    return (x - m) / torch.sqrt(v + eps)
def _scatter_add(tgt, idx, src, axis=0):
    return tgt.clone().index_add_(axis, idx, src)
def _segment_sum(src, seg, n):
    out = torch.zeros((n,) + src.shape[1:], dtype=src.dtype)
    return out.index_add_(0, seg, src)
def _pad(x, pw):
    flat = tuple(v for pair in reversed(pw) for v in pair)
    return torch.nn.functional.pad(x, flat)

kernel_name = 'gated_mix__ssm_conv_s4__dense_activation_squared_relu__prompt'

def setup_inputs():

    _w = (lambda a: (lambda t: t.to(torch.bfloat16) if t.is_floating_point() else t)(torch.as_tensor(a)))
    def _A_setup():
        B, L, D, N = 1, 2048, 640, 192
        A_re = -(lambda _x: torch.exp(torch.as_tensor(_x)))((lambda *s: torch.randn(*s, dtype=torch.bfloat16) * 6.4)(D, N))
        A_im = torch.pi * (lambda *s: torch.randn(*s, dtype=torch.bfloat16) * 0.1)(D, N)
        B_re = (lambda *s: torch.randn(*s, dtype=torch.bfloat16) * 0.2)(D, N)
        B_im = (lambda *s: torch.randn(*s, dtype=torch.bfloat16) * 0.2)(D, N)
        C_re = (lambda *s: torch.randn(*s, dtype=torch.bfloat16) * 0.2)(D, N)
        C_im = (lambda *s: torch.randn(*s, dtype=torch.bfloat16) * 0.2)(D, N)
        log_dt = (lambda *s: torch.randn(*s, dtype=torch.bfloat16) * 0.1)(D) * 0.5 - 4.0
        Dskip = (lambda *s: torch.randn(*s, dtype=torch.bfloat16) * 0.1)(D)
        return {
            "u": _w((lambda *s: torch.randn(*s, dtype=torch.bfloat16) * 0.05)(B, L, D)),
            "A_re": _w(A_re),
            "A_im": _w(A_im),
            "B_re": _w(B_re),
            "B_im": _w(B_im),
            "C_re": _w(C_re),
            "C_im": _w(C_im),
            "log_dt": _w(log_dt),
            "Dskip": _w(Dskip),
        }
    _A_in = _A_setup()

    def _B_setup():
        B, S, D, F = 1, 2048, 640, 1536
        return {
            "x": _w((lambda *s: torch.randn(*s, dtype=torch.bfloat16) * 0.05)(B, S, D)),
            "w1": _w((lambda *s: torch.randn(*s, dtype=torch.bfloat16) * 0.05)(D, F)),
            "b1": _w((lambda *s: torch.randn(*s, dtype=torch.bfloat16) * 0.05)(F)),
            "w2": _w((lambda *s: torch.randn(*s, dtype=torch.bfloat16) * 0.05)(F, D)),
            "b2": _w((lambda *s: torch.randn(*s, dtype=torch.bfloat16) * 0.05)(D)),
        }
    _B_in = _B_setup()

    return {
        "A_u": _A_in["u"],
        "A_A_re": _A_in["A_re"],
        "A_A_im": _A_in["A_im"],
        "A_B_re": _A_in["B_re"],
        "A_B_im": _A_in["B_im"],
        "A_C_re": _A_in["C_re"],
        "A_C_im": _A_in["C_im"],
        "A_log_dt": _A_in["log_dt"],
        "A_Dskip": _A_in["Dskip"],
        "B_x": _B_in["x"],
        "B_w1": _B_in["w1"],
        "B_b1": _B_in["b1"],
        "B_w2": _B_in["w2"],
        "B_b2": _B_in["b2"],
        "gate_w": _w((lambda *s: torch.randn(*s, dtype=torch.bfloat16) * 0.05)(640) * 16.0),
    }

def reference(A_u, A_A_re, A_A_im, A_B_re, A_B_im, A_C_re, A_C_im, A_log_dt, A_Dskip, B_x, B_w1, B_b1, B_w2, B_b2, gate_w):
    def _A_ref(u, A_re, A_im, B_re, B_im, C_re, C_im, log_dt, Dskip):
        Bsz, L, D = u.shape
        dt = torch.exp(log_dt)[:, None]
        A = A_re + 1j * A_im
        Bc = B_re + 1j * B_im
        Cc = C_re + 1j * C_im
        logdA = dt * A
        dB = dt * Bc
        l = (lambda x, dt: x.to(dt))(torch.arange(L), A_re.dtype)
        P = torch.exp(logdA[:, :, None] * l[None, None, :])
        K = torch.einsum("dn,dnl,dn->dl", Cc, P, dB).real
        L2 = 2 * L
        Kp = _pad(K, ((0, 0), (0, L)))
        up = (lambda x, *d: x.permute(*d))(u, 0, 2, 1)
        up = _pad(up, ((0, 0), (0, 0), (0, L)))
        Kf = (lambda x, axes=(-2,-1): torch.fft.rfft2(x.float(), dim=axes))(Kp[:, None, :], axes=(-2, -1))
        Uf = (lambda x, axes=(-2,-1): torch.fft.rfft2(x.float(), dim=axes))(up[:, :, None, :], axes=(-2, -1))
        Yf = Uf * Kf[None, :, :, :]
        y = (lambda x, s, axes=(-2,-1): torch.fft.irfft2(x, s=s, dim=axes).to(torch.bfloat16))(Yf, (1, L2), axes=(-2, -1))[:, :, 0, :L]
        y = (lambda x, *d: x.permute(*d))(y, 0, 2, 1) + u * Dskip[None, None, :]
        return y

    def _B_ref(x, w1, b1, w2, b2):
        h = torch.einsum("bsd,df->bsf", x, w1) + b1
        zero = torch.zeros_like(h)
        r = torch.where(h > zero, h, zero)
        h = r * r
        out = torch.einsum("bsf,fd->bsd", h, w2) + b2
        return out

    x = A_u
    g = _sigmoid((x * gate_w).sum(-1, keepdims=True))
    a = _A_ref(x, A_A_re, A_A_im, A_B_re, A_B_im, A_C_re, A_C_im, A_log_dt, A_Dskip)
    b = _B_ref(x, B_w1, B_b1, B_w2, B_b2)
    return g * a + (1 - g) * b
```

```asm
; @launch grid=(256,1,1) block=(256,1,1) lds=163840
.amdgcn_target "amdgcn-amd-amdhsa--gfx950"
.text
.p2align 12
.globl gated_mix__ssm_conv_s4__dense_activation_squared_relu__prompt_kernel
.p2align 8
.type gated_mix__ssm_conv_s4__dense_activation_squared_relu__prompt_kernel,@function
gated_mix__ssm_conv_s4__dense_activation_squared_relu__prompt_kernel:
    s_cmp_ge_u32 s2, 256
    s_cbranch_scc1 L_exit
    s_load_dwordx16 s[4:19], s[0:1], 0
    s_load_dwordx16 s[20:35], s[0:1], 64
    s_load_dwordx4 s[36:39], s[0:1], 128
    v_lshrrev_b32 v2, 6, v0
    v_and_b32 v1, 63, v0
    s_and_b32 s41, s2, 7
    v_readfirstlane_b32 s40, v2
    s_lshr_b32 s42, s2, 3
    s_mov_b32 s100, 0
    s_getpc_b64 s[66:67]
L_pc:
    s_lshl_b32 s68, s42, 2
    s_add_u32 s68, s68, s40
    s_mul_i32 s68, s68, 768
    v_min_u32_e64 v2, 5, v1
    v_lshl_add_u32 v2, v2, 7, s68
    v_min_u32 v2, L_end-L_pc-4, v2
    global_load_dword a255, v2, s[66:67]
    s_cmp_lt_u32 s42, 12
    s_cbranch_scc1 L_roleA
    s_add_u32 s64, s66, L_tab-L_pc+4096
    s_addc_u32 s65, s67, 0
    s_mul_i32 s66, s40, 15360
    v_lshl_add_u32 v8, v1, 4, s66
    s_mul_i32 s43, s41, 20
    s_add_u32 s43, s43, s42
    s_sub_u32 s43, s43, 12
    s_lshl_b32 s60, s43, 2
    s_add_u32 s60, s60, s40
    s_mul_i32 s66, s60, 384
    v_lshl_add_u32 v2, v1, 2, s66
    v_lshl_add_u32 v4, v1, 1, s66
    s_lshl_b32 s66, s60, 1
    v_mov_b32 v3, s66
    v_mov_b32_e64 v28, 0
    s_and_b32 s56, s41, 6
    s_lshl_b32 s56, s56, 1
    s_and_b32 s66, s42, 3
    s_add_u32 s56, s56, s66
    s_lshl_b32 s3, s56, 2
    s_add_u32 s3, s3, s40
    s_and_b32 s57, s41, 1
    s_mul_i32 s57, s57, 5
    s_lshr_b32 s66, s42, 2
    s_add_u32 s57, s57, s66
    s_sub_u32 s57, s57, 3
    s_lshl_b32 s59, s40, 12
    s_add_u32 s59, s59, 19712
    s_mul_i32 s58, s40, 14416
    s_mul_i32 s68, s3, 40960
    s_lshl_b32 s67, s57, 7
    s_add_u32 s69, s68, s67
    v_mov_b32 v33, 12644352
    v_mov_b32 v22, 0
    v_mov_b32 v23, 0
    v_mov_b32 v24, 0
    v_mov_b32 v25, 0
    v_mov_b32 v26, 0
    v_mov_b32 v27, 0
    v_mov_b32 v29, 0
    s_waitcnt lgkmcnt(0)
    global_load_short_d16_hi v28, v3, s[18:19]
    global_load_dword v34, v2, s[6:7]
    global_load_dword v35, v2, s[8:9]
    global_load_dword v36, v2, s[10:11]
    global_load_dword v37, v2, s[12:13]
    global_load_dword v38, v2, s[14:15]
    global_load_dword v39, v2, s[16:17]
    global_load_dword v137, v33, s[38:39] sc1
    global_load_short_d16_hi v22, v4, s[6:7] offset:256
    global_load_short_d16_hi v23, v4, s[8:9] offset:256
    global_load_short_d16_hi v24, v4, s[10:11] offset:256
    global_load_short_d16_hi v25, v4, s[12:13] offset:256
    global_load_short_d16_hi v26, v4, s[14:15] offset:256
    global_load_short_d16_hi v27, v4, s[16:17] offset:256
    global_load_short_d16_hi v29, v3, s[20:21]
    s_branch L_bodyB
L_roleA:
    s_and_b32 s60, s41, 6
    s_lshl_b32 s60, s60, 1
    s_and_b32 s69, s42, 3
    s_add_u32 s60, s60, s69
    s_mul_i32 s69, s69, 5
    s_add_u32 s69, s69, 1
    s_lshr_b32 s69, s69, 1
    s_and_b32 s61, s41, 1
    s_mul_i32 s61, s61, 3
    s_lshr_b32 s66, s42, 2
    s_add_u32 s61, s61, s66
    s_lshl_b32 s66, s61, 2
    s_lshr_b32 s66, 9840704, s66
    s_and_b32 s66, s66, 15
    s_add_u32 s69, s69, s66
    s_cmp_ge_u32 s69, 10
    s_cselect_b32 s66, 10, 0
    s_sub_u32 s69, s69, s66
    s_lshl_b32 s65, s60, 2
    s_add_u32 s65, s65, s40
    s_mul_i32 s62, s65, 40960
    s_mul_i32 s63, s40, 49152
    s_lshl_b32 s66, s61, 9
    s_add_u32 s63, s63, s66
    s_lshl_b32 s64, s40, 12
    v_lshrrev_b32 v2, 3, v1
    v_and_b32 v3, 7, v1
    v_lshrrev_b32 v24, 1, v2
    v_xor_b32 v25, v3, v24
    v_lshlrev_b32 v25, 4, v25
    v_mov_b32 v26, 1280
    v_mad_u32_u24 v4, v2, v26, v25
    v_xor_b32_e64 v5, 64, v4
    v_add_u32 v5, 9216, v5
    v_add_u32 v6, 18432, v4
    v_add_u32 v7, 18432, v5
    v_and_b32 v24, 1, v24
    v_lshlrev_b32 v24, 2, v24
    v_xor_b32 v25, v3, v24
    v_lshlrev_b32 v25, 4, v25
    v_mov_b32 v26, 3072
    v_mad_u32_u24 v25, v2, v26, v25
    v_add_u32 v8, 4096, v25
    v_add_u32 v10, 2048, v25
    v_xor_b32_e64 v25, 32, v25
    v_add_u32 v9, 27648, v25
    v_add_u32 v11, 25600, v25
    v_lshl_add_u32 v27, v1, 3, s66
    s_lshl_b32 s68, s69, 3
    s_mov_b32 s46, 2621440
    s_mov_b32 s47, 0x20000
    s_mov_b32 s50, 1970176
    s_mov_b32 s51, 0x20000
    s_waitcnt lgkmcnt(0)
    s_mov_b32 s44, s4
    s_mov_b32 s45, s5
    s_sub_u32 s48, s24, 4096
    s_subb_u32 s49, s25, 0
    global_load_dwordx2 v[28:29], v27, s[26:27]
    s_lshl_b32 s66, s69, 7
    s_add_u32 s4, s66, s62
    s_mul_i32 s66, s69, 196608
    s_add_u32 s14, s66, s63
    s_add_u32 s69, s69, 1
    s_cmp_eq_u32 s69, 10
    s_cselect_b32 s69, 0, s69
    s_add_u32 m0, s64, 0
    s_nop 0
    buffer_load_dwordx4 v4, s[44:47], s4 offen offset:0 lds
    buffer_load_dwordx4 v5, s[44:47], s4 offen offset:1024 lds
    buffer_load_dwordx4 v6, s[44:47], s4 offen offset:2048 lds
    buffer_load_dwordx4 v7, s[44:47], s4 offen offset:3072 lds
    s_add_u32 m0, s64, 81920
    s_nop 0
    buffer_load_dwordx4 v8, s[48:51], s14 offen offset:0 lds
    buffer_load_dwordx4 v9, s[48:51], s14 offen offset:1024 lds
    s_branch L_bodyA
L_bodyB:
    global_load_dwordx4 v[132:135], v8, s[64:65] offset:3072
    global_load_dwordx4 v[108:111], v8, s[64:65] offset:-4096
    global_load_dwordx4 v[112:115], v8, s[64:65] offset:-3072
    global_load_dwordx4 v[128:131], v8, s[64:65] offset:-2048
    s_mov_b32 s44, s4
    s_mov_b32 s45, s5
    s_mov_b32 s46, 0x00280000
    s_mov_b32 s47, 0x20000
    s_mov_b32 s52, s38
    s_mov_b32 s53, s39
    s_mov_b32 s54, 0x10000000
    s_mov_b32 s55, 0x20000
    s_mov_b32 s48, s28
    s_mov_b32 s49, s29
    s_mov_b32 s50, 0x001e0000
    s_mov_b32 s51, 0x20000
    v_lshrrev_b32 v5, 3, v1
    v_and_b32_e64 v6, 7, v1
    v_bfe_u32 v7, v1, 4, 1
    v_xor_b32 v7, v7, v6
    v_lshlrev_b32 v7, 4, v7
    v_mov_b32 v6, 1280
    v_mad_u32_u24 v124, v5, v6, v7
    v_xor_b32_e64 v125, 32, v124
    v_add_u32 v125, 9216, v125
    v_xor_b32_e64 v126, 64, v124
    v_add_u32 v126, 18432, v126
    v_xor_b32 v127, 96, v124
    v_add_u32 v127, 27648, v127
    s_cmp_ge_u32 s57, 5
    s_cselect_b32 s66, 1280, 0
    s_sub_u32 s66, s69, s66
    s_add_u32 s66, s66, 640
    v_and_b32_e64 v5, 31, v1
    v_mad_u32_u24 v62, v5, v6, s66
    s_lshl_b32 s66, s42, 2
    s_add_u32 s66, s66, s40
    s_sub_u32 s66, s66, 48
    s_mul_i32 s66, s66, 24576
    s_and_b32 s68, s41, 1
    s_mul_i32 s68, s68, 1536
    s_add_u32 s66, s66, s68
    s_add_u32 s28, s24, s66
    s_addc_u32 s29, s25, 0
    v_and_b32 v5, 7, v1
    v_mul_u32_u24_e64 v5, 24, v5
    v_bfe_u32 v7, v1, 3, 2
    v_min_u32_e64 v7, 2, v7
    v_lshl_add_u32 v5, v7, 2, v5
    v_lshrrev_b32_e64 v7, 6, v1
    v_add_lshl_u32 v63, v5, v7, 7
    s_mov_b32 m0, s58
    v_mov_b32 v5, 0x3f80
    s_mov_b32 s62, 0
    s_mov_b32 s63, -1
    ds_write_addtid_b32 v5 offset:38144
    v_mov_b32 v6, 0
    v_mov_b32 v7, 0
    v_lshlrev_b32 v5, 3, v0
    v_mov_b32_e64 v138, 0
    ds_write_b64 v5, v[6:7] offset:36096
    v_add_u32 v9, 0x2000, v8
    s_add_u32 s30, s30, s67
    s_addc_u32 s31, s31, 0
    s_sub_u32 s66, s42, 12
    s_lshr_b32 s68, s41, 1
    s_mul_i32 s68, s68, 20
    s_add_u32 s68, s68, s66
    s_mul_i32 s68, s68, 24576
    s_add_u32 s24, s24, s68
    s_addc_u32 s25, s25, 0
    s_and_b32 s68, s41, 1
    s_mul_i32 s68, s68, 1536
    s_add_u32 s24, s24, s68
    s_addc_u32 s25, s25, 0
    s_lshl_b32 s26, s40, 11
    s_mul_i32 s32, s3, 98304
    s_lshr_b32 s66, s66, 2
    s_and_b32 s68, s56, 3
    s_mul_i32 s68, s68, 3
    s_add_u32 s68, s68, 1
    s_lshr_b32 s68, s68, 1
    s_add_u32 s66, s66, s68
    s_lshr_b32 s68, s56, 2
    s_add_u32 s66, s66, s68
    s_mul_i32 s68, s66, 43
    s_lshr_b32 s68, s68, 8
    s_mul_i32 s68, s68, 6
    s_sub_u32 s66, s66, s68
    s_lshl_b32 s68, s66, 12
    s_add_u32 s4, s68, s32
    s_mul_i32 s68, s66, 327680
    s_add_u32 s10, s68, s67
    s_add_u32 s66, s66, 1
    s_cmp_eq_u32 s66, 6
    s_cselect_b32 s66, 0, s66
    s_lshl_b32 s68, s66, 12
    s_add_u32 s5, s68, s32
    s_mul_i32 s68, s66, 327680
    s_add_u32 s11, s68, s67
    s_add_u32 s66, s66, 1
    s_cmp_eq_u32 s66, 6
    s_cselect_b32 s66, 0, s66
    s_lshl_b32 s68, s66, 12
    s_add_u32 s6, s68, s32
    s_mul_i32 s68, s66, 327680
    s_add_u32 s12, s68, s67
    s_add_u32 s66, s66, 1
    s_cmp_eq_u32 s66, 6
    s_cselect_b32 s66, 0, s66
    s_lshl_b32 s68, s66, 12
    s_add_u32 s7, s68, s32
    s_mul_i32 s68, s66, 327680
    s_add_u32 s13, s68, s67
    s_add_u32 s66, s66, 1
    s_cmp_eq_u32 s66, 6
    s_cselect_b32 s66, 0, s66
    s_lshl_b32 s68, s66, 12
    s_add_u32 s8, s68, s32
    s_mul_i32 s68, s66, 327680
    s_add_u32 s14, s68, s67
    s_add_u32 s66, s66, 1
    s_cmp_eq_u32 s66, 6
    s_cselect_b32 s66, 0, s66
    s_lshl_b32 s68, s66, 12
    s_add_u32 s9, s68, s32
    s_mul_i32 s68, s66, 327680
    s_add_u32 s15, s68, s67
    s_mul_i32 s27, s56, 122880
    s_add_u32 s27, s27, s67
    s_mul_i32 s42, s56, 163840
    s_add_u32 s42, s42, s67
    s_lshl_b32 s66, s57, 18
    s_lshl_b32 s41, s56, 10
    s_add_u32 s41, s41, s66
    s_add_u32 s41, s41, 6291456
    s_lshl_b32 s67, s3, 8
    s_sub_u32 s66, s66, s67
    s_add_u32 s18, s66, 16793344
    s_add_u32 s19, s66, 16858880
    s_add_u32 s22, s66, 16924416
    s_add_u32 s23, s66, 16989952
    s_lshl_b32 s66, s57, 2
    s_lshr_b32 s67, s3, 4
    s_add_u32 s66, s66, s67
    s_lshl_b32 s66, s66, 6
    s_and_b32 s68, s3, 15
    s_add_u32 s66, s66, s68
    s_lshl_b32 s66, s66, 2
    s_add_u32 s0, s66, 12730368
    s_mul_i32 s66, s67, 10
    s_add_u32 s66, s66, s57
    s_lshl_b32 s66, s66, 8
    s_add_u32 s36, s66, 12713984
    s_lshl_b32 s66, s60, 12
    s_add_u32 s1, s66, 16777216
    s_add_u32 s17, s66, 6291456
    s_lshr_b32 s67, s43, 4
    s_lshl_b32 s66, s67, 2
    s_sub_u32 s66, s66, s40
    s_lshl_b32 s66, s66, 8
    s_add_u32 s37, s66, 12731136
    s_mul_i32 s66, s40, 10
    s_add_u32 s66, s66, s67
    s_lshl_b32 s66, s66, 6
    s_and_b32 s67, s43, 15
    s_add_u32 s66, s66, s67
    s_lshl_b32 s66, s66, 2
    s_add_u32 s101, s66, 12713984
    s_lshr_b32 s66, s3, 1
    s_lshl_b32 s66, s66, 11
    s_add_u32 s32, s66, 12648448
    s_lshl_b32 s61, s56, 12
    s_add_u32 s61, s61, 11534336
    s_mov_b64 exec, 0
    s_cmp_eq_u32 s40, 0
    s_cbranch_scc1 L_ptB0
    s_cmp_eq_u32 s40, 1
    s_cbranch_scc1 L_ptB1
    s_cmp_eq_u32 s40, 2
    s_cbranch_scc1 L_ptB2
    s_cmp_eq_u32 s40, 3
    s_cbranch_scc1 L_ptB3
L_ptdB:
    s_mov_b64 exec, -1
    s_mov_b32 m0, s59
    s_nop 0
    buffer_load_dwordx4 v124, s[44:47], s69 offen offset:0 lds
    buffer_load_dwordx4 v125, s[44:47], s69 offen offset:1024 lds
    buffer_load_dwordx4 v126, s[44:47], s69 offen offset:2048 lds
    buffer_load_dwordx4 v127, s[44:47], s69 offen offset:3072 lds
    s_mov_b32 m0, s58
    s_nop 0
    global_load_dword v139, v63, s[28:29]
    buffer_load_dword v139, v62, s[44:47], 0 offen
    s_mov_b32 s66, 0x3fb8aa3b
    s_mov_b32 s67, 0x32a57060
    s_mov_b32 s68, 0x3f317218
    s_waitcnt vmcnt(24)
    v_mul_f32 v5, s66, v28
    v_fma_f32 v6, v28, s66, -v5
    v_exp_f32_e64 v7, v5
    v_fma_f32 v6, v28, s67, v6
    v_mul_f32_e64 v6, s68, v6
    v_fma_f32 v7, v7, v6, v7
    v_cvt_pk_bf16_f32 v30, 0, v7
    v_mul_f32 v31, s66, v30
    v_mul_f32 v32, 0.15915494, v30
    s_waitcnt vmcnt(18)
    v_lshlrev_b32 v10, 16, v34
    v_lshlrev_b32 v11, 16, v35
    v_lshlrev_b32 v12, 16, v36
    v_lshlrev_b32 v13, 16, v37
    v_lshlrev_b32 v14, 16, v38
    v_lshlrev_b32 v15, 16, v39
    v_mul_f32 v10, v10, v31
    v_mul_f32 v11, v11, v32
    v_mul_f32 v12, v12, v30
    v_mul_f32 v13, v13, v30
    v_exp_f32 v2, v10
    v_fract_f32_e64 v3, v11
    v_mul_f32 v4, 0x41000000, v10
    v_mul_f32 v5, 0x41000000, v11
    v_cos_f32 v40, v3
    v_sin_f32 v41, v3
    v_exp_f32 v4, v4
    v_fract_f32 v5, v5
    v_mul_f32 v6, 0x43800000, v10
    v_mul_f32 v7, 0x43800000, v11
    v_cos_f32 v42, v5
    v_sin_f32 v43, v5
    v_exp_f32 v6, v6
    v_fract_f32 v7, v7
    v_mul_f32 v40, v2, v40
    v_mul_f32 v41, v2, v41
    v_cos_f32 v44, v7
    v_sin_f32 v45, v7
    v_mul_f32 v42, v4, v42
    v_mul_f32 v43, v4, v43
    v_mul_f32 v50, v14, v12
    v_mul_f32 v51, v14, v13
    v_mul_f32 v44, v6, v44
    v_mul_f32 v45, v6, v45
    v_fma_f32 v50, -v15, v13, v50
    v_fma_f32 v51, -v15, v12, -v51
    v_cvt_pk_bf16_f32 v192, v50, v51
    v_pk_mul_f32 v[48:49], v[50:51], v[40:41] op_sel_hi:[1,0]
    v_pk_fma_f32 v[46:47], v[50:51], v[40:41], v[48:49] op_sel:[1,1,0] op_sel_hi:[0,1,1] neg_hi:[1,0,0]
    v_cvt_pk_bf16_f32 v193, v46, v47
    v_pk_mul_f32 v[48:49], v[46:47], v[40:41] op_sel_hi:[1,0]
    v_pk_fma_f32 v[52:53], v[46:47], v[40:41], v[48:49] op_sel:[1,1,0] op_sel_hi:[0,1,1] neg_hi:[1,0,0]
    v_cvt_pk_bf16_f32 v194, v52, v53
    v_pk_mul_f32 v[48:49], v[52:53], v[40:41] op_sel_hi:[1,0]
    v_pk_fma_f32 v[46:47], v[52:53], v[40:41], v[48:49] op_sel:[1,1,0] op_sel_hi:[0,1,1] neg_hi:[1,0,0]
    v_cvt_pk_bf16_f32 v195, v46, v47
    v_pk_mul_f32 v[48:49], v[46:47], v[40:41] op_sel_hi:[1,0]
    v_pk_fma_f32 v[54:55], v[46:47], v[40:41], v[48:49] op_sel:[1,1,0] op_sel_hi:[0,1,1] neg_hi:[1,0,0]
    v_cvt_pk_bf16_f32 v196, v54, v55
    v_pk_mul_f32 v[48:49], v[54:55], v[40:41] op_sel_hi:[1,0]
    v_pk_fma_f32 v[46:47], v[54:55], v[40:41], v[48:49] op_sel:[1,1,0] op_sel_hi:[0,1,1] neg_hi:[1,0,0]
    v_cvt_pk_bf16_f32 v197, v46, v47
    v_pk_mul_f32 v[48:49], v[46:47], v[40:41] op_sel_hi:[1,0]
    v_pk_fma_f32 v[56:57], v[46:47], v[40:41], v[48:49] op_sel:[1,1,0] op_sel_hi:[0,1,1] neg_hi:[1,0,0]
    v_cvt_pk_bf16_f32 v198, v56, v57
    v_pk_mul_f32 v[48:49], v[56:57], v[40:41] op_sel_hi:[1,0]
    v_pk_fma_f32 v[46:47], v[56:57], v[40:41], v[48:49] op_sel:[1,1,0] op_sel_hi:[0,1,1] neg_hi:[1,0,0]
    v_cvt_pk_bf16_f32 v199, v46, v47
    v_pk_mul_f32 v[48:49], v[50:51], v[44:45] op_sel_hi:[1,0]
    v_pk_fma_f32 v[50:51], v[50:51], v[44:45], v[48:49] op_sel:[1,1,0] op_sel_hi:[0,1,1] neg_hi:[1,0,0]
    v_cvt_pk_bf16_f32 v200, v50, v51
    v_pk_mul_f32 v[48:49], v[52:53], v[44:45] op_sel_hi:[1,0]
    v_pk_fma_f32 v[52:53], v[52:53], v[44:45], v[48:49] op_sel:[1,1,0] op_sel_hi:[0,1,1] neg_hi:[1,0,0]
    v_cvt_pk_bf16_f32 v201, v52, v53
    v_pk_mul_f32 v[48:49], v[54:55], v[44:45] op_sel_hi:[1,0]
    v_pk_fma_f32 v[54:55], v[54:55], v[44:45], v[48:49] op_sel:[1,1,0] op_sel_hi:[0,1,1] neg_hi:[1,0,0]
    v_cvt_pk_bf16_f32 v202, v54, v55
    ds_write_addtid_b32 v192 offset:46848
    ds_write_addtid_b32 v193 offset:47120
    ds_write_addtid_b32 v194 offset:47392
    ds_write_addtid_b32 v195 offset:47664
    ds_write_addtid_b32 v196 offset:47936
    ds_write_addtid_b32 v197 offset:48208
    ds_write_addtid_b32 v198 offset:48480
    ds_write_addtid_b32 v199 offset:48752
    ds_write_addtid_b32 v200 offset:49024
    ds_write_addtid_b32 v201 offset:49296
    ds_write_addtid_b32 v202 offset:49568
    v_pk_mul_f32 v[48:49], v[56:57], v[44:45] op_sel_hi:[1,0]
    v_pk_fma_f32 v[56:57], v[56:57], v[44:45], v[48:49] op_sel:[1,1,0] op_sel_hi:[0,1,1] neg_hi:[1,0,0]
    v_cvt_pk_bf16_f32 v192, v56, v57
    v_pk_mul_f32 v[48:49], v[50:51], v[44:45] op_sel_hi:[1,0]
    v_pk_fma_f32 v[50:51], v[50:51], v[44:45], v[48:49] op_sel:[1,1,0] op_sel_hi:[0,1,1] neg_hi:[1,0,0]
    v_cvt_pk_bf16_f32 v193, v50, v51
    v_pk_mul_f32 v[48:49], v[54:55], v[44:45] op_sel_hi:[1,0]
    v_pk_fma_f32 v[54:55], v[54:55], v[44:45], v[48:49] op_sel:[1,1,0] op_sel_hi:[0,1,1] neg_hi:[1,0,0]
    v_cvt_pk_bf16_f32 v194, v54, v55
    v_pk_mul_f32 v[48:49], v[50:51], v[44:45] op_sel_hi:[1,0]
    v_pk_fma_f32 v[50:51], v[50:51], v[44:45], v[48:49] op_sel:[1,1,0] op_sel_hi:[0,1,1] neg_hi:[1,0,0]
    v_cvt_pk_bf16_f32 v195, v50, v51
    v_pk_mul_f32 v[48:49], v[54:55], v[44:45] op_sel_hi:[1,0]
    v_pk_fma_f32 v[54:55], v[54:55], v[44:45], v[48:49] op_sel:[1,1,0] op_sel_hi:[0,1,1] neg_hi:[1,0,0]
    v_cvt_pk_bf16_f32 v196, v54, v55
    v_pk_mul_f32 v[48:49], v[50:51], v[44:45] op_sel_hi:[1,0]
    v_pk_fma_f32 v[50:51], v[50:51], v[44:45], v[48:49] op_sel:[1,1,0] op_sel_hi:[0,1,1] neg_hi:[1,0,0]
    v_cvt_pk_bf16_f32 v197, v50, v51
    v_pk_mul_f32 v[48:49], v[50:51], v[44:45] op_sel_hi:[1,0]
    v_pk_fma_f32 v[50:51], v[50:51], v[44:45], v[48:49] op_sel:[1,1,0] op_sel_hi:[0,1,1] neg_hi:[1,0,0]
    v_cvt_pk_bf16_f32 v198, v50, v51
    v_pk_mul_f32 v[48:49], v[50:51], v[44:45] op_sel_hi:[1,0]
    v_pk_fma_f32 v[50:51], v[50:51], v[44:45], v[48:49] op_sel:[1,1,0] op_sel_hi:[0,1,1] neg_hi:[1,0,0]
    v_cvt_pk_bf16_f32 v199, v50, v51
    v_pk_mul_f32 v[48:49], v[50:51], v[44:45] op_sel_hi:[1,0]
    v_pk_fma_f32 v[50:51], v[50:51], v[44:45], v[48:49] op_sel:[1,1,0] op_sel_hi:[0,1,1] neg_hi:[1,0,0]
    v_cvt_pk_bf16_f32 v200, v50, v51
    v_pk_mul_f32 v[48:49], v[50:51], v[44:45] op_sel_hi:[1,0]
    v_pk_fma_f32 v[50:51], v[50:51], v[44:45], v[48:49] op_sel:[1,1,0] op_sel_hi:[0,1,1] neg_hi:[1,0,0]
    v_cvt_pk_bf16_f32 v201, v50, v51
    ds_write_addtid_b32 v192 offset:49840
    ds_write_addtid_b32 v193 offset:50112
    ds_write_addtid_b32 v194 offset:50384
    ds_write_addtid_b32 v195 offset:50656
    ds_write_addtid_b32 v196 offset:50928
    ds_write_addtid_b32 v197 offset:51200
    ds_write_addtid_b32 v198 offset:51472
    ds_write_addtid_b32 v199 offset:51744
    ds_write_addtid_b32 v200 offset:52016
    ds_write_addtid_b32 v201 offset:52288
    v_cvt_pk_bf16_f32 v192, v42, v43
    v_pk_mul_f32 v[48:49], v[42:43], v[42:43] op_sel_hi:[1,0]
    v_pk_fma_f32 v[46:47], v[42:43], v[42:43], v[48:49] op_sel:[1,1,0] op_sel_hi:[0,1,1] neg_lo:[1,0,0]
    v_cvt_pk_bf16_f32 v193, v46, v47
    v_pk_mul_f32 v[48:49], v[46:47], v[42:43] op_sel_hi:[1,0]
    v_pk_fma_f32 v[46:47], v[46:47], v[42:43], v[48:49] op_sel:[1,1,0] op_sel_hi:[0,1,1] neg_lo:[1,0,0]
    v_cvt_pk_bf16_f32 v194, v46, v47
    v_pk_mul_f32 v[48:49], v[46:47], v[42:43] op_sel_hi:[1,0]
    v_pk_fma_f32 v[46:47], v[46:47], v[42:43], v[48:49] op_sel:[1,1,0] op_sel_hi:[0,1,1] neg_lo:[1,0,0]
    v_cvt_pk_bf16_f32 v195, v46, v47
    v_pk_mul_f32 v[48:49], v[46:47], v[42:43] op_sel_hi:[1,0]
    v_pk_fma_f32 v[46:47], v[46:47], v[42:43], v[48:49] op_sel:[1,1,0] op_sel_hi:[0,1,1] neg_lo:[1,0,0]
    v_cvt_pk_bf16_f32 v196, v46, v47
    v_pk_mul_f32 v[48:49], v[46:47], v[42:43] op_sel_hi:[1,0]
    v_pk_fma_f32 v[46:47], v[46:47], v[42:43], v[48:49] op_sel:[1,1,0] op_sel_hi:[0,1,1] neg_lo:[1,0,0]
    v_cvt_pk_bf16_f32 v197, v46, v47
    v_pk_mul_f32 v[48:49], v[46:47], v[42:43] op_sel_hi:[1,0]
    v_pk_fma_f32 v[46:47], v[46:47], v[42:43], v[48:49] op_sel:[1,1,0] op_sel_hi:[0,1,1] neg_lo:[1,0,0]
    v_cvt_pk_bf16_f32 v198, v46, v47
    v_pk_mul_f32 v[48:49], v[46:47], v[42:43] op_sel_hi:[1,0]
    v_pk_fma_f32 v[46:47], v[46:47], v[42:43], v[48:49] op_sel:[1,1,0] op_sel_hi:[0,1,1] neg_lo:[1,0,0]
    v_cvt_pk_bf16_f32 v199, v46, v47
    v_pk_mul_f32 v[48:49], v[46:47], v[42:43] op_sel_hi:[1,0]
    v_pk_fma_f32 v[46:47], v[46:47], v[42:43], v[48:49] op_sel:[1,1,0] op_sel_hi:[0,1,1] neg_lo:[1,0,0]
    v_cvt_pk_bf16_f32 v200, v46, v47
    ds_write_addtid_b32 v192 offset:38416
    ds_write_addtid_b32 v193 offset:38688
    ds_write_addtid_b32 v194 offset:38960
    ds_write_addtid_b32 v195 offset:39232
    ds_write_addtid_b32 v196 offset:39504
    ds_write_addtid_b32 v197 offset:39776
    ds_write_addtid_b32 v198 offset:40048
    ds_write_addtid_b32 v199 offset:40320
    ds_write_addtid_b32 v200 offset:40592
    v_pk_mul_f32 v[48:49], v[46:47], v[42:43] op_sel_hi:[1,0]
    v_pk_fma_f32 v[46:47], v[46:47], v[42:43], v[48:49] op_sel:[1,1,0] op_sel_hi:[0,1,1] neg_lo:[1,0,0]
    v_cvt_pk_bf16_f32 v192, v46, v47
    v_pk_mul_f32 v[48:49], v[46:47], v[42:43] op_sel_hi:[1,0]
    v_pk_fma_f32 v[46:47], v[46:47], v[42:43], v[48:49] op_sel:[1,1,0] op_sel_hi:[0,1,1] neg_lo:[1,0,0]
    v_cvt_pk_bf16_f32 v193, v46, v47
    v_pk_mul_f32 v[48:49], v[46:47], v[42:43] op_sel_hi:[1,0]
    v_pk_fma_f32 v[46:47], v[46:47], v[42:43], v[48:49] op_sel:[1,1,0] op_sel_hi:[0,1,1] neg_lo:[1,0,0]
    v_cvt_pk_bf16_f32 v194, v46, v47
    v_pk_mul_f32 v[48:49], v[46:47], v[42:43] op_sel_hi:[1,0]
    v_pk_fma_f32 v[46:47], v[46:47], v[42:43], v[48:49] op_sel:[1,1,0] op_sel_hi:[0,1,1] neg_lo:[1,0,0]
    v_cvt_pk_bf16_f32 v195, v46, v47
    v_pk_mul_f32 v[48:49], v[46:47], v[42:43] op_sel_hi:[1,0]
    v_pk_fma_f32 v[46:47], v[46:47], v[42:43], v[48:49] op_sel:[1,1,0] op_sel_hi:[0,1,1] neg_lo:[1,0,0]
    v_cvt_pk_bf16_f32 v196, v46, v47
    v_pk_mul_f32 v[48:49], v[46:47], v[42:43] op_sel_hi:[1,0]
    v_pk_fma_f32 v[46:47], v[46:47], v[42:43], v[48:49] op_sel:[1,1,0] op_sel_hi:[0,1,1] neg_lo:[1,0,0]
    v_cvt_pk_bf16_f32 v197, v46, v47
    v_pk_mul_f32 v[48:49], v[46:47], v[42:43] op_sel_hi:[1,0]
    v_pk_fma_f32 v[46:47], v[46:47], v[42:43], v[48:49] op_sel:[1,1,0] op_sel_hi:[0,1,1] neg_lo:[1,0,0]
    v_cvt_pk_bf16_f32 v198, v46, v47
    v_pk_mul_f32 v[48:49], v[46:47], v[42:43] op_sel_hi:[1,0]
    v_pk_fma_f32 v[46:47], v[46:47], v[42:43], v[48:49] op_sel:[1,1,0] op_sel_hi:[0,1,1] neg_lo:[1,0,0]
    v_cvt_pk_bf16_f32 v199, v46, v47
    ds_write_addtid_b32 v192 offset:40864
    ds_write_addtid_b32 v193 offset:41136
    ds_write_addtid_b32 v194 offset:41408
    ds_write_addtid_b32 v195 offset:41680
    ds_write_addtid_b32 v196 offset:41952
L_ptB0:
    s_cbranch_execz L_ptB4
    ds_write_addtid_b32 v197 offset:42224
    ds_write_addtid_b32 v198 offset:42496
    ds_write_addtid_b32 v199 offset:42768
    s_waitcnt vmcnt(2)
    ds_read_b64_tr_b16 v[80:81], v108 offset:512
    ds_read_b64_tr_b16 v[82:83], v108
    ds_read_b64_tr_b16 v[84:85], v109 offset:512
    ds_read_b64_tr_b16 v[86:87], v109
    ds_read_b64_tr_b16 v[88:89], v110 offset:512
    ds_read_b64_tr_b16 v[90:91], v110
    ds_read_b64_tr_b16 v[92:93], v111 offset:512
    ds_read_b64_tr_b16 v[94:95], v111
    v_pk_mul_f32 v[48:49], v[46:47], v[42:43] op_sel_hi:[1,0]
    v_pk_fma_f32 v[46:47], v[46:47], v[42:43], v[48:49] op_sel:[1,1,0] op_sel_hi:[0,1,1] neg_lo:[1,0,0]
    v_cvt_pk_bf16_f32 v192, v46, v47
    v_pk_mul_f32 v[48:49], v[46:47], v[42:43] op_sel_hi:[1,0]
    v_pk_fma_f32 v[46:47], v[46:47], v[42:43], v[48:49] op_sel:[1,1,0] op_sel_hi:[0,1,1] neg_lo:[1,0,0]
    v_cvt_pk_bf16_f32 v193, v46, v47
    v_pk_mul_f32 v[48:49], v[46:47], v[42:43] op_sel_hi:[1,0]
    v_pk_fma_f32 v[46:47], v[46:47], v[42:43], v[48:49] op_sel:[1,1,0] op_sel_hi:[0,1,1] neg_lo:[1,0,0]
    v_cvt_pk_bf16_f32 v194, v46, v47
    v_pk_mul_f32 v[48:49], v[46:47], v[42:43] op_sel_hi:[1,0]
    v_pk_fma_f32 v[46:47], v[46:47], v[42:43], v[48:49] op_sel:[1,1,0] op_sel_hi:[0,1,1] neg_lo:[1,0,0]
    v_cvt_pk_bf16_f32 v195, v46, v47
    ds_write_addtid_b32 v192 offset:43040
    ds_write_addtid_b32 v193 offset:43312
    ds_write_addtid_b32 v194 offset:43584
    ds_write_addtid_b32 v195 offset:43856
    ds_read_b128 a[128:131], v112 offset:38144
    ds_read_b128 a[132:135], v112 offset:38176
    ds_read_b128 a[136:139], v112 offset:38208
    ds_read_b128 a[140:143], v112 offset:38240
    s_waitcnt lgkmcnt(14)
    buffer_store_dwordx4 v[80:83], v114, s[52:55], s18 offen sc1
    s_waitcnt lgkmcnt(12)
    buffer_store_dwordx4 v[84:87], v114, s[52:55], s19 offen sc1
    s_waitcnt lgkmcnt(10)
    buffer_store_dwordx4 v[88:91], v114, s[52:55], s22 offen sc1
    s_waitcnt lgkmcnt(8)
    buffer_store_dwordx4 v[92:95], v114, s[52:55], s23 offen sc1
    global_load_dword v139, v63, s[28:29] offset:128
    v_pk_mul_f32 v[48:49], v[46:47], v[42:43] op_sel_hi:[1,0]
    v_pk_fma_f32 v[46:47], v[46:47], v[42:43], v[48:49] op_sel:[1,1,0] op_sel_hi:[0,1,1] neg_lo:[1,0,0]
    v_cvt_pk_bf16_f32 v192, v46, v47
    v_pk_mul_f32 v[48:49], v[46:47], v[42:43] op_sel_hi:[1,0]
    v_pk_fma_f32 v[46:47], v[46:47], v[42:43], v[48:49] op_sel:[1,1,0] op_sel_hi:[0,1,1] neg_lo:[1,0,0]
    v_cvt_pk_bf16_f32 v193, v46, v47
    v_pk_mul_f32 v[48:49], v[46:47], v[42:43] op_sel_hi:[1,0]
    v_pk_fma_f32 v[46:47], v[46:47], v[42:43], v[48:49] op_sel:[1,1,0] op_sel_hi:[0,1,1] neg_lo:[1,0,0]
    v_cvt_pk_bf16_f32 v194, v46, v47
    v_pk_mul_f32 v[48:49], v[46:47], v[42:43] op_sel_hi:[1,0]
    v_pk_fma_f32 v[46:47], v[46:47], v[42:43], v[48:49] op_sel:[1,1,0] op_sel_hi:[0,1,1] neg_lo:[1,0,0]
    v_cvt_pk_bf16_f32 v195, v46, v47
    v_pk_mul_f32 v[48:49], v[46:47], v[42:43] op_sel_hi:[1,0]
    v_pk_fma_f32 v[46:47], v[46:47], v[42:43], v[48:49] op_sel:[1,1,0] op_sel_hi:[0,1,1] neg_lo:[1,0,0]
    v_cvt_pk_bf16_f32 v196, v46, v47
    v_pk_mul_f32 v[48:49], v[46:47], v[42:43] op_sel_hi:[1,0]
    v_pk_fma_f32 v[46:47], v[46:47], v[42:43], v[48:49] op_sel:[1,1,0] op_sel_hi:[0,1,1] neg_lo:[1,0,0]
    v_cvt_pk_bf16_f32 v197, v46, v47
    v_pk_mul_f32 v[48:49], v[46:47], v[42:43] op_sel_hi:[1,0]
    v_pk_fma_f32 v[46:47], v[46:47], v[42:43], v[48:49] op_sel:[1,1,0] op_sel_hi:[0,1,1] neg_lo:[1,0,0]
    v_cvt_pk_bf16_f32 v198, v46, v47
    v_pk_mul_f32 v[48:49], v[46:47], v[42:43] op_sel_hi:[1,0]
    v_pk_fma_f32 v[46:47], v[46:47], v[42:43], v[48:49] op_sel:[1,1,0] op_sel_hi:[0,1,1] neg_lo:[1,0,0]
    v_cvt_pk_bf16_f32 v199, v46, v47
    v_pk_mul_f32 v[48:49], v[46:47], v[42:43] op_sel_hi:[1,0]
    v_pk_fma_f32 v[46:47], v[46:47], v[42:43], v[48:49] op_sel:[1,1,0] op_sel_hi:[0,1,1] neg_lo:[1,0,0]
    v_cvt_pk_bf16_f32 v200, v46, v47
    v_pk_mul_f32 v[48:49], v[46:47], v[42:43] op_sel_hi:[1,0]
    v_pk_fma_f32 v[46:47], v[46:47], v[42:43], v[48:49] op_sel:[1,1,0] op_sel_hi:[0,1,1] neg_lo:[1,0,0]
    v_cvt_pk_bf16_f32 v201, v46, v47
    ds_write_addtid_b32 v192 offset:44128
    ds_write_addtid_b32 v193 offset:44400
    ds_write_addtid_b32 v194 offset:44672
    ds_write_addtid_b32 v195 offset:44944
    ds_write_addtid_b32 v196 offset:45216
    ds_write_addtid_b32 v197 offset:45488
    ds_write_addtid_b32 v198 offset:45760
    ds_write_addtid_b32 v199 offset:46032
    ds_write_addtid_b32 v200 offset:46304
    ds_write_addtid_b32 v201 offset:46576
    ds_read_b128 a[144:147], v112 offset:38272
    ds_read_b128 a[148:151], v112 offset:38304
    ds_read_b128 a[152:155], v112 offset:38336
    ds_read_b128 a[156:159], v112 offset:38368
    ds_read_b128 a[160:163], v113 offset:38144
    ds_read_b128 a[164:167], v113 offset:38176
    ds_read_b128 a[168:171], v113 offset:38208
    ds_read_b128 a[172:175], v113 offset:38240
    ds_read_b128 a[176:179], v113 offset:38272
    ds_read_b128 a[180:183], v113 offset:38304
    ds_read_b128 a[184:187], v113 offset:38336
    ds_read_b128 a[188:191], v113 offset:38368
    v_and_b32 v16, 0xffff0000, v34
    v_and_b32 v17, 0xffff0000, v35
    v_and_b32 v18, 0xffff0000, v36
    v_and_b32 v19, 0xffff0000, v37
    v_and_b32 v20, 0xffff0000, v38
    v_and_b32 v21, 0xffff0000, v39
    v_mul_f32 v16, v16, v31
    v_mul_f32 v17, v17, v32
    v_mul_f32 v18, v18, v30
    v_mul_f32 v19, v19, v30
    v_exp_f32 v2, v16
    v_fract_f32 v3, v17
    v_mul_f32 v4, 0x41000000, v16
    v_mul_f32 v5, 0x41000000, v17
    v_cos_f32 v40, v3
    v_sin_f32 v41, v3
    v_exp_f32 v4, v4
    v_fract_f32 v5, v5
    v_mul_f32 v6, 0x43800000, v16
    v_mul_f32 v7, 0x43800000, v17
    v_cos_f32 v42, v5
    v_sin_f32 v43, v5
    v_exp_f32 v6, v6
    v_fract_f32 v7, v7
    v_mul_f32 v40, v2, v40
    v_mul_f32 v41, v2, v41
    v_cos_f32 v44, v7
    v_sin_f32 v45, v7
    v_mul_f32 v42, v4, v42
    v_mul_f32 v43, v4, v43
    v_mul_f32 v50, v20, v18
    v_mul_f32 v51, v20, v19
    v_mul_f32 v44, v6, v44
    v_mul_f32 v45, v6, v45
    v_fma_f32 v50, -v21, v19, v50
    v_fma_f32 v51, -v21, v18, -v51
    v_cvt_pk_bf16_f32 v192, v50, v51
    s_waitcnt lgkmcnt(7)
    v_mfma_f32_32x32x16_bf16 v[64:79], a[128:131], a[160:163], 0
    v_mul_f32 v48, v50, v40
    v_mul_f32_e64 v49, v50, v41
    v_fma_f32 v46, v51, v41, v48
    v_fma_f32 v47, v51, v40, -v49
    v_cvt_pk_bf16_f32 v193, v46, v47
    s_waitcnt lgkmcnt(6)
    v_mfma_f32_32x32x16_bf16 v[64:79], a[132:135], a[164:167], v[64:79]
    v_mul_f32 v48, v46, v40
    v_mul_f32_e64 v49, v46, v41
    v_fma_f32 v52, v47, v41, v48
    v_fma_f32 v53, v47, v40, -v49
    v_cvt_pk_bf16_f32 v194, v52, v53
    s_waitcnt lgkmcnt(5)
    v_mfma_f32_32x32x16_bf16 v[64:79], a[136:139], a[168:171], v[64:79]
    v_mul_f32 v48, v52, v40
    v_mul_f32_e64 v49, v52, v41
    v_fma_f32 v46, v53, v41, v48
    v_fma_f32 v47, v53, v40, -v49
    v_cvt_pk_bf16_f32 v195, v46, v47
    s_waitcnt lgkmcnt(4)
    v_mfma_f32_32x32x16_bf16 v[64:79], a[140:143], a[172:175], v[64:79]
    v_mul_f32 v48, v46, v40
    v_mul_f32_e64 v49, v46, v41
    v_fma_f32 v54, v47, v41, v48
    v_fma_f32 v55, v47, v40, -v49
    v_cvt_pk_bf16_f32 v196, v54, v55
    s_waitcnt lgkmcnt(3)
    v_mfma_f32_32x32x16_bf16 v[64:79], a[144:147], a[176:179], v[64:79]
    v_mul_f32 v48, v54, v40
    v_mul_f32_e64 v49, v54, v41
    v_fma_f32 v46, v55, v41, v48
    v_fma_f32 v47, v55, v40, -v49
    v_cvt_pk_bf16_f32 v197, v46, v47
    s_waitcnt lgkmcnt(2)
    v_mfma_f32_32x32x16_bf16 v[64:79], a[148:151], a[180:183], v[64:79]
    v_mul_f32 v48, v46, v40
    v_mul_f32_e64 v49, v46, v41
    v_fma_f32 v56, v47, v41, v48
    v_fma_f32 v57, v47, v40, -v49
    v_cvt_pk_bf16_f32 v198, v56, v57
    s_waitcnt lgkmcnt(1)
    v_mfma_f32_32x32x16_bf16 v[64:79], a[152:155], a[184:187], v[64:79]
    v_mul_f32 v48, v56, v40
    v_mul_f32_e64 v49, v56, v41
    v_fma_f32 v46, v57, v41, v48
    v_fma_f32 v47, v57, v40, -v49
    v_cvt_pk_bf16_f32 v199, v46, v47
    s_waitcnt lgkmcnt(0)
    v_mfma_f32_32x32x16_bf16 v[64:79], a[156:159], a[188:191], v[64:79]
    v_mul_f32 v48, v50, v44
    v_mul_f32_e64 v49, v50, v45
    v_fma_f32 v50, v51, v45, v48
    v_fma_f32 v51, v51, v44, -v49
    v_cvt_pk_bf16_f32 v200, v50, v51
    ds_write_addtid_b32 v192 offset:46848
    ds_write_addtid_b32 v193 offset:47120
    ds_write_addtid_b32 v194 offset:47392
    ds_write_addtid_b32 v195 offset:47664
    ds_write_addtid_b32 v196 offset:47936
    ds_write_addtid_b32 v197 offset:48208
    ds_write_addtid_b32 v198 offset:48480
    ds_write_addtid_b32 v199 offset:48752
    ds_write_addtid_b32 v200 offset:49024
    v_pk_mul_f32 v[48:49], v[52:53], v[44:45] op_sel_hi:[1,0]
    v_pk_fma_f32 v[52:53], v[52:53], v[44:45], v[48:49] op_sel:[1,1,0] op_sel_hi:[0,1,1] neg_hi:[1,0,0]
    v_cvt_pk_bf16_f32 v192, v52, v53
    v_pk_mul_f32 v[48:49], v[54:55], v[44:45] op_sel_hi:[1,0]
    v_pk_fma_f32 v[54:55], v[54:55], v[44:45], v[48:49] op_sel:[1,1,0] op_sel_hi:[0,1,1] neg_hi:[1,0,0]
    v_cvt_pk_bf16_f32 v193, v54, v55
    v_pk_mul_f32 v[48:49], v[56:57], v[44:45] op_sel_hi:[1,0]
    v_pk_fma_f32 v[56:57], v[56:57], v[44:45], v[48:49] op_sel:[1,1,0] op_sel_hi:[0,1,1] neg_hi:[1,0,0]
    v_cvt_pk_bf16_f32 v194, v56, v57
    v_pk_mul_f32 v[48:49], v[50:51], v[44:45] op_sel_hi:[1,0]
    v_pk_fma_f32 v[50:51], v[50:51], v[44:45], v[48:49] op_sel:[1,1,0] op_sel_hi:[0,1,1] neg_hi:[1,0,0]
    v_cvt_pk_bf16_f32 v195, v50, v51
    v_pk_mul_f32 v[48:49], v[54:55], v[44:45] op_sel_hi:[1,0]
    v_pk_fma_f32 v[54:55], v[54:55], v[44:45], v[48:49] op_sel:[1,1,0] op_sel_hi:[0,1,1] neg_hi:[1,0,0]
    v_cvt_pk_bf16_f32 v196, v54, v55
    v_pk_mul_f32 v[48:49], v[50:51], v[44:45] op_sel_hi:[1,0]
    v_pk_fma_f32 v[50:51], v[50:51], v[44:45], v[48:49] op_sel:[1,1,0] op_sel_hi:[0,1,1] neg_hi:[1,0,0]
    v_cvt_pk_bf16_f32 v197, v50, v51
    v_pk_mul_f32 v[48:49], v[54:55], v[44:45] op_sel_hi:[1,0]
    v_pk_fma_f32 v[54:55], v[54:55], v[44:45], v[48:49] op_sel:[1,1,0] op_sel_hi:[0,1,1] neg_hi:[1,0,0]
    v_cvt_pk_bf16_f32 v198, v54, v55
    v_pk_mul_f32 v[48:49], v[50:51], v[44:45] op_sel_hi:[1,0]
    v_pk_fma_f32 v[50:51], v[50:51], v[44:45], v[48:49] op_sel:[1,1,0] op_sel_hi:[0,1,1] neg_hi:[1,0,0]
    v_cvt_pk_bf16_f32 v199, v50, v51
    v_pk_mul_f32 v[48:49], v[50:51], v[44:45] op_sel_hi:[1,0]
    v_pk_fma_f32 v[50:51], v[50:51], v[44:45], v[48:49] op_sel:[1,1,0] op_sel_hi:[0,1,1] neg_hi:[1,0,0]
    v_cvt_pk_bf16_f32 v200, v50, v51
    v_pk_mul_f32 v[48:49], v[50:51], v[44:45] op_sel_hi:[1,0]
    v_pk_fma_f32 v[50:51], v[50:51], v[44:45], v[48:49] op_sel:[1,1,0] op_sel_hi:[0,1,1] neg_hi:[1,0,0]
    v_cvt_pk_bf16_f32 v201, v50, v51
    v_pk_mul_f32 v[48:49], v[50:51], v[44:45] op_sel_hi:[1,0]
    v_pk_fma_f32 v[50:51], v[50:51], v[44:45], v[48:49] op_sel:[1,1,0] op_sel_hi:[0,1,1] neg_hi:[1,0,0]
    v_cvt_pk_bf16_f32 v202, v50, v51
    v_pk_mul_f32 v[48:49], v[50:51], v[44:45] op_sel_hi:[1,0]
    v_pk_fma_f32 v[50:51], v[50:51], v[44:45], v[48:49] op_sel:[1,1,0] op_sel_hi:[0,1,1] neg_hi:[1,0,0]
    v_cvt_pk_bf16_f32 v203, v50, v51
    ds_write_addtid_b32 v192 offset:49296
    ds_write_addtid_b32 v193 offset:49568
    ds_write_addtid_b32 v194 offset:49840
    ds_write_addtid_b32 v195 offset:50112
    ds_write_addtid_b32 v196 offset:50384
    ds_write_addtid_b32 v197 offset:50656
    ds_write_addtid_b32 v198 offset:50928
    ds_write_addtid_b32 v199 offset:51200
    ds_write_addtid_b32 v200 offset:51472
    ds_write_addtid_b32 v201 offset:51744
    ds_write_addtid_b32 v202 offset:52016
    ds_write_addtid_b32 v203 offset:52288
    ds_read_b128 a[128:131], v112 offset:38144
    ds_read_b128 a[132:135], v112 offset:38176
    ds_read_b128 a[136:139], v112 offset:38208
    ds_read_b128 a[140:143], v112 offset:38240
    s_waitcnt vmcnt(1)
    s_nop 0
    v_add_u32 v137, 0x9e3779b1, v137
    buffer_atomic_swap v137, v115, s[52:55], s0 offen offset:0 sc1
    buffer_load_dword v139, v131, s[48:51], s27 offen
    global_load_dwordx2 v[224:225], v133, s[30:31] offset:0
    v_cvt_pk_bf16_f32 v192, v42, v43
    v_pk_mul_f32 v[48:49], v[42:43], v[42:43] op_sel_hi:[1,0]
    v_pk_fma_f32 v[46:47], v[42:43], v[42:43], v[48:49] op_sel:[1,1,0] op_sel_hi:[0,1,1] neg_lo:[1,0,0]
    v_cvt_pk_bf16_f32 v193, v46, v47
    v_pk_mul_f32 v[48:49], v[46:47], v[42:43] op_sel_hi:[1,0]
    v_pk_fma_f32 v[46:47], v[46:47], v[42:43], v[48:49] op_sel:[1,1,0] op_sel_hi:[0,1,1] neg_lo:[1,0,0]
    v_cvt_pk_bf16_f32 v194, v46, v47
    v_pk_mul_f32 v[48:49], v[46:47], v[42:43] op_sel_hi:[1,0]
    v_pk_fma_f32 v[46:47], v[46:47], v[42:43], v[48:49] op_sel:[1,1,0] op_sel_hi:[0,1,1] neg_lo:[1,0,0]
    v_cvt_pk_bf16_f32 v195, v46, v47
    v_pk_mul_f32 v[48:49], v[46:47], v[42:43] op_sel_hi:[1,0]
    v_pk_fma_f32 v[46:47], v[46:47], v[42:43], v[48:49] op_sel:[1,1,0] op_sel_hi:[0,1,1] neg_lo:[1,0,0]
    v_cvt_pk_bf16_f32 v196, v46, v47
    v_pk_mul_f32 v[48:49], v[46:47], v[42:43] op_sel_hi:[1,0]
    v_pk_fma_f32 v[46:47], v[46:47], v[42:43], v[48:49] op_sel:[1,1,0] op_sel_hi:[0,1,1] neg_lo:[1,0,0]
    v_cvt_pk_bf16_f32 v197, v46, v47
    v_pk_mul_f32 v[48:49], v[46:47], v[42:43] op_sel_hi:[1,0]
    v_pk_fma_f32 v[46:47], v[46:47], v[42:43], v[48:49] op_sel:[1,1,0] op_sel_hi:[0,1,1] neg_lo:[1,0,0]
    v_cvt_pk_bf16_f32 v198, v46, v47
    v_pk_mul_f32 v[48:49], v[46:47], v[42:43] op_sel_hi:[1,0]
    v_pk_fma_f32 v[46:47], v[46:47], v[42:43], v[48:49] op_sel:[1,1,0] op_sel_hi:[0,1,1] neg_lo:[1,0,0]
    v_cvt_pk_bf16_f32 v199, v46, v47
    v_pk_mul_f32 v[48:49], v[46:47], v[42:43] op_sel_hi:[1,0]
    v_pk_fma_f32 v[46:47], v[46:47], v[42:43], v[48:49] op_sel:[1,1,0] op_sel_hi:[0,1,1] neg_lo:[1,0,0]
    v_cvt_pk_bf16_f32 v200, v46, v47
    v_pk_mul_f32 v[48:49], v[46:47], v[42:43] op_sel_hi:[1,0]
    v_pk_fma_f32 v[46:47], v[46:47], v[42:43], v[48:49] op_sel:[1,1,0] op_sel_hi:[0,1,1] neg_lo:[1,0,0]
    v_cvt_pk_bf16_f32 v201, v46, v47
    ds_write_addtid_b32 v192 offset:38416
    ds_write_addtid_b32 v193 offset:38688
    ds_write_addtid_b32 v194 offset:38960
    ds_write_addtid_b32 v195 offset:39232
    ds_write_addtid_b32 v196 offset:39504
    ds_write_addtid_b32 v197 offset:39776
    ds_write_addtid_b32 v198 offset:40048
    ds_write_addtid_b32 v199 offset:40320
    ds_write_addtid_b32 v200 offset:40592
    ds_write_addtid_b32 v201 offset:40864
    ds_read_b128 a[144:147], v112 offset:38272
    ds_read_b128 a[148:151], v112 offset:38304
    ds_read_b128 a[152:155], v112 offset:38336
    ds_read_b128 a[156:159], v112 offset:38368
    global_load_dwordx2 v[226:227], v133, s[30:31] offset:32
    global_load_dwordx2 v[228:229], v133, s[30:31] offset:64
    v_pk_mul_f32 v[48:49], v[46:47], v[42:43] op_sel_hi:[1,0]
    v_pk_fma_f32 v[46:47], v[46:47], v[42:43], v[48:49] op_sel:[1,1,0] op_sel_hi:[0,1,1] neg_lo:[1,0,0]
    v_cvt_pk_bf16_f32 v192, v46, v47
    v_pk_mul_f32 v[48:49], v[46:47], v[42:43] op_sel_hi:[1,0]
    v_pk_fma_f32 v[46:47], v[46:47], v[42:43], v[48:49] op_sel:[1,1,0] op_sel_hi:[0,1,1] neg_lo:[1,0,0]
    v_cvt_pk_bf16_f32 v193, v46, v47
    v_pk_mul_f32 v[48:49], v[46:47], v[42:43] op_sel_hi:[1,0]
    v_pk_fma_f32 v[46:47], v[46:47], v[42:43], v[48:49] op_sel:[1,1,0] op_sel_hi:[0,1,1] neg_lo:[1,0,0]
    v_cvt_pk_bf16_f32 v194, v46, v47
    v_pk_mul_f32 v[48:49], v[46:47], v[42:43] op_sel_hi:[1,0]
    v_pk_fma_f32 v[46:47], v[46:47], v[42:43], v[48:49] op_sel:[1,1,0] op_sel_hi:[0,1,1] neg_lo:[1,0,0]
    v_cvt_pk_bf16_f32 v195, v46, v47
    v_pk_mul_f32 v[48:49], v[46:47], v[42:43] op_sel_hi:[1,0]
    v_pk_fma_f32 v[46:47], v[46:47], v[42:43], v[48:49] op_sel:[1,1,0] op_sel_hi:[0,1,1] neg_lo:[1,0,0]
    v_cvt_pk_bf16_f32 v196, v46, v47
    v_pk_mul_f32 v[48:49], v[46:47], v[42:43] op_sel_hi:[1,0]
    v_pk_fma_f32 v[46:47], v[46:47], v[42:43], v[48:49] op_sel:[1,1,0] op_sel_hi:[0,1,1] neg_lo:[1,0,0]
    v_cvt_pk_bf16_f32 v197, v46, v47
    v_pk_mul_f32 v[48:49], v[46:47], v[42:43] op_sel_hi:[1,0]
    v_pk_fma_f32 v[46:47], v[46:47], v[42:43], v[48:49] op_sel:[1,1,0] op_sel_hi:[0,1,1] neg_lo:[1,0,0]
    v_cvt_pk_bf16_f32 v198, v46, v47
    v_pk_mul_f32 v[48:49], v[46:47], v[42:43] op_sel_hi:[1,0]
    v_pk_fma_f32 v[46:47], v[46:47], v[42:43], v[48:49] op_sel:[1,1,0] op_sel_hi:[0,1,1] neg_lo:[1,0,0]
    v_cvt_pk_bf16_f32 v199, v46, v47
    v_pk_mul_f32 v[48:49], v[46:47], v[42:43] op_sel_hi:[1,0]
    v_pk_fma_f32 v[46:47], v[46:47], v[42:43], v[48:49] op_sel:[1,1,0] op_sel_hi:[0,1,1] neg_lo:[1,0,0]
    v_cvt_pk_bf16_f32 v200, v46, v47
    v_pk_mul_f32 v[48:49], v[46:47], v[42:43] op_sel_hi:[1,0]
    v_pk_fma_f32 v[46:47], v[46:47], v[42:43], v[48:49] op_sel:[1,1,0] op_sel_hi:[0,1,1] neg_lo:[1,0,0]
    v_cvt_pk_bf16_f32 v201, v46, v47
    ds_write_addtid_b32 v192 offset:41136
    ds_write_addtid_b32 v193 offset:41408
    ds_write_addtid_b32 v194 offset:41680
    ds_write_addtid_b32 v195 offset:41952
    ds_write_addtid_b32 v196 offset:42224
    ds_write_addtid_b32 v197 offset:42496
    ds_write_addtid_b32 v198 offset:42768
    ds_write_addtid_b32 v199 offset:43040
    ds_write_addtid_b32 v200 offset:43312
    ds_write_addtid_b32 v201 offset:43584
    global_load_dwordx2 v[230:231], v133, s[30:31] offset:96
    global_load_dwordx4 v[104:107], v8, s[64:65] offset:-1024
    v_pk_mul_f32 v[48:49], v[46:47], v[42:43] op_sel_hi:[1,0]
    v_pk_fma_f32 v[46:47], v[46:47], v[42:43], v[48:49] op_sel:[1,1,0] op_sel_hi:[0,1,1] neg_lo:[1,0,0]
    v_cvt_pk_bf16_f32 v192, v46, v47
    v_pk_mul_f32 v[48:49], v[46:47], v[42:43] op_sel_hi:[1,0]
    v_pk_fma_f32 v[46:47], v[46:47], v[42:43], v[48:49] op_sel:[1,1,0] op_sel_hi:[0,1,1] neg_lo:[1,0,0]
    v_cvt_pk_bf16_f32 v193, v46, v47
    v_pk_mul_f32 v[48:49], v[46:47], v[42:43] op_sel_hi:[1,0]
    v_pk_fma_f32 v[46:47], v[46:47], v[42:43], v[48:49] op_sel:[1,1,0] op_sel_hi:[0,1,1] neg_lo:[1,0,0]
    v_cvt_pk_bf16_f32 v194, v46, v47
    v_pk_mul_f32 v[48:49], v[46:47], v[42:43] op_sel_hi:[1,0]
    v_pk_fma_f32 v[46:47], v[46:47], v[42:43], v[48:49] op_sel:[1,1,0] op_sel_hi:[0,1,1] neg_lo:[1,0,0]
    v_cvt_pk_bf16_f32 v195, v46, v47
    v_pk_mul_f32 v[48:49], v[46:47], v[42:43] op_sel_hi:[1,0]
    v_pk_fma_f32 v[46:47], v[46:47], v[42:43], v[48:49] op_sel:[1,1,0] op_sel_hi:[0,1,1] neg_lo:[1,0,0]
    v_cvt_pk_bf16_f32 v196, v46, v47
    v_pk_mul_f32 v[48:49], v[46:47], v[42:43] op_sel_hi:[1,0]
    v_pk_fma_f32 v[46:47], v[46:47], v[42:43], v[48:49] op_sel:[1,1,0] op_sel_hi:[0,1,1] neg_lo:[1,0,0]
    v_cvt_pk_bf16_f32 v197, v46, v47
    v_pk_mul_f32 v[48:49], v[46:47], v[42:43] op_sel_hi:[1,0]
    v_pk_fma_f32 v[46:47], v[46:47], v[42:43], v[48:49] op_sel:[1,1,0] op_sel_hi:[0,1,1] neg_lo:[1,0,0]
    v_cvt_pk_bf16_f32 v198, v46, v47
    v_pk_mul_f32 v[48:49], v[46:47], v[42:43] op_sel_hi:[1,0]
    v_pk_fma_f32 v[46:47], v[46:47], v[42:43], v[48:49] op_sel:[1,1,0] op_sel_hi:[0,1,1] neg_lo:[1,0,0]
    v_cvt_pk_bf16_f32 v199, v46, v47
    v_pk_mul_f32 v[48:49], v[46:47], v[42:43] op_sel_hi:[1,0]
    v_pk_fma_f32 v[46:47], v[46:47], v[42:43], v[48:49] op_sel:[1,1,0] op_sel_hi:[0,1,1] neg_lo:[1,0,0]
    v_cvt_pk_bf16_f32 v200, v46, v47
    v_pk_mul_f32 v[48:49], v[46:47], v[42:43] op_sel_hi:[1,0]
    v_pk_fma_f32 v[46:47], v[46:47], v[42:43], v[48:49] op_sel:[1,1,0] op_sel_hi:[0,1,1] neg_lo:[1,0,0]
    v_cvt_pk_bf16_f32 v201, v46, v47
    v_pk_mul_f32 v[48:49], v[46:47], v[42:43] op_sel_hi:[1,0]
    v_pk_fma_f32 v[46:47], v[46:47], v[42:43], v[48:49] op_sel:[1,1,0] op_sel_hi:[0,1,1] neg_lo:[1,0,0]
    v_cvt_pk_bf16_f32 v202, v46, v47
    ds_write_addtid_b32 v192 offset:43856
    ds_write_addtid_b32 v193 offset:44128
    ds_write_addtid_b32 v194 offset:44400
    ds_write_addtid_b32 v195 offset:44672
    ds_write_addtid_b32 v196 offset:44944
    ds_write_addtid_b32 v197 offset:45216
    ds_write_addtid_b32 v198 offset:45488
    ds_write_addtid_b32 v199 offset:45760
    ds_write_addtid_b32 v200 offset:46032
    ds_write_addtid_b32 v201 offset:46304
    ds_write_addtid_b32 v202 offset:46576
    global_load_dwordx4 v[140:143], v8, s[64:65] offset:0
    global_load_dwordx4 v[116:119], v8, s[64:65] offset:1024
    ds_read_b128 a[160:163], v113 offset:38144
    ds_read_b128 a[164:167], v113 offset:38176
    ds_read_b128 a[168:171], v113 offset:38208
    ds_read_b128 a[172:175], v113 offset:38240
    ds_read_b128 a[176:179], v113 offset:38272
    ds_read_b128 a[180:183], v113 offset:38304
    ds_read_b128 a[184:187], v113 offset:38336
    ds_read_b128 a[188:191], v113 offset:38368
    v_mul_f32 v22, v22, v31
    v_mul_f32 v23, v23, v32
    v_mul_f32 v24, v24, v30
    v_mul_f32 v25, v25, v30
    v_exp_f32 v2, v22
    v_fract_f32 v3, v23
    v_mul_f32 v4, 0x41000000, v22
    v_mul_f32 v5, 0x41000000, v23
    v_cos_f32 v40, v3
    v_sin_f32 v41, v3
    v_exp_f32 v4, v4
    v_fract_f32 v5, v5
    v_mul_f32 v6, 0x43800000, v22
    v_mul_f32 v7, 0x43800000, v23
    v_cos_f32 v42, v5
    v_sin_f32 v43, v5
    v_exp_f32 v6, v6
    v_fract_f32 v7, v7
    v_mul_f32 v40, v2, v40
    v_mul_f32 v41, v2, v41
    v_cos_f32 v44, v7
    v_sin_f32 v45, v7
    v_mul_f32 v42, v4, v42
    v_mul_f32 v43, v4, v43
    v_mul_f32 v50, v26, v24
    v_mul_f32 v51, v26, v25
    v_mul_f32 v44, v6, v44
    v_mul_f32 v45, v6, v45
    v_fma_f32 v50, -v27, v25, v50
    v_fma_f32 v51, -v27, v24, -v51
    global_load_dwordx4 v[120:123], v8, s[64:65] offset:2048
    global_load_dwordx4 v[96:99], v9, s[64:65] offset:-4096
    global_load_dwordx4 v[100:103], v9, s[64:65] offset:-3072
    v_cvt_pk_bf16_f32 v192, v50, v51
    s_waitcnt lgkmcnt(7)
    v_mfma_f32_32x32x16_bf16 v[64:79], a[128:131], a[160:163], v[64:79]
    v_mul_f32 v48, v50, v40
    v_mul_f32_e64 v49, v50, v41
    v_fma_f32 v46, v51, v41, v48
    v_fma_f32 v47, v51, v40, -v49
    v_cvt_pk_bf16_f32 v193, v46, v47
    s_waitcnt lgkmcnt(6)
    v_mfma_f32_32x32x16_bf16 v[64:79], a[132:135], a[164:167], v[64:79]
    v_mul_f32 v48, v46, v40
    v_mul_f32_e64 v49, v46, v41
    v_fma_f32 v52, v47, v41, v48
    v_fma_f32 v53, v47, v40, -v49
    v_cvt_pk_bf16_f32 v194, v52, v53
    s_waitcnt lgkmcnt(5)
    v_mfma_f32_32x32x16_bf16 v[64:79], a[136:139], a[168:171], v[64:79]
    v_mul_f32 v48, v52, v40
    v_mul_f32_e64 v49, v52, v41
    v_fma_f32 v46, v53, v41, v48
    v_fma_f32 v47, v53, v40, -v49
    v_cvt_pk_bf16_f32 v195, v46, v47
    s_waitcnt lgkmcnt(4)
    v_mfma_f32_32x32x16_bf16 v[64:79], a[140:143], a[172:175], v[64:79]
    v_mul_f32 v48, v46, v40
    v_mul_f32_e64 v49, v46, v41
    v_fma_f32 v54, v47, v41, v48
    v_fma_f32 v55, v47, v40, -v49
    v_cvt_pk_bf16_f32 v196, v54, v55
    s_waitcnt lgkmcnt(3)
    v_mfma_f32_32x32x16_bf16 v[64:79], a[144:147], a[176:179], v[64:79]
    v_mul_f32 v48, v54, v40
    v_mul_f32_e64 v49, v54, v41
    v_fma_f32 v46, v55, v41, v48
    v_fma_f32 v47, v55, v40, -v49
    v_cvt_pk_bf16_f32 v197, v46, v47
    s_waitcnt lgkmcnt(2)
    v_mfma_f32_32x32x16_bf16 v[64:79], a[148:151], a[180:183], v[64:79]
    v_mul_f32 v48, v46, v40
    v_mul_f32_e64 v49, v46, v41
    v_fma_f32 v56, v47, v41, v48
    v_fma_f32 v57, v47, v40, -v49
    v_cvt_pk_bf16_f32 v198, v56, v57
    s_waitcnt lgkmcnt(1)
    v_mfma_f32_32x32x16_bf16 v[64:79], a[152:155], a[184:187], v[64:79]
    v_mul_f32 v48, v56, v40
    v_mul_f32_e64 v49, v56, v41
    v_fma_f32 v46, v57, v41, v48
    v_fma_f32 v47, v57, v40, -v49
    v_cvt_pk_bf16_f32 v199, v46, v47
    s_waitcnt lgkmcnt(0)
    v_mfma_f32_32x32x16_bf16 v[64:79], a[156:159], a[188:191], v[64:79]
    v_mul_f32 v48, v50, v44
    v_mul_f32_e64 v49, v50, v45
    v_fma_f32 v50, v51, v45, v48
    v_fma_f32 v51, v51, v44, -v49
    v_cvt_pk_bf16_f32 v200, v50, v51
    ds_write_addtid_b32 v192 offset:46848
    ds_write_addtid_b32 v193 offset:47120
    ds_write_addtid_b32 v194 offset:47392
    ds_write_addtid_b32 v195 offset:47664
    ds_write_addtid_b32 v196 offset:47936
    ds_write_addtid_b32 v197 offset:48208
    ds_write_addtid_b32 v198 offset:48480
    ds_write_addtid_b32 v199 offset:48752
    ds_write_addtid_b32 v200 offset:49024
    v_mov_b32_e64 v136, 0
    buffer_atomic_or v136, v129, s[52:55], s37 offen offset:0 sc0 sc1
    global_load_dwordx4 v[144:147], v9, s[64:65] offset:-2048
    global_load_dwordx4 v[148:151], v9, s[64:65] offset:-1024
    v_pk_mul_f32 v[48:49], v[52:53], v[44:45] op_sel_hi:[1,0]
    v_pk_fma_f32 v[52:53], v[52:53], v[44:45], v[48:49] op_sel:[1,1,0] op_sel_hi:[0,1,1] neg_hi:[1,0,0]
    v_cvt_pk_bf16_f32 v192, v52, v53
    v_pk_mul_f32 v[48:49], v[54:55], v[44:45] op_sel_hi:[1,0]
    v_pk_fma_f32 v[54:55], v[54:55], v[44:45], v[48:49] op_sel:[1,1,0] op_sel_hi:[0,1,1] neg_hi:[1,0,0]
    v_cvt_pk_bf16_f32 v193, v54, v55
    v_pk_mul_f32 v[48:49], v[56:57], v[44:45] op_sel_hi:[1,0]
    v_pk_fma_f32 v[56:57], v[56:57], v[44:45], v[48:49] op_sel:[1,1,0] op_sel_hi:[0,1,1] neg_hi:[1,0,0]
    v_cvt_pk_bf16_f32 v194, v56, v57
    v_pk_mul_f32 v[48:49], v[50:51], v[44:45] op_sel_hi:[1,0]
    v_pk_fma_f32 v[50:51], v[50:51], v[44:45], v[48:49] op_sel:[1,1,0] op_sel_hi:[0,1,1] neg_hi:[1,0,0]
    v_cvt_pk_bf16_f32 v195, v50, v51
    v_pk_mul_f32 v[48:49], v[54:55], v[44:45] op_sel_hi:[1,0]
    v_pk_fma_f32 v[54:55], v[54:55], v[44:45], v[48:49] op_sel:[1,1,0] op_sel_hi:[0,1,1] neg_hi:[1,0,0]
    v_cvt_pk_bf16_f32 v196, v54, v55
    v_pk_mul_f32 v[48:49], v[50:51], v[44:45] op_sel_hi:[1,0]
    v_pk_fma_f32 v[50:51], v[50:51], v[44:45], v[48:49] op_sel:[1,1,0] op_sel_hi:[0,1,1] neg_hi:[1,0,0]
    v_cvt_pk_bf16_f32 v197, v50, v51
    v_pk_mul_f32 v[48:49], v[54:55], v[44:45] op_sel_hi:[1,0]
    v_pk_fma_f32 v[54:55], v[54:55], v[44:45], v[48:49] op_sel:[1,1,0] op_sel_hi:[0,1,1] neg_hi:[1,0,0]
    v_cvt_pk_bf16_f32 v198, v54, v55
    v_pk_mul_f32 v[48:49], v[50:51], v[44:45] op_sel_hi:[1,0]
    v_pk_fma_f32 v[50:51], v[50:51], v[44:45], v[48:49] op_sel:[1,1,0] op_sel_hi:[0,1,1] neg_hi:[1,0,0]
    v_cvt_pk_bf16_f32 v199, v50, v51
    v_pk_mul_f32 v[48:49], v[50:51], v[44:45] op_sel_hi:[1,0]
    v_pk_fma_f32 v[50:51], v[50:51], v[44:45], v[48:49] op_sel:[1,1,0] op_sel_hi:[0,1,1] neg_hi:[1,0,0]
    v_cvt_pk_bf16_f32 v200, v50, v51
    v_pk_mul_f32 v[48:49], v[50:51], v[44:45] op_sel_hi:[1,0]
    v_pk_fma_f32 v[50:51], v[50:51], v[44:45], v[48:49] op_sel:[1,1,0] op_sel_hi:[0,1,1] neg_hi:[1,0,0]
    v_cvt_pk_bf16_f32 v201, v50, v51
    v_pk_mul_f32 v[48:49], v[50:51], v[44:45] op_sel_hi:[1,0]
    v_pk_fma_f32 v[50:51], v[50:51], v[44:45], v[48:49] op_sel:[1,1,0] op_sel_hi:[0,1,1] neg_hi:[1,0,0]
    v_cvt_pk_bf16_f32 v202, v50, v51
    v_pk_mul_f32 v[48:49], v[50:51], v[44:45] op_sel_hi:[1,0]
    v_pk_fma_f32 v[50:51], v[50:51], v[44:45], v[48:49] op_sel:[1,1,0] op_sel_hi:[0,1,1] neg_hi:[1,0,0]
    v_cvt_pk_bf16_f32 v203, v50, v51
    ds_write_addtid_b32 v192 offset:49296
    ds_write_addtid_b32 v193 offset:49568
    ds_write_addtid_b32 v194 offset:49840
    ds_write_addtid_b32 v195 offset:50112
    ds_write_addtid_b32 v196 offset:50384
    ds_write_addtid_b32 v197 offset:50656
    ds_write_addtid_b32 v198 offset:50928
    ds_write_addtid_b32 v199 offset:51200
    ds_write_addtid_b32 v200 offset:51472
    ds_write_addtid_b32 v201 offset:51744
    ds_write_addtid_b32 v202 offset:52016
    ds_write_addtid_b32 v203 offset:52288
    ds_read_b128 a[128:131], v112 offset:38144
    ds_read_b128 a[132:135], v112 offset:38176
    ds_read_b128 a[136:139], v112 offset:38208
    ds_read_b128 a[140:143], v112 offset:38240
    global_load_dwordx4 v[152:155], v9, s[64:65] offset:0
    global_load_dwordx4 v[208:211], v9, s[64:65] offset:1024
    v_cvt_pk_bf16_f32 v192, v42, v43
    v_pk_mul_f32 v[48:49], v[42:43], v[42:43] op_sel_hi:[1,0]
    v_pk_fma_f32 v[46:47], v[42:43], v[42:43], v[48:49] op_sel:[1,1,0] op_sel_hi:[0,1,1] neg_lo:[1,0,0]
    v_cvt_pk_bf16_f32 v193, v46, v47
    v_pk_mul_f32 v[48:49], v[46:47], v[42:43] op_sel_hi:[1,0]
L_ptB1:
    s_cbranch_execz L_ptdB
    s_nop 0
    v_pk_fma_f32 v[46:47], v[46:47], v[42:43], v[48:49] op_sel:[1,1,0] op_sel_hi:[0,1,1] neg_lo:[1,0,0]
    v_cvt_pk_bf16_f32 v194, v46, v47
    v_pk_mul_f32 v[48:49], v[46:47], v[42:43] op_sel_hi:[1,0]
    v_pk_fma_f32 v[46:47], v[46:47], v[42:43], v[48:49] op_sel:[1,1,0] op_sel_hi:[0,1,1] neg_lo:[1,0,0]
    v_cvt_pk_bf16_f32 v195, v46, v47
    v_pk_mul_f32 v[48:49], v[46:47], v[42:43] op_sel_hi:[1,0]
    v_pk_fma_f32 v[46:47], v[46:47], v[42:43], v[48:49] op_sel:[1,1,0] op_sel_hi:[0,1,1] neg_lo:[1,0,0]
    v_cvt_pk_bf16_f32 v196, v46, v47
    v_pk_mul_f32 v[48:49], v[46:47], v[42:43] op_sel_hi:[1,0]
    v_pk_fma_f32 v[46:47], v[46:47], v[42:43], v[48:49] op_sel:[1,1,0] op_sel_hi:[0,1,1] neg_lo:[1,0,0]
    v_cvt_pk_bf16_f32 v197, v46, v47
    v_pk_mul_f32 v[48:49], v[46:47], v[42:43] op_sel_hi:[1,0]
    v_pk_fma_f32 v[46:47], v[46:47], v[42:43], v[48:49] op_sel:[1,1,0] op_sel_hi:[0,1,1] neg_lo:[1,0,0]
    v_cvt_pk_bf16_f32 v198, v46, v47
    v_pk_mul_f32 v[48:49], v[46:47], v[42:43] op_sel_hi:[1,0]
    v_pk_fma_f32 v[46:47], v[46:47], v[42:43], v[48:49] op_sel:[1,1,0] op_sel_hi:[0,1,1] neg_lo:[1,0,0]
    v_cvt_pk_bf16_f32 v199, v46, v47
    v_pk_mul_f32 v[48:49], v[46:47], v[42:43] op_sel_hi:[1,0]
    v_pk_fma_f32 v[46:47], v[46:47], v[42:43], v[48:49] op_sel:[1,1,0] op_sel_hi:[0,1,1] neg_lo:[1,0,0]
    v_cvt_pk_bf16_f32 v200, v46, v47
    v_pk_mul_f32 v[48:49], v[46:47], v[42:43] op_sel_hi:[1,0]
    v_pk_fma_f32 v[46:47], v[46:47], v[42:43], v[48:49] op_sel:[1,1,0] op_sel_hi:[0,1,1] neg_lo:[1,0,0]
    v_cvt_pk_bf16_f32 v201, v46, v47
    ds_write_addtid_b32 v192 offset:38416
    ds_write_addtid_b32 v193 offset:38688
    ds_write_addtid_b32 v194 offset:38960
    ds_write_addtid_b32 v195 offset:39232
    ds_write_addtid_b32 v196 offset:39504
    ds_write_addtid_b32 v197 offset:39776
    ds_write_addtid_b32 v198 offset:40048
    ds_write_addtid_b32 v199 offset:40320
    ds_write_addtid_b32 v200 offset:40592
    ds_write_addtid_b32 v201 offset:40864
    ds_read_b128 a[144:147], v112 offset:38272
    ds_read_b128 a[148:151], v112 offset:38304
    ds_read_b128 a[152:155], v112 offset:38336
    ds_read_b128 a[156:159], v112 offset:38368
    global_load_dwordx4 v[212:215], v9, s[64:65] offset:2048
    v_pk_mul_f32 v[48:49], v[46:47], v[42:43] op_sel_hi:[1,0]
    v_pk_fma_f32 v[46:47], v[46:47], v[42:43], v[48:49] op_sel:[1,1,0] op_sel_hi:[0,1,1] neg_lo:[1,0,0]
    v_cvt_pk_bf16_f32 v192, v46, v47
    v_pk_mul_f32 v[48:49], v[46:47], v[42:43] op_sel_hi:[1,0]
    v_pk_fma_f32 v[46:47], v[46:47], v[42:43], v[48:49] op_sel:[1,1,0] op_sel_hi:[0,1,1] neg_lo:[1,0,0]
    v_cvt_pk_bf16_f32 v193, v46, v47
    v_pk_mul_f32 v[48:49], v[46:47], v[42:43] op_sel_hi:[1,0]
    v_pk_fma_f32 v[46:47], v[46:47], v[42:43], v[48:49] op_sel:[1,1,0] op_sel_hi:[0,1,1] neg_lo:[1,0,0]
    v_cvt_pk_bf16_f32 v194, v46, v47
    v_pk_mul_f32 v[48:49], v[46:47], v[42:43] op_sel_hi:[1,0]
    v_pk_fma_f32 v[46:47], v[46:47], v[42:43], v[48:49] op_sel:[1,1,0] op_sel_hi:[0,1,1] neg_lo:[1,0,0]
    v_cvt_pk_bf16_f32 v195, v46, v47
    v_pk_mul_f32 v[48:49], v[46:47], v[42:43] op_sel_hi:[1,0]
    v_pk_fma_f32 v[46:47], v[46:47], v[42:43], v[48:49] op_sel:[1,1,0] op_sel_hi:[0,1,1] neg_lo:[1,0,0]
    v_cvt_pk_bf16_f32 v196, v46, v47
    v_pk_mul_f32 v[48:49], v[46:47], v[42:43] op_sel_hi:[1,0]
    v_pk_fma_f32 v[46:47], v[46:47], v[42:43], v[48:49] op_sel:[1,1,0] op_sel_hi:[0,1,1] neg_lo:[1,0,0]
    v_cvt_pk_bf16_f32 v197, v46, v47
    v_pk_mul_f32 v[48:49], v[46:47], v[42:43] op_sel_hi:[1,0]
    v_pk_fma_f32 v[46:47], v[46:47], v[42:43], v[48:49] op_sel:[1,1,0] op_sel_hi:[0,1,1] neg_lo:[1,0,0]
    v_cvt_pk_bf16_f32 v198, v46, v47
    v_pk_mul_f32 v[48:49], v[46:47], v[42:43] op_sel_hi:[1,0]
    v_pk_fma_f32 v[46:47], v[46:47], v[42:43], v[48:49] op_sel:[1,1,0] op_sel_hi:[0,1,1] neg_lo:[1,0,0]
    v_cvt_pk_bf16_f32 v199, v46, v47
    v_pk_mul_f32 v[48:49], v[46:47], v[42:43] op_sel_hi:[1,0]
    v_pk_fma_f32 v[46:47], v[46:47], v[42:43], v[48:49] op_sel:[1,1,0] op_sel_hi:[0,1,1] neg_lo:[1,0,0]
    v_cvt_pk_bf16_f32 v200, v46, v47
    v_pk_mul_f32 v[48:49], v[46:47], v[42:43] op_sel_hi:[1,0]
    v_pk_fma_f32 v[46:47], v[46:47], v[42:43], v[48:49] op_sel:[1,1,0] op_sel_hi:[0,1,1] neg_lo:[1,0,0]
    v_cvt_pk_bf16_f32 v201, v46, v47
    ds_write_addtid_b32 v192 offset:41136
    ds_write_addtid_b32 v193 offset:41408
    ds_write_addtid_b32 v194 offset:41680
    ds_write_addtid_b32 v195 offset:41952
    ds_write_addtid_b32 v196 offset:42224
    ds_write_addtid_b32 v197 offset:42496
    ds_write_addtid_b32 v198 offset:42768
    ds_write_addtid_b32 v199 offset:43040
    ds_write_addtid_b32 v200 offset:43312
    ds_write_addtid_b32 v201 offset:43584
    s_waitcnt vmcnt(5)
    v_cmp_ne_u32 vcc, v137, v136
    s_mov_b32 m0, s59
    s_and_b32 s29, vcc_lo, 0xffff
    s_cselect_b32 s28, 0x7ffff000, 0
    v_or_b32 v126, s28, v128
    buffer_load_dwordx4 v126, s[52:55], s1 offen offset:0 sc1 lds
    buffer_load_dwordx4 v126, s[52:55], s1 offen offset:1024 sc1 lds
    buffer_load_dwordx4 v126, s[52:55], s1 offen offset:2048 sc1 lds
    buffer_load_dwordx4 v126, s[52:55], s1 offen offset:3072 sc1 lds
    s_mov_b32 m0, s58
    v_mov_b32 v61, 0
    buffer_atomic_or v61, v129, s[52:55], s37 offen offset:0 sc0 sc1
    global_load_dword v139, v130, s[24:25]
    v_pk_mul_f32 v[48:49], v[46:47], v[42:43] op_sel_hi:[1,0]
    v_pk_fma_f32 v[46:47], v[46:47], v[42:43], v[48:49] op_sel:[1,1,0] op_sel_hi:[0,1,1] neg_lo:[1,0,0]
    v_cvt_pk_bf16_f32 v192, v46, v47
    v_pk_mul_f32 v[48:49], v[46:47], v[42:43] op_sel_hi:[1,0]
    v_pk_fma_f32 v[46:47], v[46:47], v[42:43], v[48:49] op_sel:[1,1,0] op_sel_hi:[0,1,1] neg_lo:[1,0,0]
    v_cvt_pk_bf16_f32 v193, v46, v47
    v_pk_mul_f32 v[48:49], v[46:47], v[42:43] op_sel_hi:[1,0]
    v_pk_fma_f32 v[46:47], v[46:47], v[42:43], v[48:49] op_sel:[1,1,0] op_sel_hi:[0,1,1] neg_lo:[1,0,0]
    v_cvt_pk_bf16_f32 v194, v46, v47
    v_pk_mul_f32 v[48:49], v[46:47], v[42:43] op_sel_hi:[1,0]
    v_pk_fma_f32 v[46:47], v[46:47], v[42:43], v[48:49] op_sel:[1,1,0] op_sel_hi:[0,1,1] neg_lo:[1,0,0]
    v_cvt_pk_bf16_f32 v195, v46, v47
    v_pk_mul_f32 v[48:49], v[46:47], v[42:43] op_sel_hi:[1,0]
    v_pk_fma_f32 v[46:47], v[46:47], v[42:43], v[48:49] op_sel:[1,1,0] op_sel_hi:[0,1,1] neg_lo:[1,0,0]
    v_cvt_pk_bf16_f32 v196, v46, v47
    v_pk_mul_f32 v[48:49], v[46:47], v[42:43] op_sel_hi:[1,0]
    v_pk_fma_f32 v[46:47], v[46:47], v[42:43], v[48:49] op_sel:[1,1,0] op_sel_hi:[0,1,1] neg_lo:[1,0,0]
    v_cvt_pk_bf16_f32 v197, v46, v47
    v_pk_mul_f32 v[48:49], v[46:47], v[42:43] op_sel_hi:[1,0]
    v_pk_fma_f32 v[46:47], v[46:47], v[42:43], v[48:49] op_sel:[1,1,0] op_sel_hi:[0,1,1] neg_lo:[1,0,0]
    v_cvt_pk_bf16_f32 v198, v46, v47
    v_pk_mul_f32 v[48:49], v[46:47], v[42:43] op_sel_hi:[1,0]
    v_pk_fma_f32 v[46:47], v[46:47], v[42:43], v[48:49] op_sel:[1,1,0] op_sel_hi:[0,1,1] neg_lo:[1,0,0]
    v_cvt_pk_bf16_f32 v199, v46, v47
    v_pk_mul_f32 v[48:49], v[46:47], v[42:43] op_sel_hi:[1,0]
    v_pk_fma_f32 v[46:47], v[46:47], v[42:43], v[48:49] op_sel:[1,1,0] op_sel_hi:[0,1,1] neg_lo:[1,0,0]
    v_cvt_pk_bf16_f32 v200, v46, v47
    v_pk_mul_f32 v[48:49], v[46:47], v[42:43] op_sel_hi:[1,0]
    v_pk_fma_f32 v[46:47], v[46:47], v[42:43], v[48:49] op_sel:[1,1,0] op_sel_hi:[0,1,1] neg_lo:[1,0,0]
    v_cvt_pk_bf16_f32 v201, v46, v47
    v_pk_mul_f32 v[48:49], v[46:47], v[42:43] op_sel_hi:[1,0]
    v_pk_fma_f32 v[46:47], v[46:47], v[42:43], v[48:49] op_sel:[1,1,0] op_sel_hi:[0,1,1] neg_lo:[1,0,0]
    v_cvt_pk_bf16_f32 v202, v46, v47
    ds_write_addtid_b32 v192 offset:43856
    ds_write_addtid_b32 v193 offset:44128
    ds_write_addtid_b32 v194 offset:44400
    ds_write_addtid_b32 v195 offset:44672
    ds_write_addtid_b32 v196 offset:44944
    ds_write_addtid_b32 v197 offset:45216
    ds_write_addtid_b32 v198 offset:45488
    ds_write_addtid_b32 v199 offset:45760
    ds_write_addtid_b32 v200 offset:46032
    ds_write_addtid_b32 v201 offset:46304
    ds_write_addtid_b32 v202 offset:46576
    ds_read_b128 a[160:163], v113 offset:38144
    ds_read_b128 a[164:167], v113 offset:38176
    ds_read_b128 a[168:171], v113 offset:38208
    ds_read_b128 a[172:175], v113 offset:38240
    ds_read_b128 a[176:179], v113 offset:38272
    ds_read_b128 a[180:183], v113 offset:38304
    ds_read_b128 a[184:187], v113 offset:38336
    ds_read_b128 a[188:191], v113 offset:38368
    v_cmp_eq_u32 vcc, 0, v1
    s_waitcnt lgkmcnt(7)
    v_mfma_f32_32x32x16_bf16 v[64:79], a[128:131], a[160:163], v[64:79]
    v_lshlrev_b32_e64 v160, 16, v224
    s_add_u32 s16, s10, 245760
    buffer_load_dwordx4 a[24:27], v134, s[48:51], s16 offen offset:0
    v_and_b32 v161, 0xffff0000, v224
    v_lshlrev_b32 v162, 16, v225
    s_waitcnt lgkmcnt(6)
    v_mfma_f32_32x32x16_bf16 v[64:79], a[132:135], a[164:167], v[64:79]
    v_and_b32 v163, 0xffff0000, v225
    v_lshlrev_b32_e64 v164, 16, v224
    v_and_b32 v165, 0xffff0000, v224
    v_lshlrev_b32_e64 v166, 16, v225
    v_and_b32 v167, 0xffff0000, v225
    s_waitcnt lgkmcnt(5)
    v_mfma_f32_32x32x16_bf16 v[64:79], a[136:139], a[168:171], v[64:79]
    v_lshlrev_b32 v168, 16, v226
    buffer_load_dwordx4 a[28:31], v135, s[48:51], s16 offen offset:1024
    v_and_b32 v169, 0xffff0000, v226
    v_lshlrev_b32 v170, 16, v227
    s_waitcnt lgkmcnt(4)
    v_mfma_f32_32x32x16_bf16 v[64:79], a[140:143], a[172:175], v[64:79]
    v_and_b32 v171, 0xffff0000, v227
    v_lshlrev_b32_e64 v172, 16, v226
    v_and_b32 v173, 0xffff0000, v226
    v_lshlrev_b32_e64 v174, 16, v227
    v_and_b32 v175, 0xffff0000, v227
    s_waitcnt lgkmcnt(3)
    v_mfma_f32_32x32x16_bf16 v[64:79], a[144:147], a[176:179], v[64:79]
    v_lshlrev_b32 v176, 16, v228
    s_add_u32 m0, s26, 139264
    s_add_u32 s16, s10, 163840
    buffer_load_dwordx4 v134, s[48:51], s16 offen offset:0 lds
    v_and_b32 v177, 0xffff0000, v228
    v_lshlrev_b32_e64 v178, 16, v229
    v_and_b32 v179, 0xffff0000, v229
    s_waitcnt lgkmcnt(2)
    v_mfma_f32_32x32x16_bf16 v[64:79], a[148:151], a[180:183], v[64:79]
    v_lshlrev_b32 v180, 16, v228
    v_and_b32 v181, 0xffff0000, v228
    v_lshlrev_b32_e64 v182, 16, v229
    v_and_b32 v183, 0xffff0000, v229
    s_waitcnt lgkmcnt(1)
    v_mfma_f32_32x32x16_bf16 v[64:79], a[152:155], a[184:187], v[64:79]
    v_lshlrev_b32 v184, 16, v230
    buffer_load_dwordx4 v135, s[48:51], s16 offen offset:1024 lds
    v_and_b32 v185, 0xffff0000, v230
    v_lshlrev_b32_e64 v186, 16, v231
    v_and_b32 v187, 0xffff0000, v231
    s_waitcnt lgkmcnt(0)
    v_mfma_f32_32x32x16_bf16 v[64:79], a[156:159], a[188:191], v[64:79]
    v_lshlrev_b32 v188, 16, v230
    v_and_b32 v189, 0xffff0000, v230
    v_lshlrev_b32_e64 v190, 16, v231
    v_and_b32 v191, 0xffff0000, v231
    v_cndmask_b32 v29, 0, v29, vcc
    s_cmp_eq_u32 s29, 0
    s_cbranch_scc1 L_uok
    s_waitcnt vmcnt(5)
    v_mov_b32 v136, v61
    v_cmp_ne_u32 vcc, v137, v136
    s_and_b32 vcc_lo, vcc_lo, 0xffff
    s_cbranch_scc1 L_spin0
L_back0:
    s_mov_b32 m0, s59
    v_cmp_eq_u32 vcc, 0, v1
    buffer_load_dwordx4 v128, s[52:55], s1 offen offset:0 sc1 lds
    buffer_load_dwordx4 v128, s[52:55], s1 offen offset:1024 sc1 lds
    buffer_load_dwordx4 v128, s[52:55], s1 offen offset:2048 sc1 lds
    buffer_load_dwordx4 v128, s[52:55], s1 offen offset:3072 sc1 lds
L_uok:
    s_nop 8
    v_add_f32_e64 v64, v64, v29
    v_mov_b32_dpp v10, v72 wave_rol:1 row_mask:0xf bank_mask:0xf
    v_mov_b32_dpp v11, v74 wave_rol:1 row_mask:0xf bank_mask:0xf
    v_mov_b32_dpp v12, v75 wave_rol:1 row_mask:0xf bank_mask:0xf
    v_mov_b32_dpp v13, v76 wave_rol:1 row_mask:0xf bank_mask:0xf
    v_mov_b32_dpp v10, v64 wave_shl:1 row_mask:0xf bank_mask:0xf
    v_mov_b32_dpp v11, v72 wave_shl:1 row_mask:0xf bank_mask:0xf
    v_mov_b32_dpp v12, v74 wave_shl:1 row_mask:0xf bank_mask:0xf
    v_mov_b32_dpp v13, v75 wave_shl:1 row_mask:0xf bank_mask:0xf
    v_cvt_pk_bf16_f32 v16, 0, v64
    v_cvt_pk_bf16_f32 v17, v74, v74
    v_cvt_pk_bf16_f32 v18, v74, v12
    v_cvt_pk_bf16_f32 v19, v75, v13
    v_readfirstlane_b32 s66, v17
    v_cndmask_b32 v71, v71, v10, s[62:63]
    v_cndmask_b32 v16, 0, v16, vcc
    v_mov_b32_dpp v18, v18 quad_perm:[1,1,3,3] row_mask:0xf bank_mask:0xf
    v_mov_b32_dpp v19, v19 quad_perm:[1,1,3,3] row_mask:0xf bank_mask:0xf
    v_and_b32_e64 v17, s66, v107
    ds_write_b32 v141, v16 offset:2240
    ds_write_b32 v141, v138
    ds_write_b32 v106, v17
    ds_write2_b32 v105, v18, v19 offset1:32
    v_cvt_pk_bf16_f32 v80, v64, v65
    v_cvt_pk_bf16_f32 v81, v66, v67
    v_cvt_pk_bf16_f32 v82, v68, v69
    v_cvt_pk_bf16_f32 v83, v70, v71
    ds_write_b128 v140, v[80:83] offset:32
    s_add_u32 s16, s11, 245760
    buffer_load_dwordx4 a[32:35], v134, s[48:51], s16 offen offset:0
    buffer_load_dwordx4 a[36:39], v135, s[48:51], s16 offen offset:1024
    v_cvt_pk_bf16_f32 v84, v65, v66
    v_cvt_pk_bf16_f32 v85, v67, v68
    v_cvt_pk_bf16_f32 v86, v69, v70
    v_cvt_pk_bf16_f32 v87, v71, v10
    ds_write_b128 v140, v[84:87] offset:2272
    s_add_u32 m0, s26, 98304
    s_add_u32 s16, s11, 81920
    buffer_load_dwordx4 v134, s[48:51], s16 offen offset:0 lds
    buffer_load_dwordx4 v135, s[48:51], s16 offen offset:1024 lds
    v_cvt_pk_bf16_f32 v88, v72, v72
    v_cvt_pk_bf16_f32 v89, v72, v73
    v_cvt_pk_bf16_f32 v90, v73, v73
    v_cvt_pk_bf16_f32 v91, v11, v11
    ds_write_b128 v140, v[88:91] offset:1056
    v_cvt_pk_bf16_f32 v92, v72, v72
    v_cvt_pk_bf16_f32 v93, v73, v73
    v_cvt_pk_bf16_f32 v94, v73, v11
    v_cvt_pk_bf16_f32 v95, v11, v11
    ds_write_b128 v140, v[92:95] offset:3296
    ds_read2_b32 a[128:129], v116 offset0:0 offset1:1
    ds_read2_b32 a[130:131], v116 offset0:2 offset1:3
    ds_read2_b32 a[132:133], v116 offset0:128 offset1:129
    ds_read2_b32 a[134:135], v116 offset0:130 offset1:131
    ds_read2_b32 a[136:137], v117 offset0:0 offset1:1
    ds_read2_b32 a[138:139], v117 offset0:2 offset1:3
    ds_read2_b32 a[140:141], v117 offset0:128 offset1:129
    ds_read2_b32 a[142:143], v117 offset0:130 offset1:131
    ds_read2_b32 a[144:145], v118 offset0:0 offset1:1
    ds_read2_b32 a[146:147], v118 offset0:2 offset1:3
    s_cmp_eq_u32 s29, 0
    s_cbranch_scc1 L_uok2
    s_waitcnt vmcnt(0)
L_uok2:
    s_waitcnt vmcnt(10)
    s_barrier
    s_nop 0
    ds_read_b128 a[188:191], v120 offset:19712
    ds_read_b128 a[184:187], v120 offset:21760
    ds_read_b128 a[180:183], v120 offset:23808
    ds_read_b128 a[176:179], v120 offset:25856
    ds_read_b128 a[172:175], v120 offset:27904
    ds_read_b128 a[168:171], v120 offset:29952
    ds_read_b128 a[164:167], v120 offset:32000
    ds_read_b128 a[160:163], v120 offset:34048
    s_waitcnt lgkmcnt(6)
    v_mfma_f32_16x16x32_bf16 v[252:255], a[128:131], a[188:191], 0
    ds_read2_b32 a[192:193], v116 offset0:16 offset1:17
    s_add_u32 m0, s26, 40960
    v_mfma_f32_16x16x32_bf16 v[248:251], a[128:131], a[184:187], 0
    ds_read2_b32 a[194:195], v116 offset0:18 offset1:19
    s_waitcnt lgkmcnt(6)
    v_mfma_f32_16x16x32_bf16 v[244:247], a[128:131], a[180:183], 0
    s_add_u32 s16, s10, 0
    buffer_load_dwordx4 v134, s[48:51], s16 offen offset:0 lds
    v_mfma_f32_16x16x32_bf16 v[240:243], a[128:131], a[176:179], 0
    ds_read_b128 a[252:255], v121 offset:19712
    s_waitcnt lgkmcnt(5)
    v_mfma_f32_16x16x32_bf16 v[236:239], a[128:131], a[172:175], 0
    ds_read_b128 a[80:83], v120 offset:34048
    ds_read_b128 a[84:87], v120 offset:32000
    v_mfma_f32_16x16x32_bf16 v[232:235], a[128:131], a[168:171], 0
    ds_read_b128 a[248:251], v121 offset:21760
    s_waitcnt lgkmcnt(6)
    v_mfma_f32_16x16x32_bf16 v[228:231], a[128:131], a[164:167], 0
    buffer_load_dwordx4 v135, s[48:51], s16 offen offset:1024 lds
    v_mfma_f32_16x16x32_bf16 v[224:227], a[128:131], a[160:163], 0
    ds_read_b128 a[244:247], v121 offset:23808
    s_add_u32 m0, s26, 90112
    v_mfma_f32_16x16x32_bf16 v[252:255], a[132:135], a[184:187], v[252:255]
    s_add_u32 s16, s10, 81920
    ds_read_b128 a[88:91], v120 offset:29952
    v_mfma_f32_16x16x32_bf16 v[248:251], a[132:135], a[180:183], v[248:251]
    ds_read_b128 a[240:243], v121 offset:25856
    ds_read_b128 a[92:95], v120 offset:27904
    v_mfma_f32_16x16x32_bf16 v[244:247], a[132:135], a[176:179], v[244:247]
    buffer_load_dwordx4 v134, s[48:51], s16 offen offset:0 lds
    v_mfma_f32_16x16x32_bf16 v[240:243], a[132:135], a[172:175], v[240:243]
    ds_read_b128 a[236:239], v121 offset:27904
    ds_read_b128 a[96:99], v119 offset:34048
    v_mfma_f32_16x16x32_bf16 v[236:239], a[132:135], a[168:171], v[236:239]
    ds_read_b128 a[100:103], v119 offset:32000
    ds_read_b128 a[104:107], v119 offset:29952
    v_mfma_f32_16x16x32_bf16 v[232:235], a[132:135], a[164:167], v[232:235]
    ds_read_b128 a[232:235], v121 offset:29952
    ds_read_b128 a[108:111], v119 offset:27904
    v_mfma_f32_16x16x32_bf16 v[228:231], a[132:135], a[160:163], v[228:231]
    buffer_load_dwordx4 v135, s[48:51], s16 offen offset:1024 lds
    v_mfma_f32_16x16x32_bf16 v[252:255], a[136:139], a[180:183], v[252:255]
    ds_read_b128 a[228:231], v121 offset:32000
    v_mfma_f32_16x16x32_bf16 v[248:251], a[136:139], a[176:179], v[248:251]
    ds_read_b128 a[224:227], v121 offset:34048
    v_mfma_f32_16x16x32_bf16 v[244:247], a[136:139], a[172:175], v[244:247]
    v_mfma_f32_16x16x32_bf16 v[240:243], a[136:139], a[168:171], v[240:243]
    ds_read2_b32 a[196:197], v116 offset0:144 offset1:145
    s_add_u32 m0, s26, 49152
    v_mfma_f32_16x16x32_bf16 v[236:239], a[136:139], a[164:167], v[236:239]
    s_add_u32 s16, s11, 0
    v_mfma_f32_16x16x32_bf16 v[232:235], a[136:139], a[160:163], v[232:235]
    ds_read2_b32 a[198:199], v116 offset0:146 offset1:147
    v_mfma_f32_16x16x32_bf16 v[252:255], a[140:143], a[176:179], v[252:255]
    buffer_load_dwordx4 v134, s[48:51], s16 offen offset:0 lds
    v_mfma_f32_16x16x32_bf16 v[248:251], a[140:143], a[172:175], v[248:251]
    ds_read2_b32 a[200:201], v117 offset0:16 offset1:17
    v_mfma_f32_16x16x32_bf16 v[244:247], a[140:143], a[168:171], v[244:247]
    v_mfma_f32_16x16x32_bf16 v[240:243], a[140:143], a[164:167], v[240:243]
    ds_read2_b32 a[202:203], v117 offset0:18 offset1:19
    v_mfma_f32_16x16x32_bf16 v[236:239], a[140:143], a[160:163], v[236:239]
    buffer_load_dwordx4 v135, s[48:51], s16 offen offset:1024 lds
    v_mfma_f32_16x16x32_bf16 v[252:255], a[144:147], a[172:175], v[252:255]
    ds_read2_b32 a[204:205], v117 offset0:144 offset1:145
    s_add_u32 m0, s26, 147456
    v_mfma_f32_16x16x32_bf16 v[248:251], a[144:147], a[168:171], v[248:251]
    s_add_u32 s16, s11, 163840
    v_mfma_f32_16x16x32_bf16 v[244:247], a[144:147], a[164:167], v[244:247]
    ds_read2_b32 a[206:207], v117 offset0:146 offset1:147
    v_mfma_f32_16x16x32_bf16 v[240:243], a[144:147], a[160:163], v[240:243]
    buffer_load_dwordx4 v134, s[48:51], s16 offen offset:0 lds
    s_waitcnt lgkmcnt(6)
    v_mfma_f32_16x16x32_bf16 v[252:255], a[192:195], a[252:255], v[252:255]
    ds_read2_b32 a[128:129], v116 offset0:32 offset1:33
    v_mfma_f32_16x16x32_bf16 v[248:251], a[192:195], a[248:251], v[248:251]
    ds_read2_b32 a[130:131], v116 offset0:34 offset1:35
    v_mfma_f32_16x16x32_bf16 v[244:247], a[192:195], a[244:247], v[244:247]
    v_mfma_f32_16x16x32_bf16 v[240:243], a[192:195], a[240:243], v[240:243]
    ds_read_b128 a[188:191], v122 offset:19712
    v_mfma_f32_16x16x32_bf16 v[236:239], a[192:195], a[236:239], v[236:239]
    ds_read_b128 a[184:187], v122 offset:21760
    v_mfma_f32_16x16x32_bf16 v[232:235], a[192:195], a[232:235], v[232:235]
    buffer_load_dwordx4 v135, s[48:51], s16 offen offset:1024 lds
    v_mfma_f32_16x16x32_bf16 v[228:231], a[192:195], a[228:231], v[228:231]
    ds_read_b128 a[180:183], v122 offset:23808
    v_mfma_f32_16x16x32_bf16 v[224:227], a[192:195], a[224:227], v[224:227]
    s_waitcnt lgkmcnt(5)
    v_mfma_f32_16x16x32_bf16 v[252:255], a[196:199], a[248:251], v[252:255]
    ds_read_b128 a[176:179], v122 offset:25856
    v_mfma_f32_16x16x32_bf16 v[248:251], a[196:199], a[244:247], v[248:251]
    ds_read_b128 a[172:175], v122 offset:27904
    s_add_u32 s16, s12, 245760
    v_mfma_f32_16x16x32_bf16 v[244:247], a[196:199], a[240:243], v[244:247]
    v_mfma_f32_16x16x32_bf16 v[240:243], a[196:199], a[236:239], v[240:243]
    ds_read_b128 a[168:171], v122 offset:29952
    v_mfma_f32_16x16x32_bf16 v[236:239], a[196:199], a[232:235], v[236:239]
    buffer_load_dwordx4 a[40:43], v134, s[48:51], s16 offen offset:0
    v_mfma_f32_16x16x32_bf16 v[232:235], a[196:199], a[228:231], v[232:235]
    ds_read_b128 a[164:167], v122 offset:32000
    v_mfma_f32_16x16x32_bf16 v[228:231], a[196:199], a[224:227], v[228:231]
    ds_read_b128 a[160:163], v122 offset:34048
    v_mfma_f32_16x16x32_bf16 v[252:255], a[200:203], a[244:247], v[252:255]
    v_mfma_f32_16x16x32_bf16 v[248:251], a[200:203], a[240:243], v[248:251]
    ds_read2_b32 a[132:133], v116 offset0:160 offset1:161
    v_mfma_f32_16x16x32_bf16 v[244:247], a[200:203], a[236:239], v[244:247]
    ds_read2_b32 a[134:135], v116 offset0:162 offset1:163
    v_mfma_f32_16x16x32_bf16 v[240:243], a[200:203], a[232:235], v[240:243]
    buffer_load_dwordx4 a[44:47], v135, s[48:51], s16 offen offset:1024
    v_mfma_f32_16x16x32_bf16 v[236:239], a[200:203], a[228:231], v[236:239]
    ds_read2_b32 a[136:137], v117 offset0:32 offset1:33
    v_mfma_f32_16x16x32_bf16 v[232:235], a[200:203], a[224:227], v[232:235]
    s_add_u32 m0, s26, 57344
    s_add_u32 s16, s12, 0
    v_mfma_f32_16x16x32_bf16 v[252:255], a[204:207], a[240:243], v[252:255]
    ds_read2_b32 a[138:139], v117 offset0:34 offset1:35
    v_mfma_f32_16x16x32_bf16 v[248:251], a[204:207], a[236:239], v[248:251]
    ds_read2_b32 a[140:141], v117 offset0:160 offset1:161
    v_mfma_f32_16x16x32_bf16 v[244:247], a[204:207], a[232:235], v[244:247]
    buffer_load_dwordx4 v134, s[48:51], s16 offen offset:0 lds
    v_mfma_f32_16x16x32_bf16 v[240:243], a[204:207], a[228:231], v[240:243]
    ds_read2_b32 a[142:143], v117 offset0:162 offset1:163
    v_mfma_f32_16x16x32_bf16 v[236:239], a[204:207], a[224:227], v[236:239]
    s_waitcnt lgkmcnt(6)
    v_mfma_f32_16x16x32_bf16 v[252:255], a[128:131], a[188:191], v[252:255]
    ds_read2_b32 a[192:193], v116 offset0:48 offset1:49
    v_mfma_f32_16x16x32_bf16 v[248:251], a[128:131], a[184:187], v[248:251]
    ds_read2_b32 a[194:195], v116 offset0:50 offset1:51
    v_mfma_f32_16x16x32_bf16 v[244:247], a[128:131], a[180:183], v[244:247]
    buffer_load_dwordx4 v135, s[48:51], s16 offen offset:1024 lds
    v_mfma_f32_16x16x32_bf16 v[240:243], a[128:131], a[176:179], v[240:243]
    ds_read_b128 a[252:255], v123 offset:19712
    v_mfma_f32_16x16x32_bf16 v[236:239], a[128:131], a[172:175], v[236:239]
    ds_read_b128 a[248:251], v123 offset:21760
    v_mfma_f32_16x16x32_bf16 v[232:235], a[128:131], a[168:171], v[232:235]
    v_mfma_f32_16x16x32_bf16 v[228:231], a[128:131], a[164:167], v[228:231]
    ds_read_b128 a[244:247], v123 offset:23808
    v_mfma_f32_16x16x32_bf16 v[224:227], a[128:131], a[160:163], v[224:227]
    s_add_u32 m0, s26, 106496
    s_waitcnt lgkmcnt(5)
    v_mfma_f32_16x16x32_bf16 v[252:255], a[132:135], a[184:187], v[252:255]
    ds_read_b128 a[240:243], v123 offset:25856
    s_add_u32 s16, s12, 81920
    v_mfma_f32_16x16x32_bf16 v[248:251], a[132:135], a[180:183], v[248:251]
    ds_read_b128 a[236:239], v123 offset:27904
    v_mfma_f32_16x16x32_bf16 v[244:247], a[132:135], a[176:179], v[244:247]
    buffer_load_dwordx4 v134, s[48:51], s16 offen offset:0 lds
    v_mfma_f32_16x16x32_bf16 v[240:243], a[132:135], a[172:175], v[240:243]
    ds_read_b128 a[232:235], v123 offset:29952
    v_mfma_f32_16x16x32_bf16 v[236:239], a[132:135], a[168:171], v[236:239]
    v_mfma_f32_16x16x32_bf16 v[232:235], a[132:135], a[164:167], v[232:235]
    ds_read_b128 a[228:231], v123 offset:32000
    v_mfma_f32_16x16x32_bf16 v[228:231], a[132:135], a[160:163], v[228:231]
    ds_read_b128 a[224:227], v123 offset:34048
    v_mfma_f32_16x16x32_bf16 v[252:255], a[136:139], a[180:183], v[252:255]
    buffer_load_dwordx4 v135, s[48:51], s16 offen offset:1024 lds
    v_mfma_f32_16x16x32_bf16 v[248:251], a[136:139], a[176:179], v[248:251]
    ds_read2_b32 a[196:197], v116 offset0:176 offset1:177
    v_mfma_f32_16x16x32_bf16 v[244:247], a[136:139], a[172:175], v[244:247]
    ds_read2_b32 a[198:199], v116 offset0:178 offset1:179
    s_add_u32 m0, s26, 155648
    v_mfma_f32_16x16x32_bf16 v[240:243], a[136:139], a[168:171], v[240:243]
    s_add_u32 s16, s12, 163840
    v_mfma_f32_16x16x32_bf16 v[236:239], a[136:139], a[164:167], v[236:239]
    ds_read2_b32 a[200:201], v117 offset0:48 offset1:49
    v_mfma_f32_16x16x32_bf16 v[232:235], a[136:139], a[160:163], v[232:235]
    buffer_load_dwordx4 v134, s[48:51], s16 offen offset:0 lds
    v_mfma_f32_16x16x32_bf16 v[252:255], a[140:143], a[176:179], v[252:255]
    ds_read2_b32 a[202:203], v117 offset0:50 offset1:51
    v_mfma_f32_16x16x32_bf16 v[248:251], a[140:143], a[172:175], v[248:251]
    ds_read2_b32 a[204:205], v117 offset0:176 offset1:177
    v_mfma_f32_16x16x32_bf16 v[244:247], a[140:143], a[168:171], v[244:247]
    ds_write_b32 v212, v138
    v_mfma_f32_16x16x32_bf16 v[240:243], a[140:143], a[164:167], v[240:243]
    ds_read2_b32 a[206:207], v117 offset0:178 offset1:179
    v_add_u32 v192, 65536, v144
    v_mfma_f32_16x16x32_bf16 v[236:239], a[140:143], a[160:163], v[236:239]
    buffer_load_dwordx4 v135, s[48:51], s16 offen offset:1024 lds
    s_waitcnt lgkmcnt(7)
    v_mfma_f32_16x16x32_bf16 v[252:255], a[192:195], a[252:255], v[252:255]
    ds_read2_b32 a[128:129], v116 offset0:64 offset1:65
    v_add_u32 v193, 65536, v145
    v_mfma_f32_16x16x32_bf16 v[248:251], a[192:195], a[248:251], v[248:251]
    v_add_u32 v194, 65536, v146
    v_add_u32 v195, 65536, v147
    v_mfma_f32_16x16x32_bf16 v[244:247], a[192:195], a[244:247], v[244:247]
    ds_read2_b32 a[130:131], v116 offset0:66 offset1:67
    s_add_u32 s16, s13, 245760
    v_mfma_f32_16x16x32_bf16 v[240:243], a[192:195], a[240:243], v[240:243]
    v_add_u32 v196, 131072, v144
    v_add_u32 v197, 131072, v145
    v_mfma_f32_16x16x32_bf16 v[236:239], a[192:195], a[236:239], v[236:239]
    ds_read_b128 a[188:191], v120 offset:20736
    v_add_u32 v198, 131072, v146
    v_mfma_f32_16x16x32_bf16 v[232:235], a[192:195], a[232:235], v[232:235]
    buffer_load_dwordx4 a[48:51], v134, s[48:51], s16 offen offset:0
    v_mfma_f32_16x16x32_bf16 v[228:231], a[192:195], a[228:231], v[228:231]
    ds_read_b128 a[184:187], v120 offset:22784
    v_add_u32 v199, 131072, v147
    v_mfma_f32_16x16x32_bf16 v[224:227], a[192:195], a[224:227], v[224:227]
    ds_read2_b32 a[112:113], v104 offset0:3 offset1:2
    s_waitcnt lgkmcnt(5)
    v_mfma_f32_16x16x32_bf16 v[252:255], a[196:199], a[248:251], v[252:255]
    ds_read_b128 a[180:183], v120 offset:24832
    ds_read2_b32 a[114:115], v104 offset0:1 offset1:0
    v_mfma_f32_16x16x32_bf16 v[248:251], a[196:199], a[244:247], v[248:251]
    buffer_load_dwordx4 a[52:55], v135, s[48:51], s16 offen offset:1024
    v_mfma_f32_16x16x32_bf16 v[244:247], a[196:199], a[240:243], v[244:247]
    ds_read_b128 a[176:179], v120 offset:26880
    s_add_u32 m0, s26, 65536
    v_mfma_f32_16x16x32_bf16 v[240:243], a[196:199], a[236:239], v[240:243]
    s_add_u32 s16, s13, 0
    ds_read2_b32 a[116:117], v104 offset0:19 offset1:18
    v_mfma_f32_16x16x32_bf16 v[236:239], a[196:199], a[232:235], v[236:239]
    ds_read_b128 a[172:175], v120 offset:28928
    ds_read2_b32 a[118:119], v104 offset0:17 offset1:16
    v_mfma_f32_16x16x32_bf16 v[232:235], a[196:199], a[228:231], v[232:235]
    buffer_load_dwordx4 v134, s[48:51], s16 offen offset:0 lds
    v_mfma_f32_16x16x32_bf16 v[228:231], a[196:199], a[224:227], v[228:231]
    ds_read_b128 a[168:171], v120 offset:30976
    ds_read2_b32 a[120:121], v104 offset0:35 offset1:34
    v_mfma_f32_16x16x32_bf16 v[252:255], a[200:203], a[244:247], v[252:255]
    ds_read2_b32 a[122:123], v104 offset0:33 offset1:32
    ds_read2_b32 a[124:125], v104 offset0:51 offset1:50
    v_mfma_f32_16x16x32_bf16 v[248:251], a[200:203], a[240:243], v[248:251]
    buffer_load_dwordx4 v135, s[48:51], s16 offen offset:1024 lds
    v_mfma_f32_16x16x32_bf16 v[244:247], a[200:203], a[236:239], v[244:247]
    ds_read_b128 a[164:167], v120 offset:33024
    ds_read2_b32 a[126:127], v104 offset0:49 offset1:48
    v_mfma_f32_16x16x32_bf16 v[240:243], a[200:203], a[232:235], v[240:243]
    v_mfma_f32_16x16x32_bf16 v[236:239], a[200:203], a[228:231], v[236:239]
    ds_read_b128 a[160:163], v120 offset:35072
    s_add_u32 m0, s26, 114688
    v_mfma_f32_16x16x32_bf16 v[232:235], a[200:203], a[224:227], v[232:235]
    s_add_u32 s16, s13, 81920
    v_mfma_f32_16x16x32_bf16 v[252:255], a[204:207], a[240:243], v[252:255]
    ds_read2_b32 a[132:133], v116 offset0:192 offset1:193
    v_mfma_f32_16x16x32_bf16 v[248:251], a[204:207], a[236:239], v[248:251]
    buffer_load_dwordx4 v134, s[48:51], s16 offen offset:0 lds
    v_mfma_f32_16x16x32_bf16 v[244:247], a[204:207], a[232:235], v[244:247]
    ds_read2_b32 a[134:135], v116 offset0:194 offset1:195
    v_mfma_f32_16x16x32_bf16 v[240:243], a[204:207], a[228:231], v[240:243]
    v_mfma_f32_16x16x32_bf16 v[236:239], a[204:207], a[224:227], v[236:239]
    ds_read2_b32 a[136:137], v117 offset0:64 offset1:65
    v_mfma_f32_16x16x32_bf16 v[64:67], a[80:83], v[96:99], 0
    buffer_load_dwordx4 v135, s[48:51], s16 offen offset:1024 lds
    v_mfma_f32_16x16x32_bf16 v[68:71], a[84:87], v[96:99], 0
    ds_read2_b32 a[138:139], v117 offset0:66 offset1:67
L_ptB2:
    s_cbranch_execz L_ptdB
    s_add_u32 s16, s13, 163840
    v_mfma_f32_16x16x32_bf16 v[72:75], a[88:91], v[96:99], 0
    v_mfma_f32_16x16x32_bf16 v[76:79], a[92:95], v[96:99], 0
    ds_read2_b32 a[140:141], v117 offset0:192 offset1:193
    v_mfma_f32_16x16x32_bf16 v[80:83], a[96:99], v[100:103], 0
    buffer_load_dwordx4 a[0:3], v134, s[48:51], s16 offen offset:0
    v_mfma_f32_16x16x32_bf16 v[84:87], a[100:103], v[100:103], 0
    ds_read2_b32 a[142:143], v117 offset0:194 offset1:195
    v_mfma_f32_16x16x32_bf16 v[88:91], a[104:107], v[100:103], 0
    v_mfma_f32_16x16x32_bf16 v[92:95], a[108:111], v[100:103], 0
    buffer_load_dwordx4 a[4:7], v135, s[48:51], s16 offen offset:1024
    s_waitcnt lgkmcnt(6)
    v_mfma_f32_16x16x32_bf16 v[252:255], a[128:131], a[188:191], v[252:255]
    ds_read2_b32 a[192:193], v116 offset0:80 offset1:81
    v_mfma_f32_16x16x32_bf16 v[248:251], a[128:131], a[184:187], v[248:251]
    ds_read2_b32 a[194:195], v116 offset0:82 offset1:83
    v_mfma_f32_16x16x32_bf16 v[244:247], a[128:131], a[180:183], v[244:247]
    v_mfma_f32_16x16x32_bf16 v[240:243], a[128:131], a[176:179], v[240:243]
    ds_read_b128 a[252:255], v121 offset:20736
    v_mfma_f32_16x16x32_bf16 v[236:239], a[128:131], a[172:175], v[236:239]
    ds_read_b128 a[248:251], v121 offset:22784
    s_add_u32 m0, s26, 73728
    v_mfma_f32_16x16x32_bf16 v[232:235], a[128:131], a[168:171], v[232:235]
    s_add_u32 s16, s14, 0
    v_cvt_pk_bf16_f32 v64, v64, v80
    v_mfma_f32_16x16x32_bf16 v[228:231], a[128:131], a[164:167], v[228:231]
    ds_read_b128 a[244:247], v121 offset:24832
    v_cvt_pk_bf16_f32 v65, v65, v81
    v_mfma_f32_16x16x32_bf16 v[224:227], a[128:131], a[160:163], v[224:227]
    buffer_load_dwordx4 v134, s[48:51], s16 offen offset:0 lds
    s_waitcnt lgkmcnt(5)
    v_mfma_f32_16x16x32_bf16 v[252:255], a[132:135], a[184:187], v[252:255]
    ds_read_b128 a[240:243], v121 offset:26880
    v_cvt_pk_bf16_f32 v66, v66, v82
    v_mfma_f32_16x16x32_bf16 v[248:251], a[132:135], a[180:183], v[248:251]
    ds_read_b128 a[236:239], v121 offset:28928
    v_cvt_pk_bf16_f32 v67, v67, v83
    v_mfma_f32_16x16x32_bf16 v[244:247], a[132:135], a[176:179], v[244:247]
    v_cvt_pk_bf16_f32 v68, v68, v84
    v_cvt_pk_bf16_f32 v69, v69, v85
    v_mfma_f32_16x16x32_bf16 v[240:243], a[132:135], a[172:175], v[240:243]
    ds_read_b128 a[232:235], v121 offset:30976
    v_cvt_pk_bf16_f32 v70, v70, v86
    v_mfma_f32_16x16x32_bf16 v[236:239], a[132:135], a[168:171], v[236:239]
    buffer_load_dwordx4 v135, s[48:51], s16 offen offset:1024 lds
    v_mfma_f32_16x16x32_bf16 v[232:235], a[132:135], a[164:167], v[232:235]
    ds_read_b128 a[228:231], v121 offset:33024
    v_cvt_pk_bf16_f32 v71, v71, v87
    v_mfma_f32_16x16x32_bf16 v[228:231], a[132:135], a[160:163], v[228:231]
    ds_read_b128 a[224:227], v121 offset:35072
    v_cvt_pk_bf16_f32 v72, v72, v88
    v_mfma_f32_16x16x32_bf16 v[252:255], a[136:139], a[180:183], v[252:255]
    s_add_u32 m0, s26, 122880
    s_add_u32 s16, s14, 81920
    v_mfma_f32_16x16x32_bf16 v[248:251], a[136:139], a[176:179], v[248:251]
    ds_read2_b32 a[196:197], v116 offset0:208 offset1:209
    v_cvt_pk_bf16_f32 v73, v73, v89
    v_mfma_f32_16x16x32_bf16 v[244:247], a[136:139], a[172:175], v[244:247]
    ds_read2_b32 a[198:199], v116 offset0:210 offset1:211
    v_cvt_pk_bf16_f32 v74, v74, v90
    v_mfma_f32_16x16x32_bf16 v[240:243], a[136:139], a[168:171], v[240:243]
    buffer_load_dwordx4 v134, s[48:51], s16 offen offset:0 lds
    v_mfma_f32_16x16x32_bf16 v[236:239], a[136:139], a[164:167], v[236:239]
    ds_read2_b32 a[200:201], v117 offset0:80 offset1:81
    v_cvt_pk_bf16_f32 v75, v75, v91
    v_mfma_f32_16x16x32_bf16 v[232:235], a[136:139], a[160:163], v[232:235]
    v_cvt_pk_bf16_f32 v76, v76, v92
    v_cvt_pk_bf16_f32 v77, v77, v93
    v_mfma_f32_16x16x32_bf16 v[252:255], a[140:143], a[176:179], v[252:255]
    ds_read2_b32 a[202:203], v117 offset0:82 offset1:83
    v_cvt_pk_bf16_f32 v78, v78, v94
    v_mfma_f32_16x16x32_bf16 v[248:251], a[140:143], a[172:175], v[248:251]
    ds_read2_b32 a[204:205], v117 offset0:208 offset1:209
    v_cvt_pk_bf16_f32 v79, v79, v95
    v_mfma_f32_16x16x32_bf16 v[244:247], a[140:143], a[168:171], v[244:247]
    buffer_load_dwordx4 v135, s[48:51], s16 offen offset:1024 lds
    v_mfma_f32_16x16x32_bf16 v[240:243], a[140:143], a[164:167], v[240:243]
    ds_read2_b32 a[206:207], v117 offset0:210 offset1:211
    v_mfma_f32_16x16x32_bf16 v[236:239], a[140:143], a[160:163], v[236:239]
    s_waitcnt lgkmcnt(6)
    v_mfma_f32_16x16x32_bf16 v[252:255], a[192:195], a[252:255], v[252:255]
    ds_read2_b32 a[128:129], v116 offset0:96 offset1:97
    s_add_u32 s16, s14, 163840
    v_mfma_f32_16x16x32_bf16 v[248:251], a[192:195], a[248:251], v[248:251]
    v_mfma_f32_16x16x32_bf16 v[244:247], a[192:195], a[244:247], v[244:247]
    ds_read2_b32 a[130:131], v116 offset0:98 offset1:99
    v_mfma_f32_16x16x32_bf16 v[240:243], a[192:195], a[240:243], v[240:243]
    buffer_load_dwordx4 a[8:11], v134, s[48:51], s16 offen offset:0
    v_mfma_f32_16x16x32_bf16 v[236:239], a[192:195], a[236:239], v[236:239]
    ds_read_b128 a[188:191], v122 offset:20736
    v_mfma_f32_16x16x32_bf16 v[232:235], a[192:195], a[232:235], v[232:235]
    v_mfma_f32_16x16x32_bf16 v[228:231], a[192:195], a[228:231], v[228:231]
    ds_read_b128 a[184:187], v122 offset:22784
    v_mfma_f32_16x16x32_bf16 v[224:227], a[192:195], a[224:227], v[224:227]
    buffer_load_dwordx4 a[12:15], v135, s[48:51], s16 offen offset:1024
    s_waitcnt lgkmcnt(4)
    v_mfma_f32_16x16x32_bf16 v[252:255], a[196:199], a[248:251], v[252:255]
    s_add_u32 m0, s26, 81920
    s_add_u32 s16, s15, 0
    v_mfma_f32_16x16x32_bf16 v[248:251], a[196:199], a[244:247], v[248:251]
    ds_read_b128 a[180:183], v122 offset:24832
    v_mfma_f32_16x16x32_bf16 v[244:247], a[196:199], a[240:243], v[244:247]
    buffer_load_dwordx4 v134, s[48:51], s16 offen offset:0 lds
    v_mfma_f32_16x16x32_bf16 v[240:243], a[196:199], a[236:239], v[240:243]
    ds_read_b128 a[176:179], v122 offset:26880
    v_mfma_f32_16x16x32_bf16 v[236:239], a[196:199], a[232:235], v[236:239]
    v_mfma_f32_16x16x32_bf16 v[232:235], a[196:199], a[228:231], v[232:235]
    ds_read_b128 a[172:175], v122 offset:28928
    v_mfma_f32_16x16x32_bf16 v[228:231], a[196:199], a[224:227], v[228:231]
    buffer_load_dwordx4 v135, s[48:51], s16 offen offset:1024 lds
    v_mfma_f32_16x16x32_bf16 v[252:255], a[200:203], a[244:247], v[252:255]
    ds_read_b128 a[168:171], v122 offset:30976
    v_mfma_f32_16x16x32_bf16 v[248:251], a[200:203], a[240:243], v[248:251]
    s_add_u32 m0, s26, 131072
    s_add_u32 s16, s15, 81920
    v_mfma_f32_16x16x32_bf16 v[244:247], a[200:203], a[236:239], v[244:247]
    v_mfma_f32_16x16x32_bf16 v[240:243], a[200:203], a[232:235], v[240:243]
    ds_read_b128 a[164:167], v122 offset:33024
    v_mfma_f32_16x16x32_bf16 v[236:239], a[200:203], a[228:231], v[236:239]
    buffer_load_dwordx4 v134, s[48:51], s16 offen offset:0 lds
    v_mfma_f32_16x16x32_bf16 v[232:235], a[200:203], a[224:227], v[232:235]
    ds_read_b128 a[160:163], v122 offset:35072
    v_mfma_f32_16x16x32_bf16 v[252:255], a[204:207], a[240:243], v[252:255]
    v_mfma_f32_16x16x32_bf16 v[248:251], a[204:207], a[236:239], v[248:251]
    ds_read2_b32 a[132:133], v116 offset0:224 offset1:225
    v_mfma_f32_16x16x32_bf16 v[244:247], a[204:207], a[232:235], v[244:247]
    buffer_load_dwordx4 v135, s[48:51], s16 offen offset:1024 lds
    v_mfma_f32_16x16x32_bf16 v[240:243], a[204:207], a[228:231], v[240:243]
    ds_read2_b32 a[134:135], v116 offset0:226 offset1:227
    s_add_u32 s16, s14, 245760
    v_mfma_f32_16x16x32_bf16 v[236:239], a[204:207], a[224:227], v[236:239]
    v_mfma_f32_16x16x32_bf16 v[240:243], v[64:67], a[112:115], v[240:243]
    buffer_load_dwordx4 a[56:59], v134, s[48:51], s16 offen offset:0
    v_mfma_f32_16x16x32_bf16 v[244:247], v[68:71], a[112:115], v[244:247]
    ds_read2_b32 a[136:137], v117 offset0:96 offset1:97
    v_mfma_f32_16x16x32_bf16 v[248:251], v[72:75], a[112:115], v[248:251]
    v_mov_b32 v136, 0
    buffer_atomic_or v136, v132, s[52:55], s32 offen offset:0 sc0 sc1
    v_mfma_f32_16x16x32_bf16 v[252:255], v[76:79], a[112:115], v[252:255]
    ds_read2_b32 a[138:139], v117 offset0:98 offset1:99
    v_mfma_f32_16x16x32_bf16 v[244:247], v[64:67], a[116:119], v[244:247]
    buffer_load_dwordx4 a[60:63], v135, s[48:51], s16 offen offset:1024
    v_mfma_f32_16x16x32_bf16 v[248:251], v[68:71], a[116:119], v[248:251]
    ds_read2_b32 a[140:141], v117 offset0:224 offset1:225
    v_mfma_f32_16x16x32_bf16 v[252:255], v[72:75], a[116:119], v[252:255]
    s_add_u32 s16, s15, 163840
    v_mfma_f32_16x16x32_bf16 v[248:251], v[64:67], a[120:123], v[248:251]
    ds_read2_b32 a[142:143], v117 offset0:226 offset1:227
    v_mfma_f32_16x16x32_bf16 v[252:255], v[68:71], a[120:123], v[252:255]
    v_mfma_f32_16x16x32_bf16 v[252:255], v[64:67], a[124:127], v[252:255]
    buffer_load_dwordx4 a[16:19], v134, s[48:51], s16 offen offset:0
    s_waitcnt lgkmcnt(6)
    v_mfma_f32_16x16x32_bf16 v[252:255], a[128:131], a[188:191], v[252:255]
    ds_read2_b32 a[192:193], v116 offset0:112 offset1:113
    v_mfma_f32_16x16x32_bf16 v[248:251], a[128:131], a[184:187], v[248:251]
    ds_read2_b32 a[194:195], v116 offset0:114 offset1:115
    v_mfma_f32_16x16x32_bf16 v[244:247], a[128:131], a[180:183], v[244:247]
    v_mfma_f32_16x16x32_bf16 v[240:243], a[128:131], a[176:179], v[240:243]
    ds_read_b128 a[252:255], v123 offset:20736
    v_mfma_f32_16x16x32_bf16 v[236:239], a[128:131], a[172:175], v[236:239]
    ds_read_b128 a[248:251], v123 offset:22784
    v_mfma_f32_16x16x32_bf16 v[232:235], a[128:131], a[168:171], v[232:235]
    buffer_load_dwordx4 a[20:23], v135, s[48:51], s16 offen offset:1024
    v_mfma_f32_16x16x32_bf16 v[228:231], a[128:131], a[164:167], v[228:231]
    ds_read_b128 a[244:247], v123 offset:24832
    v_mfma_f32_16x16x32_bf16 v[224:227], a[128:131], a[160:163], v[224:227]
    s_add_u32 s16, s15, 245760
    s_waitcnt lgkmcnt(5)
    v_mfma_f32_16x16x32_bf16 v[252:255], a[132:135], a[184:187], v[252:255]
    ds_read_b128 a[240:243], v123 offset:26880
    v_mfma_f32_16x16x32_bf16 v[248:251], a[132:135], a[180:183], v[248:251]
    ds_read_b128 a[236:239], v123 offset:28928
    v_mfma_f32_16x16x32_bf16 v[244:247], a[132:135], a[176:179], v[244:247]
    buffer_load_dwordx4 a[64:67], v134, s[48:51], s16 offen offset:0
    v_mfma_f32_16x16x32_bf16 v[240:243], a[132:135], a[172:175], v[240:243]
    ds_read_b128 a[232:235], v123 offset:30976
    v_mfma_f32_16x16x32_bf16 v[236:239], a[132:135], a[168:171], v[236:239]
    v_mfma_f32_16x16x32_bf16 v[232:235], a[132:135], a[164:167], v[232:235]
    ds_read_b128 a[228:231], v123 offset:33024
    v_mfma_f32_16x16x32_bf16 v[228:231], a[132:135], a[160:163], v[228:231]
    ds_read_b128 a[224:227], v123 offset:35072
    v_mfma_f32_16x16x32_bf16 v[252:255], a[136:139], a[180:183], v[252:255]
    buffer_load_dwordx4 a[68:71], v135, s[48:51], s16 offen offset:1024
    v_mfma_f32_16x16x32_bf16 v[248:251], a[136:139], a[176:179], v[248:251]
    ds_read2_b32 a[196:197], v116 offset0:240 offset1:241
    v_mfma_f32_16x16x32_bf16 v[244:247], a[136:139], a[172:175], v[244:247]
    ds_read2_b32 a[198:199], v116 offset0:242 offset1:243
    v_mfma_f32_16x16x32_bf16 v[240:243], a[136:139], a[168:171], v[240:243]
    v_mfma_f32_16x16x32_bf16 v[236:239], a[136:139], a[164:167], v[236:239]
    ds_read2_b32 a[200:201], v117 offset0:112 offset1:113
    v_mfma_f32_16x16x32_bf16 v[232:235], a[136:139], a[160:163], v[232:235]
    v_mfma_f32_16x16x32_bf16 v[252:255], a[140:143], a[176:179], v[252:255]
    ds_read2_b32 a[202:203], v117 offset0:114 offset1:115
    v_mfma_f32_16x16x32_bf16 v[248:251], a[140:143], a[172:175], v[248:251]
    ds_read2_b32 a[204:205], v117 offset0:240 offset1:241
    v_mfma_f32_16x16x32_bf16 v[244:247], a[140:143], a[168:171], v[244:247]
    v_mfma_f32_16x16x32_bf16 v[240:243], a[140:143], a[164:167], v[240:243]
    ds_read2_b32 a[206:207], v117 offset0:242 offset1:243
    v_mfma_f32_16x16x32_bf16 v[236:239], a[140:143], a[160:163], v[236:239]
    s_waitcnt lgkmcnt(6)
    v_mfma_f32_16x16x32_bf16 v[224:227], a[192:195], a[224:227], v[224:227]
    s_waitcnt vmcnt(5)
    v_cmp_ne_u32 vcc, v137, v136
    v_mfma_f32_16x16x32_bf16 v[228:231], a[192:195], a[228:231], v[228:231]
    s_and_b32 s29, vcc_lo, 0xfff
    s_cselect_b32 s28, 0x7ffff000, 0
    s_waitcnt lgkmcnt(4)
    v_mfma_f32_16x16x32_bf16 v[228:231], a[196:199], a[224:227], v[228:231]
    v_or_b32_e64 v126, s28, v128
    v_mfma_f32_16x16x32_bf16 v[232:235], a[192:195], a[232:235], v[232:235]
    s_add_u32 s33, s4, 0
    buffer_load_dwordx4 a[80:83], v126, s[52:55], s33 offen offset:0 sc1
    v_mfma_f32_16x16x32_bf16 v[232:235], a[196:199], a[228:231], v[232:235]
    s_waitcnt lgkmcnt(2)
    v_mfma_f32_16x16x32_bf16 v[232:235], a[200:203], a[224:227], v[232:235]
    v_mfma_f32_16x16x32_bf16 v[236:239], a[192:195], a[236:239], v[236:239]
    buffer_load_dwordx4 a[84:87], v126, s[52:55], s33 offen offset:1024 sc1
    v_mfma_f32_16x16x32_bf16 v[236:239], a[196:199], a[232:235], v[236:239]
    v_mfma_f32_16x16x32_bf16 v[236:239], a[200:203], a[228:231], v[236:239]
    s_waitcnt lgkmcnt(0)
    v_mfma_f32_16x16x32_bf16 v[236:239], a[204:207], a[224:227], v[236:239]
    buffer_load_dwordx4 a[88:91], v126, s[52:55], s33 offen offset:2048 sc1
    v_mfma_f32_16x16x32_bf16 v[240:243], a[192:195], a[240:243], v[240:243]
    v_cvt_pk_bf16_f32 v8, v224, v225
    v_cvt_pk_bf16_f32 v9, v226, v227
    v_mfma_f32_16x16x32_bf16 v[240:243], a[196:199], a[236:239], v[240:243]
    ds_write_b64 v142, v[8:9] offset:0
    v_mfma_f32_16x16x32_bf16 v[240:243], a[200:203], a[232:235], v[240:243]
    buffer_load_dwordx4 a[92:95], v126, s[52:55], s33 offen offset:3072 sc1
    v_mfma_f32_16x16x32_bf16 v[240:243], a[204:207], a[228:231], v[240:243]
    s_add_u32 s33, s5, 0
    v_cvt_pk_bf16_f32 v10, v228, v229
    v_mfma_f32_16x16x32_bf16 v[244:247], a[192:195], a[244:247], v[244:247]
    v_cvt_pk_bf16_f32 v11, v230, v231
    v_mfma_f32_16x16x32_bf16 v[244:247], a[196:199], a[240:243], v[244:247]
    ds_write_b64 v142, v[10:11] offset:256
    v_mfma_f32_16x16x32_bf16 v[244:247], a[200:203], a[236:239], v[244:247]
    buffer_load_dwordx4 a[96:99], v126, s[52:55], s33 offen offset:0 sc1
    v_mfma_f32_16x16x32_bf16 v[244:247], a[204:207], a[232:235], v[244:247]
    v_cvt_pk_bf16_f32 v12, v232, v233
    v_cvt_pk_bf16_f32 v13, v234, v235
    v_mfma_f32_16x16x32_bf16 v[248:251], a[192:195], a[248:251], v[248:251]
    ds_write_b64 v142, v[12:13] offset:512
    v_mfma_f32_16x16x32_bf16 v[248:251], a[196:199], a[244:247], v[248:251]
    buffer_load_dwordx4 a[100:103], v126, s[52:55], s33 offen offset:1024 sc1
    v_mfma_f32_16x16x32_bf16 v[248:251], a[200:203], a[240:243], v[248:251]
    v_cvt_pk_bf16_f32 v14, v236, v237
    v_cvt_pk_bf16_f32 v15, v238, v239
    v_mfma_f32_16x16x32_bf16 v[248:251], a[204:207], a[236:239], v[248:251]
    ds_write_b64 v142, v[14:15] offset:768
    v_mfma_f32_16x16x32_bf16 v[252:255], a[192:195], a[252:255], v[252:255]
    buffer_load_dwordx4 a[104:107], v126, s[52:55], s33 offen offset:2048 sc1
    v_mfma_f32_16x16x32_bf16 v[252:255], a[196:199], a[248:251], v[252:255]
    v_cvt_pk_bf16_f32 v16, v240, v241
    v_cvt_pk_bf16_f32 v17, v242, v243
    v_mfma_f32_16x16x32_bf16 v[252:255], a[200:203], a[244:247], v[252:255]
    ds_write_b64 v142, v[16:17] offset:1024
    v_mfma_f32_16x16x32_bf16 v[252:255], a[204:207], a[240:243], v[252:255]
    v_cvt_pk_bf16_f32 v18, v244, v245
    v_cvt_pk_bf16_f32 v19, v246, v247
    ds_write_b64 v142, v[18:19] offset:1280
    v_mov_b32_e64 v139, 0
    buffer_atomic_or v139, v132, s[52:55], s32 offen offset:0 sc0 sc1
    s_nop 2
    s_nop 0
    v_cvt_pk_bf16_f32 v20, v248, v249
    v_cvt_pk_bf16_f32 v21, v250, v251
    ds_write_b64 v142, v[20:21] offset:1536
    buffer_load_dwordx4 a[108:111], v126, s[52:55], s33 offen offset:3072 sc1
    v_cvt_pk_bf16_f32 v22, v252, v253
    v_cvt_pk_bf16_f32 v23, v254, v255
    ds_write_b64 v142, v[22:23] offset:1792
    s_add_u32 s33, s6, 0
    buffer_load_dwordx4 a[112:115], v126, s[52:55], s33 offen offset:0 sc1
    s_waitcnt lgkmcnt(0)
    s_barrier
    s_nop 0
    ds_read_b64_tr_b16 v[24:25], v143 offset:0
    ds_read_b64_tr_b16 v[26:27], v143 offset:2064
    buffer_load_dwordx4 a[116:119], v126, s[52:55], s33 offen offset:1024 sc1
    ds_read_b64_tr_b16 v[28:29], v143 offset:128
    ds_read_b64_tr_b16 v[30:31], v143 offset:2192
    buffer_load_dwordx4 a[120:123], v126, s[52:55], s33 offen offset:2048 sc1
    ds_read_b64_tr_b16 v[32:33], v143 offset:256
    ds_read_b64_tr_b16 v[34:35], v143 offset:2320
    buffer_load_dwordx4 a[124:127], v126, s[52:55], s33 offen offset:3072 sc1
    ds_read_b64_tr_b16 v[36:37], v143 offset:384
    ds_read_b64_tr_b16 v[38:39], v143 offset:2448
    ds_read_b64_tr_b16 v[224:225], v144 offset:40960
    ds_read_b64_tr_b16 v[226:227], v144 offset:43008
    ds_read_b64_tr_b16 v[228:229], v145 offset:40960
    ds_read_b64_tr_b16 v[230:231], v145 offset:43008
    ds_read_b64_tr_b16 v[232:233], v146 offset:40960
    ds_read_b64_tr_b16 v[234:235], v146 offset:43008
    ds_read_b64_tr_b16 v[236:237], v147 offset:40960
    ds_read_b64_tr_b16 v[238:239], v147 offset:43008
    ds_read_b64_tr_b16 v[240:241], v144 offset:45056
    ds_read_b64_tr_b16 v[242:243], v144 offset:47104
    ds_read_b64_tr_b16 v[244:245], v145 offset:45056
    ds_read_b64_tr_b16 v[246:247], v145 offset:47104
    s_waitcnt lgkmcnt(15)
    buffer_store_dwordx4 v[24:27], v128, s[52:55], s17 offen offset:0 sc1
    buffer_store_dwordx4 v[28:31], v128, s[52:55], s17 offen offset:1024 sc1
    s_waitcnt lgkmcnt(14)
    buffer_store_dwordx4 v[32:35], v128, s[52:55], s17 offen offset:2048 sc1
    s_waitcnt lgkmcnt(12)
    buffer_store_dwordx4 v[36:39], v128, s[52:55], s17 offen offset:3072 sc1
    ds_write_b128 v150, a[0:3] offset:24576
    ds_write_b128 v150, a[4:7] offset:25600
    s_cmp_eq_u32 s29, 0
    s_cbranch_scc1 L_g2go
    s_waitcnt vmcnt(9)
    v_mov_b32 v136, v139
    v_cmp_ne_u32 vcc, v137, v136
    s_and_b32 vcc_lo, vcc_lo, 0xfff
    s_cbranch_scc1 L_spin1
L_back1:
    s_add_u32 s33, s4, 0
    buffer_load_dwordx4 a[80:83], v128, s[52:55], s33 offen offset:0 sc1
    buffer_load_dwordx4 a[84:87], v128, s[52:55], s33 offen offset:1024 sc1
    buffer_load_dwordx4 a[88:91], v128, s[52:55], s33 offen offset:2048 sc1
    buffer_load_dwordx4 a[92:95], v128, s[52:55], s33 offen offset:3072 sc1
    s_add_u32 s33, s5, 0
    buffer_load_dwordx4 a[96:99], v128, s[52:55], s33 offen offset:0 sc1
    buffer_load_dwordx4 a[100:103], v128, s[52:55], s33 offen offset:1024 sc1
    buffer_load_dwordx4 a[104:107], v128, s[52:55], s33 offen offset:2048 sc1
    buffer_load_dwordx4 a[108:111], v128, s[52:55], s33 offen offset:3072 sc1
    s_add_u32 s33, s6, 0
    buffer_load_dwordx4 a[112:115], v128, s[52:55], s33 offen offset:0 sc1
    buffer_load_dwordx4 a[116:119], v128, s[52:55], s33 offen offset:1024 sc1
    buffer_load_dwordx4 a[120:123], v128, s[52:55], s33 offen offset:2048 sc1
    buffer_load_dwordx4 a[124:127], v128, s[52:55], s33 offen offset:3072 sc1
L_g2go:
    s_waitcnt lgkmcnt(6) vmcnt(10)
    v_mfma_f32_16x16x32_bf16 v[160:163], v[224:227], a[80:83], v[160:163]
    ds_read_b64_tr_b16 v[248:249], v146 offset:45056
    ds_read_b64_tr_b16 v[250:251], v146 offset:47104
    v_mfma_f32_16x16x32_bf16 v[164:167], v[224:227], a[84:87], v[164:167]
    ds_read_b64_tr_b16 v[252:253], v147 offset:45056
    ds_read_b64_tr_b16 v[254:255], v147 offset:47104
    v_mfma_f32_16x16x32_bf16 v[168:171], v[228:231], a[80:83], v[168:171]
    s_add_u32 s33, s7, 0
    v_mfma_f32_16x16x32_bf16 v[172:175], v[228:231], a[84:87], v[172:175]
    buffer_load_dwordx4 a[128:131], v128, s[52:55], s33 offen offset:0 sc1
    v_mfma_f32_16x16x32_bf16 v[176:179], v[232:235], a[80:83], v[176:179]
    ds_read_b64_tr_b16 v[224:225], v144 offset:49152
    ds_read_b64_tr_b16 v[226:227], v144 offset:51200
    v_mfma_f32_16x16x32_bf16 v[180:183], v[232:235], a[84:87], v[180:183]
    ds_read_b64_tr_b16 v[228:229], v145 offset:49152
    ds_read_b64_tr_b16 v[230:231], v145 offset:51200
    v_mfma_f32_16x16x32_bf16 v[184:187], v[236:239], a[80:83], v[184:187]
    buffer_load_dwordx4 a[132:135], v128, s[52:55], s33 offen offset:1024 sc1
    v_mfma_f32_16x16x32_bf16 v[188:191], v[236:239], a[84:87], v[188:191]
    s_waitcnt lgkmcnt(4) vmcnt(10)
    v_mfma_f32_16x16x32_bf16 v[160:163], v[240:243], a[88:91], v[160:163]
    ds_read_b64_tr_b16 v[232:233], v146 offset:49152
    ds_read_b64_tr_b16 v[234:235], v146 offset:51200
    v_mfma_f32_16x16x32_bf16 v[164:167], v[240:243], a[92:95], v[164:167]
    ds_read_b64_tr_b16 v[236:237], v147 offset:49152
    ds_read_b64_tr_b16 v[238:239], v147 offset:51200
    v_mfma_f32_16x16x32_bf16 v[168:171], v[244:247], a[88:91], v[168:171]
    buffer_load_dwordx4 a[136:139], v128, s[52:55], s33 offen offset:2048 sc1
    v_mfma_f32_16x16x32_bf16 v[172:175], v[244:247], a[92:95], v[172:175]
    v_mov_b32 v136, 0
    buffer_atomic_or v136, v132, s[52:55], s32 offen offset:256 sc0 sc1
    v_mfma_f32_16x16x32_bf16 v[176:179], v[248:251], a[88:91], v[176:179]
    ds_read_b64_tr_b16 v[240:241], v144 offset:53248
    ds_read_b64_tr_b16 v[242:243], v144 offset:55296
    v_mfma_f32_16x16x32_bf16 v[180:183], v[248:251], a[92:95], v[180:183]
    ds_read_b64_tr_b16 v[244:245], v145 offset:53248
    ds_read_b64_tr_b16 v[246:247], v145 offset:55296
    v_mfma_f32_16x16x32_bf16 v[184:187], v[252:255], a[88:91], v[184:187]
    buffer_load_dwordx4 a[140:143], v128, s[52:55], s33 offen offset:3072 sc1
    v_mfma_f32_16x16x32_bf16 v[188:191], v[252:255], a[92:95], v[188:191]
    s_waitcnt lgkmcnt(4) vmcnt(11)
    v_mfma_f32_16x16x32_bf16 v[160:163], v[224:227], a[96:99], v[160:163]
    ds_read_b64_tr_b16 v[248:249], v146 offset:53248
    ds_read_b64_tr_b16 v[250:251], v146 offset:55296
    v_mfma_f32_16x16x32_bf16 v[164:167], v[224:227], a[100:103], v[164:167]
    ds_read_b64_tr_b16 v[252:253], v147 offset:53248
    ds_read_b64_tr_b16 v[254:255], v147 offset:55296
    v_mfma_f32_16x16x32_bf16 v[168:171], v[228:231], a[96:99], v[168:171]
    s_add_u32 s33, s8, 0
    v_mfma_f32_16x16x32_bf16 v[172:175], v[228:231], a[100:103], v[172:175]
    buffer_load_dwordx4 a[144:147], v128, s[52:55], s33 offen offset:0 sc1
    v_mfma_f32_16x16x32_bf16 v[176:179], v[232:235], a[96:99], v[176:179]
    ds_read_b64_tr_b16 v[224:225], v144 offset:57344
    ds_read_b64_tr_b16 v[226:227], v144 offset:59392
    ds_read_b64_tr_b16 v[228:229], v145 offset:57344
    ds_read_b64_tr_b16 v[230:231], v145 offset:59392
    v_mfma_f32_16x16x32_bf16 v[180:183], v[232:235], a[100:103], v[180:183]
    ds_write_b128 v150, a[8:11] offset:32768
    v_mfma_f32_16x16x32_bf16 v[184:187], v[236:239], a[96:99], v[184:187]
    buffer_load_dwordx4 a[148:151], v128, s[52:55], s33 offen offset:1024 sc1
    v_mfma_f32_16x16x32_bf16 v[188:191], v[236:239], a[100:103], v[188:191]
    s_waitcnt lgkmcnt(5) vmcnt(11)
    v_mfma_f32_16x16x32_bf16 v[160:163], v[240:243], a[104:107], v[160:163]
    ds_read_b64_tr_b16 v[232:233], v146 offset:57344
    ds_read_b64_tr_b16 v[234:235], v146 offset:59392
    v_mfma_f32_16x16x32_bf16 v[164:167], v[240:243], a[108:111], v[164:167]
    ds_read_b64_tr_b16 v[236:237], v147 offset:57344
    ds_read_b64_tr_b16 v[238:239], v147 offset:59392
    v_mfma_f32_16x16x32_bf16 v[168:171], v[244:247], a[104:107], v[168:171]
    v_mfma_f32_16x16x32_bf16 v[172:175], v[244:247], a[108:111], v[172:175]
    buffer_load_dwordx4 a[152:155], v128, s[52:55], s33 offen offset:2048 sc1
    v_mfma_f32_16x16x32_bf16 v[176:179], v[248:251], a[104:107], v[176:179]
    ds_read_b64_tr_b16 v[240:241], v144 offset:61440
    ds_read_b64_tr_b16 v[242:243], v144 offset:63488
    v_mfma_f32_16x16x32_bf16 v[180:183], v[248:251], a[108:111], v[180:183]
    ds_read_b64_tr_b16 v[244:245], v145 offset:61440
    ds_read_b64_tr_b16 v[246:247], v145 offset:63488
    v_mfma_f32_16x16x32_bf16 v[184:187], v[252:255], a[104:107], v[184:187]
    buffer_load_dwordx4 a[156:159], v128, s[52:55], s33 offen offset:3072 sc1
    v_mfma_f32_16x16x32_bf16 v[188:191], v[252:255], a[108:111], v[188:191]
    s_waitcnt lgkmcnt(4) vmcnt(11)
    v_mfma_f32_16x16x32_bf16 v[160:163], v[224:227], a[112:115], v[160:163]
    ds_read_b64_tr_b16 v[248:249], v146 offset:61440
    ds_read_b64_tr_b16 v[250:251], v146 offset:63488
    v_mfma_f32_16x16x32_bf16 v[164:167], v[224:227], a[116:119], v[164:167]
    ds_read_b64_tr_b16 v[252:253], v147 offset:61440
    ds_read_b64_tr_b16 v[254:255], v147 offset:63488
    v_mfma_f32_16x16x32_bf16 v[168:171], v[228:231], a[112:115], v[168:171]
    s_add_u32 s33, s9, 0
    v_mfma_f32_16x16x32_bf16 v[172:175], v[228:231], a[116:119], v[172:175]
    buffer_load_dwordx4 a[160:163], v128, s[52:55], s33 offen offset:0 sc1
    v_mfma_f32_16x16x32_bf16 v[176:179], v[232:235], a[112:115], v[176:179]
    ds_read_b64_tr_b16 v[224:225], v192 offset:0
    ds_read_b64_tr_b16 v[226:227], v192 offset:2048
    v_mfma_f32_16x16x32_bf16 v[180:183], v[232:235], a[116:119], v[180:183]
    ds_read_b64_tr_b16 v[228:229], v193 offset:0
    ds_read_b64_tr_b16 v[230:231], v193 offset:2048
    v_mfma_f32_16x16x32_bf16 v[184:187], v[236:239], a[112:115], v[184:187]
    buffer_load_dwordx4 a[164:167], v128, s[52:55], s33 offen offset:1024 sc1
    v_mfma_f32_16x16x32_bf16 v[188:191], v[236:239], a[116:119], v[188:191]
    s_waitcnt lgkmcnt(4) vmcnt(11)
    v_mfma_f32_16x16x32_bf16 v[160:163], v[240:243], a[120:123], v[160:163]
    ds_read_b64_tr_b16 v[232:233], v194 offset:0
    ds_read_b64_tr_b16 v[234:235], v194 offset:2048
    v_mfma_f32_16x16x32_bf16 v[164:167], v[240:243], a[124:127], v[164:167]
    ds_read_b64_tr_b16 v[236:237], v195 offset:0
    ds_read_b64_tr_b16 v[238:239], v195 offset:2048
    v_mfma_f32_16x16x32_bf16 v[168:171], v[244:247], a[120:123], v[168:171]
    v_mfma_f32_16x16x32_bf16 v[172:175], v[244:247], a[124:127], v[172:175]
    buffer_load_dwordx4 a[168:171], v128, s[52:55], s33 offen offset:2048 sc1
    v_mfma_f32_16x16x32_bf16 v[176:179], v[248:251], a[120:123], v[176:179]
    ds_read_b64_tr_b16 v[240:241], v192 offset:4096
    ds_read_b64_tr_b16 v[242:243], v192 offset:6144
    ds_read_b64_tr_b16 v[244:245], v193 offset:4096
    ds_read_b64_tr_b16 v[246:247], v193 offset:6144
    v_mfma_f32_16x16x32_bf16 v[180:183], v[248:251], a[124:127], v[180:183]
    ds_write_b128 v150, a[12:15] offset:33792
    v_mfma_f32_16x16x32_bf16 v[184:187], v[252:255], a[120:123], v[184:187]
    buffer_load_dwordx4 a[172:175], v128, s[52:55], s33 offen offset:3072 sc1
    v_mfma_f32_16x16x32_bf16 v[188:191], v[252:255], a[124:127], v[188:191]
    s_waitcnt lgkmcnt(5) vmcnt(11)
    v_mfma_f32_16x16x32_bf16 v[160:163], v[224:227], a[128:131], v[160:163]
    ds_read_b64_tr_b16 v[248:249], v194 offset:4096
    ds_read_b64_tr_b16 v[250:251], v194 offset:6144
    ds_read_b64_tr_b16 v[252:253], v195 offset:4096
    ds_read_b64_tr_b16 v[254:255], v195 offset:6144
    v_mfma_f32_16x16x32_bf16 v[164:167], v[224:227], a[132:135], v[164:167]
    s_waitcnt vmcnt(9)
    v_cmp_ne_u32 vcc, v137, v136
    s_and_b32 vcc_lo, vcc_lo, 0xfff
    s_cbranch_scc1 L_spin3
L_back3:
    v_mfma_f32_16x16x32_bf16 v[168:171], v[228:231], a[128:131], v[168:171]
    s_add_u32 s33, s4, 24576
    v_mfma_f32_16x16x32_bf16 v[172:175], v[228:231], a[132:135], v[172:175]
    buffer_load_dwordx4 a[176:179], v128, s[52:55], s33 offen offset:0 sc1
    v_mfma_f32_16x16x32_bf16 v[176:179], v[232:235], a[128:131], v[176:179]
    ds_read_b64_tr_b16 v[224:225], v192 offset:8192
    ds_read_b64_tr_b16 v[226:227], v192 offset:10240
    v_mfma_f32_16x16x32_bf16 v[180:183], v[232:235], a[132:135], v[180:183]
    ds_read_b64_tr_b16 v[228:229], v193 offset:8192
    ds_read_b64_tr_b16 v[230:231], v193 offset:10240
    v_mfma_f32_16x16x32_bf16 v[184:187], v[236:239], a[128:131], v[184:187]
    buffer_load_dwordx4 a[180:183], v128, s[52:55], s33 offen offset:1024 sc1
    v_mfma_f32_16x16x32_bf16 v[188:191], v[236:239], a[132:135], v[188:191]
    s_waitcnt lgkmcnt(4) vmcnt(10)
    v_mfma_f32_16x16x32_bf16 v[160:163], v[240:243], a[136:139], v[160:163]
    ds_read_b64_tr_b16 v[232:233], v194 offset:8192
    ds_read_b64_tr_b16 v[234:235], v194 offset:10240
    ds_read_b64_tr_b16 v[236:237], v195 offset:8192
    ds_read_b64_tr_b16 v[238:239], v195 offset:10240
    v_mfma_f32_16x16x32_bf16 v[164:167], v[240:243], a[140:143], v[164:167]
    buffer_atomic_swap v137, v115, s[52:55], s101 offen offset:0 sc1
    v_mfma_f32_16x16x32_bf16 v[168:171], v[244:247], a[136:139], v[168:171]
    v_mfma_f32_16x16x32_bf16 v[172:175], v[244:247], a[140:143], v[172:175]
    buffer_load_dwordx4 a[184:187], v128, s[52:55], s33 offen offset:2048 sc1
    v_mfma_f32_16x16x32_bf16 v[176:179], v[248:251], a[136:139], v[176:179]
    ds_read_b64_tr_b16 v[240:241], v192 offset:12288
    ds_read_b64_tr_b16 v[242:243], v192 offset:14336
    v_mfma_f32_16x16x32_bf16 v[180:183], v[248:251], a[140:143], v[180:183]
    ds_read_b64_tr_b16 v[244:245], v193 offset:12288
    ds_read_b64_tr_b16 v[246:247], v193 offset:14336
    v_mfma_f32_16x16x32_bf16 v[184:187], v[252:255], a[136:139], v[184:187]
    buffer_load_dwordx4 a[188:191], v128, s[52:55], s33 offen offset:3072 sc1
    v_mfma_f32_16x16x32_bf16 v[188:191], v[252:255], a[140:143], v[188:191]
    s_waitcnt lgkmcnt(4) vmcnt(11)
    v_mfma_f32_16x16x32_bf16 v[160:163], v[224:227], a[144:147], v[160:163]
    ds_read_b64_tr_b16 v[248:249], v194 offset:12288
    ds_read_b64_tr_b16 v[250:251], v194 offset:14336
    v_mfma_f32_16x16x32_bf16 v[164:167], v[224:227], a[148:151], v[164:167]
    ds_read_b64_tr_b16 v[252:253], v195 offset:12288
    ds_read_b64_tr_b16 v[254:255], v195 offset:14336
    v_mfma_f32_16x16x32_bf16 v[168:171], v[228:231], a[144:147], v[168:171]
    s_add_u32 s33, s5, 24576
    v_mfma_f32_16x16x32_bf16 v[172:175], v[228:231], a[148:151], v[172:175]
    buffer_load_dwordx4 a[192:195], v128, s[52:55], s33 offen offset:0 sc1
    v_mfma_f32_16x16x32_bf16 v[176:179], v[232:235], a[144:147], v[176:179]
    ds_read_b64_tr_b16 v[224:225], v192 offset:16384
    ds_read_b64_tr_b16 v[226:227], v192 offset:18432
    v_mfma_f32_16x16x32_bf16 v[180:183], v[232:235], a[148:151], v[180:183]
    ds_read_b64_tr_b16 v[228:229], v193 offset:16384
    ds_read_b64_tr_b16 v[230:231], v193 offset:18432
    v_mfma_f32_16x16x32_bf16 v[184:187], v[236:239], a[144:147], v[184:187]
    buffer_load_dwordx4 a[196:199], v128, s[52:55], s33 offen offset:1024 sc1
    v_mfma_f32_16x16x32_bf16 v[188:191], v[236:239], a[148:151], v[188:191]
    s_waitcnt lgkmcnt(4) vmcnt(11)
    v_mfma_f32_16x16x32_bf16 v[160:163], v[240:243], a[152:155], v[160:163]
    ds_read_b64_tr_b16 v[232:233], v194 offset:16384
    ds_read_b64_tr_b16 v[234:235], v194 offset:18432
    v_mfma_f32_16x16x32_bf16 v[164:167], v[240:243], a[156:159], v[164:167]
    ds_read_b64_tr_b16 v[236:237], v195 offset:16384
    ds_read_b64_tr_b16 v[238:239], v195 offset:18432
    v_mfma_f32_16x16x32_bf16 v[168:171], v[244:247], a[152:155], v[168:171]
    buffer_load_dwordx4 a[200:203], v128, s[52:55], s33 offen offset:2048 sc1
    v_mfma_f32_16x16x32_bf16 v[172:175], v[244:247], a[156:159], v[172:175]
    ds_write_b32 v212, v214
    v_mfma_f32_16x16x32_bf16 v[176:179], v[248:251], a[152:155], v[176:179]
    ds_read_b64_tr_b16 v[240:241], v192 offset:20480
    ds_read_b64_tr_b16 v[242:243], v192 offset:22528
    v_mfma_f32_16x16x32_bf16 v[180:183], v[248:251], a[156:159], v[180:183]
    ds_read_b64_tr_b16 v[244:245], v193 offset:20480
    ds_read_b64_tr_b16 v[246:247], v193 offset:22528
    v_mfma_f32_16x16x32_bf16 v[184:187], v[252:255], a[152:155], v[184:187]
    buffer_load_dwordx4 a[204:207], v128, s[52:55], s33 offen offset:3072 sc1
    v_mfma_f32_16x16x32_bf16 v[188:191], v[252:255], a[156:159], v[188:191]
    s_waitcnt lgkmcnt(5) vmcnt(11)
    v_mfma_f32_16x16x32_bf16 v[160:163], v[224:227], a[160:163], v[160:163]
L_ptB3:
    s_cbranch_execz L_ptdB
    ds_read_b64_tr_b16 v[248:249], v194 offset:20480
    ds_read_b64_tr_b16 v[250:251], v194 offset:22528
    v_mfma_f32_16x16x32_bf16 v[164:167], v[224:227], a[164:167], v[164:167]
    ds_read_b64_tr_b16 v[252:253], v195 offset:20480
    ds_read_b64_tr_b16 v[254:255], v195 offset:22528
    v_mfma_f32_16x16x32_bf16 v[168:171], v[228:231], a[160:163], v[168:171]
    s_add_u32 s33, s6, 24576
    v_mfma_f32_16x16x32_bf16 v[172:175], v[228:231], a[164:167], v[172:175]
    buffer_load_dwordx4 a[208:211], v128, s[52:55], s33 offen offset:0 sc1
    v_mfma_f32_16x16x32_bf16 v[176:179], v[232:235], a[160:163], v[176:179]
    ds_read_b64_tr_b16 v[224:225], v192 offset:24576
    ds_read_b64_tr_b16 v[226:227], v192 offset:26624
    v_mfma_f32_16x16x32_bf16 v[180:183], v[232:235], a[164:167], v[180:183]
    ds_read_b64_tr_b16 v[228:229], v193 offset:24576
    ds_read_b64_tr_b16 v[230:231], v193 offset:26624
    v_mfma_f32_16x16x32_bf16 v[184:187], v[236:239], a[160:163], v[184:187]
    buffer_load_dwordx4 a[212:215], v128, s[52:55], s33 offen offset:1024 sc1
    v_mfma_f32_16x16x32_bf16 v[188:191], v[236:239], a[164:167], v[188:191]
    s_waitcnt lgkmcnt(4) vmcnt(11)
    v_mfma_f32_16x16x32_bf16 v[160:163], v[240:243], a[168:171], v[160:163]
    ds_read_b64_tr_b16 v[232:233], v194 offset:24576
    ds_read_b64_tr_b16 v[234:235], v194 offset:26624
    v_mfma_f32_16x16x32_bf16 v[164:167], v[240:243], a[172:175], v[164:167]
    ds_read_b64_tr_b16 v[236:237], v195 offset:24576
    ds_read_b64_tr_b16 v[238:239], v195 offset:26624
    v_mfma_f32_16x16x32_bf16 v[168:171], v[244:247], a[168:171], v[168:171]
    buffer_load_dwordx4 a[216:219], v128, s[52:55], s33 offen offset:2048 sc1
    v_mfma_f32_16x16x32_bf16 v[172:175], v[244:247], a[172:175], v[172:175]
    ds_read_b32 v60, v213
    v_mfma_f32_16x16x32_bf16 v[176:179], v[248:251], a[168:171], v[176:179]
    ds_read_b64_tr_b16 v[240:241], v192 offset:28672
    ds_read_b64_tr_b16 v[242:243], v192 offset:30720
    v_mfma_f32_16x16x32_bf16 v[180:183], v[248:251], a[172:175], v[180:183]
    ds_read_b64_tr_b16 v[244:245], v193 offset:28672
    ds_read_b64_tr_b16 v[246:247], v193 offset:30720
    v_mfma_f32_16x16x32_bf16 v[184:187], v[252:255], a[168:171], v[184:187]
    buffer_load_dwordx4 a[220:223], v128, s[52:55], s33 offen offset:3072 sc1
    v_mfma_f32_16x16x32_bf16 v[188:191], v[252:255], a[172:175], v[188:191]
    s_waitcnt lgkmcnt(5) vmcnt(11)
    v_mfma_f32_16x16x32_bf16 v[160:163], v[224:227], a[176:179], v[160:163]
    ds_read_b64_tr_b16 v[248:249], v194 offset:28672
    ds_read_b64_tr_b16 v[250:251], v194 offset:30720
    v_mfma_f32_16x16x32_bf16 v[164:167], v[224:227], a[180:183], v[164:167]
    ds_read_b64_tr_b16 v[252:253], v195 offset:28672
    ds_read_b64_tr_b16 v[254:255], v195 offset:30720
    v_mfma_f32_16x16x32_bf16 v[168:171], v[228:231], a[176:179], v[168:171]
    s_add_u32 s33, s7, 24576
    buffer_load_dwordx4 a[224:227], v128, s[52:55], s33 offen offset:0 sc1
    v_mfma_f32_16x16x32_bf16 v[172:175], v[228:231], a[180:183], v[172:175]
    s_waitcnt lgkmcnt(8)
    v_cmp_gt_u32 vcc, 1, v60
    s_cbranch_vccnz L_sy1
L_syb1:
    v_mfma_f32_16x16x32_bf16 v[176:179], v[232:235], a[176:179], v[176:179]
    ds_read_b64_tr_b16 v[224:225], v192 offset:32768
    ds_read_b64_tr_b16 v[226:227], v192 offset:34816
    ds_read_b64_tr_b16 v[228:229], v193 offset:32768
    ds_read_b64_tr_b16 v[230:231], v193 offset:34816
    v_mfma_f32_16x16x32_bf16 v[180:183], v[232:235], a[180:183], v[180:183]
    ds_write_b128 v150, a[16:19] offset:8192
    v_mfma_f32_16x16x32_bf16 v[184:187], v[236:239], a[176:179], v[184:187]
    buffer_load_dwordx4 a[228:231], v128, s[52:55], s33 offen offset:1024 sc1
    v_mfma_f32_16x16x32_bf16 v[188:191], v[236:239], a[180:183], v[188:191]
    s_waitcnt lgkmcnt(5) vmcnt(10)
    v_mfma_f32_16x16x32_bf16 v[160:163], v[240:243], a[184:187], v[160:163]
    ds_read_b64_tr_b16 v[232:233], v194 offset:32768
    ds_read_b64_tr_b16 v[234:235], v194 offset:34816
    ds_read_b64_tr_b16 v[236:237], v195 offset:32768
    ds_read_b64_tr_b16 v[238:239], v195 offset:34816
    v_mfma_f32_16x16x32_bf16 v[164:167], v[240:243], a[188:191], v[164:167]
    ds_write_b128 v150, a[20:23] offset:9216
    v_mfma_f32_16x16x32_bf16 v[168:171], v[244:247], a[184:187], v[168:171]
    buffer_load_dwordx4 a[232:235], v128, s[52:55], s33 offen offset:2048 sc1
    v_mfma_f32_16x16x32_bf16 v[172:175], v[244:247], a[188:191], v[172:175]
    v_mov_b32 v136, 0
    buffer_atomic_or v136, v132, s[52:55], s32 offen offset:512 sc0 sc1
    v_mfma_f32_16x16x32_bf16 v[176:179], v[248:251], a[184:187], v[176:179]
    ds_read_b64_tr_b16 v[240:241], v192 offset:36864
    ds_read_b64_tr_b16 v[242:243], v192 offset:38912
    ds_read_b64_tr_b16 v[244:245], v193 offset:36864
    ds_read_b64_tr_b16 v[246:247], v193 offset:38912
    v_mfma_f32_16x16x32_bf16 v[180:183], v[248:251], a[188:191], v[180:183]
    ds_write_b128 v150, a[24:27] offset:16384
    v_mfma_f32_16x16x32_bf16 v[184:187], v[252:255], a[184:187], v[184:187]
    buffer_load_dwordx4 a[236:239], v128, s[52:55], s33 offen offset:3072 sc1
    v_mfma_f32_16x16x32_bf16 v[188:191], v[252:255], a[188:191], v[188:191]
    s_waitcnt lgkmcnt(6) vmcnt(11)
    v_mfma_f32_16x16x32_bf16 v[160:163], v[224:227], a[192:195], v[160:163]
    ds_read_b64_tr_b16 v[248:249], v194 offset:36864
    ds_read_b64_tr_b16 v[250:251], v194 offset:38912
    ds_read_b64_tr_b16 v[252:253], v195 offset:36864
    ds_read_b64_tr_b16 v[254:255], v195 offset:38912
    v_mfma_f32_16x16x32_bf16 v[164:167], v[224:227], a[196:199], v[164:167]
    ds_write_b128 v150, a[28:31] offset:17408
    v_mfma_f32_16x16x32_bf16 v[168:171], v[228:231], a[192:195], v[168:171]
    s_add_u32 s33, s8, 24576
    v_mfma_f32_16x16x32_bf16 v[172:175], v[228:231], a[196:199], v[172:175]
    buffer_load_dwordx4 a[240:243], v128, s[52:55], s33 offen offset:0 sc1
    v_mfma_f32_16x16x32_bf16 v[176:179], v[232:235], a[192:195], v[176:179]
    ds_read_b64_tr_b16 v[224:225], v192 offset:40960
    ds_read_b64_tr_b16 v[226:227], v192 offset:43008
    v_mfma_f32_16x16x32_bf16 v[180:183], v[232:235], a[196:199], v[180:183]
    ds_read_b64_tr_b16 v[228:229], v193 offset:40960
    ds_read_b64_tr_b16 v[230:231], v193 offset:43008
    v_mfma_f32_16x16x32_bf16 v[184:187], v[236:239], a[192:195], v[184:187]
    buffer_load_dwordx4 a[244:247], v128, s[52:55], s33 offen offset:1024 sc1
    v_mfma_f32_16x16x32_bf16 v[188:191], v[236:239], a[196:199], v[188:191]
    s_waitcnt lgkmcnt(5) vmcnt(11)
    v_mfma_f32_16x16x32_bf16 v[160:163], v[240:243], a[200:203], v[160:163]
    ds_read_b64_tr_b16 v[232:233], v194 offset:40960
    ds_read_b64_tr_b16 v[234:235], v194 offset:43008
    ds_read_b64_tr_b16 v[236:237], v195 offset:40960
    ds_read_b64_tr_b16 v[238:239], v195 offset:43008
    v_mfma_f32_16x16x32_bf16 v[164:167], v[240:243], a[204:207], v[164:167]
    ds_write_b128 v150, a[32:35] offset:40960
    v_mfma_f32_16x16x32_bf16 v[168:171], v[244:247], a[200:203], v[168:171]
    v_mfma_f32_16x16x32_bf16 v[172:175], v[244:247], a[204:207], v[172:175]
    buffer_load_dwordx4 a[248:251], v128, s[52:55], s33 offen offset:2048 sc1
    v_mfma_f32_16x16x32_bf16 v[176:179], v[248:251], a[200:203], v[176:179]
    ds_read_b64_tr_b16 v[240:241], v192 offset:45056
    ds_read_b64_tr_b16 v[242:243], v192 offset:47104
    ds_read_b64_tr_b16 v[244:245], v193 offset:45056
    ds_read_b64_tr_b16 v[246:247], v193 offset:47104
    v_mfma_f32_16x16x32_bf16 v[180:183], v[248:251], a[204:207], v[180:183]
    ds_write_b128 v150, a[36:39] offset:41984
    v_mfma_f32_16x16x32_bf16 v[184:187], v[252:255], a[200:203], v[184:187]
    buffer_load_dwordx4 a[252:255], v128, s[52:55], s33 offen offset:3072 sc1
    v_mfma_f32_16x16x32_bf16 v[188:191], v[252:255], a[204:207], v[188:191]
    s_waitcnt lgkmcnt(6) vmcnt(11)
    v_mfma_f32_16x16x32_bf16 v[160:163], v[224:227], a[208:211], v[160:163]
    ds_read_b64_tr_b16 v[248:249], v194 offset:45056
    ds_read_b64_tr_b16 v[250:251], v194 offset:47104
    ds_read_b64_tr_b16 v[252:253], v195 offset:45056
    ds_read_b64_tr_b16 v[254:255], v195 offset:47104
    v_mfma_f32_16x16x32_bf16 v[164:167], v[224:227], a[212:215], v[164:167]
    ds_write_b128 v150, a[40:43] offset:49152
    v_mfma_f32_16x16x32_bf16 v[168:171], v[228:231], a[208:211], v[168:171]
    s_add_u32 s33, s9, 24576
    v_mfma_f32_16x16x32_bf16 v[172:175], v[228:231], a[212:215], v[172:175]
    buffer_load_dwordx4 a[80:83], v128, s[52:55], s33 offen offset:0 sc1
    v_mfma_f32_16x16x32_bf16 v[176:179], v[232:235], a[208:211], v[176:179]
    ds_read_b64_tr_b16 v[224:225], v192 offset:49152
    ds_read_b64_tr_b16 v[226:227], v192 offset:51200
    v_mfma_f32_16x16x32_bf16 v[180:183], v[232:235], a[212:215], v[180:183]
    ds_read_b64_tr_b16 v[228:229], v193 offset:49152
    ds_read_b64_tr_b16 v[230:231], v193 offset:51200
    v_mfma_f32_16x16x32_bf16 v[184:187], v[236:239], a[208:211], v[184:187]
    buffer_load_dwordx4 a[84:87], v128, s[52:55], s33 offen offset:1024 sc1
    v_mfma_f32_16x16x32_bf16 v[188:191], v[236:239], a[212:215], v[188:191]
    s_waitcnt lgkmcnt(5) vmcnt(11)
    v_mfma_f32_16x16x32_bf16 v[160:163], v[240:243], a[216:219], v[160:163]
    ds_read_b64_tr_b16 v[232:233], v194 offset:49152
    ds_read_b64_tr_b16 v[234:235], v194 offset:51200
    ds_read_b64_tr_b16 v[236:237], v195 offset:49152
    ds_read_b64_tr_b16 v[238:239], v195 offset:51200
    v_mfma_f32_16x16x32_bf16 v[164:167], v[240:243], a[220:223], v[164:167]
    ds_write_b128 v150, a[44:47] offset:50176
    v_mfma_f32_16x16x32_bf16 v[168:171], v[244:247], a[216:219], v[168:171]
    v_mfma_f32_16x16x32_bf16 v[172:175], v[244:247], a[220:223], v[172:175]
    buffer_load_dwordx4 a[88:91], v128, s[52:55], s33 offen offset:2048 sc1
    v_mfma_f32_16x16x32_bf16 v[176:179], v[248:251], a[216:219], v[176:179]
    ds_read_b64_tr_b16 v[240:241], v192 offset:53248
    ds_read_b64_tr_b16 v[242:243], v192 offset:55296
    ds_read_b64_tr_b16 v[244:245], v193 offset:53248
    ds_read_b64_tr_b16 v[246:247], v193 offset:55296
    v_mfma_f32_16x16x32_bf16 v[180:183], v[248:251], a[220:223], v[180:183]
    ds_write_b128 v150, a[48:51] offset:57344
    v_mfma_f32_16x16x32_bf16 v[184:187], v[252:255], a[216:219], v[184:187]
    buffer_load_dwordx4 a[92:95], v128, s[52:55], s33 offen offset:3072 sc1
    v_mfma_f32_16x16x32_bf16 v[188:191], v[252:255], a[220:223], v[188:191]
    s_waitcnt lgkmcnt(6) vmcnt(11)
    v_mfma_f32_16x16x32_bf16 v[160:163], v[224:227], a[224:227], v[160:163]
    ds_read_b64_tr_b16 v[248:249], v194 offset:53248
    ds_read_b64_tr_b16 v[250:251], v194 offset:55296
    ds_read_b64_tr_b16 v[252:253], v195 offset:53248
    ds_read_b64_tr_b16 v[254:255], v195 offset:55296
    s_waitcnt vmcnt(9)
    v_cmp_ne_u32 vcc, v137, v136
    s_and_b32 vcc_lo, vcc_lo, 0xfff
    s_cbranch_scc1 L_spin4
L_back4:
    v_mfma_f32_16x16x32_bf16 v[164:167], v[224:227], a[228:231], v[164:167]
    ds_write_b128 v150, a[52:55] offset:58368
    v_mfma_f32_16x16x32_bf16 v[168:171], v[228:231], a[224:227], v[168:171]
    s_add_u32 s33, s4, 49152
    v_mfma_f32_16x16x32_bf16 v[172:175], v[228:231], a[228:231], v[172:175]
    buffer_load_dwordx4 a[96:99], v128, s[52:55], s33 offen offset:0 sc1
    v_mfma_f32_16x16x32_bf16 v[176:179], v[232:235], a[224:227], v[176:179]
    ds_read_b64_tr_b16 v[224:225], v192 offset:57344
    ds_read_b64_tr_b16 v[226:227], v192 offset:59392
    ds_read_b64_tr_b16 v[228:229], v193 offset:57344
    ds_read_b64_tr_b16 v[230:231], v193 offset:59392
    v_mov_b32_e64 v139, 0
    buffer_atomic_or v139, v129, s[52:55], s36 offen offset:0 sc0 sc1
    v_mfma_f32_16x16x32_bf16 v[180:183], v[232:235], a[228:231], v[180:183]
    ds_write_b128 v151, a[56:59] offset:0
    v_mfma_f32_16x16x32_bf16 v[184:187], v[236:239], a[224:227], v[184:187]
    buffer_load_dwordx4 a[100:103], v128, s[52:55], s33 offen offset:1024 sc1
    v_mfma_f32_16x16x32_bf16 v[188:191], v[236:239], a[228:231], v[188:191]
    s_waitcnt lgkmcnt(6) vmcnt(11)
    v_mfma_f32_16x16x32_bf16 v[160:163], v[240:243], a[232:235], v[160:163]
    ds_read_b64_tr_b16 v[232:233], v194 offset:57344
    ds_read_b64_tr_b16 v[234:235], v194 offset:59392
    v_mfma_f32_16x16x32_bf16 v[164:167], v[240:243], a[236:239], v[164:167]
    ds_read_b64_tr_b16 v[236:237], v195 offset:57344
    ds_read_b64_tr_b16 v[238:239], v195 offset:59392
    v_mfma_f32_16x16x32_bf16 v[168:171], v[244:247], a[232:235], v[168:171]
    v_mfma_f32_16x16x32_bf16 v[172:175], v[244:247], a[236:239], v[172:175]
    buffer_load_dwordx4 a[104:107], v128, s[52:55], s33 offen offset:2048 sc1
    v_mfma_f32_16x16x32_bf16 v[176:179], v[248:251], a[232:235], v[176:179]
    ds_read_b64_tr_b16 v[240:241], v192 offset:61440
    ds_read_b64_tr_b16 v[242:243], v192 offset:63488
    ds_read_b64_tr_b16 v[244:245], v193 offset:61440
    ds_read_b64_tr_b16 v[246:247], v193 offset:63488
    v_mfma_f32_16x16x32_bf16 v[180:183], v[248:251], a[236:239], v[180:183]
    ds_write_b128 v151, a[60:63] offset:1024
    v_mfma_f32_16x16x32_bf16 v[184:187], v[252:255], a[232:235], v[184:187]
    buffer_load_dwordx4 a[108:111], v128, s[52:55], s33 offen offset:3072 sc1
    v_mfma_f32_16x16x32_bf16 v[188:191], v[252:255], a[236:239], v[188:191]
    s_waitcnt lgkmcnt(5) vmcnt(11)
    v_mfma_f32_16x16x32_bf16 v[160:163], v[224:227], a[240:243], v[160:163]
    ds_read_b64_tr_b16 v[248:249], v194 offset:61440
    ds_read_b64_tr_b16 v[250:251], v194 offset:63488
    ds_read_b64_tr_b16 v[252:253], v195 offset:61440
    ds_read_b64_tr_b16 v[254:255], v195 offset:63488
    v_mfma_f32_16x16x32_bf16 v[164:167], v[224:227], a[244:247], v[164:167]
    ds_write_b128 v151, a[64:67] offset:8192
    v_mfma_f32_16x16x32_bf16 v[168:171], v[228:231], a[240:243], v[168:171]
    s_add_u32 s33, s5, 49152
    v_mfma_f32_16x16x32_bf16 v[172:175], v[228:231], a[244:247], v[172:175]
    buffer_load_dwordx4 a[112:115], v128, s[52:55], s33 offen offset:0 sc1
    v_mfma_f32_16x16x32_bf16 v[176:179], v[232:235], a[240:243], v[176:179]
    ds_read_b64_tr_b16 v[224:225], v196 offset:0
    ds_read_b64_tr_b16 v[226:227], v196 offset:2048
    ds_read_b64_tr_b16 v[228:229], v197 offset:0
    ds_read_b64_tr_b16 v[230:231], v197 offset:2048
    v_mfma_f32_16x16x32_bf16 v[180:183], v[232:235], a[244:247], v[180:183]
    ds_write_b128 v151, a[68:71] offset:9216
    v_mfma_f32_16x16x32_bf16 v[184:187], v[236:239], a[240:243], v[184:187]
    buffer_load_dwordx4 a[116:119], v128, s[52:55], s33 offen offset:1024 sc1
    v_mfma_f32_16x16x32_bf16 v[188:191], v[236:239], a[244:247], v[188:191]
    ds_write_b32 v212, v215
    s_waitcnt lgkmcnt(7) vmcnt(11)
    v_mfma_f32_16x16x32_bf16 v[160:163], v[240:243], a[248:251], v[160:163]
    ds_read_b64_tr_b16 v[232:233], v198 offset:0
    ds_read_b64_tr_b16 v[234:235], v198 offset:2048
    v_mfma_f32_16x16x32_bf16 v[164:167], v[240:243], a[252:255], v[164:167]
    ds_read_b64_tr_b16 v[236:237], v199 offset:0
    ds_read_b64_tr_b16 v[238:239], v199 offset:2048
    v_mfma_f32_16x16x32_bf16 v[168:171], v[244:247], a[248:251], v[168:171]
    v_mfma_f32_16x16x32_bf16 v[172:175], v[244:247], a[252:255], v[172:175]
    buffer_load_dwordx4 a[120:123], v128, s[52:55], s33 offen offset:2048 sc1
    v_mfma_f32_16x16x32_bf16 v[176:179], v[248:251], a[248:251], v[176:179]
    ds_read_b64_tr_b16 v[240:241], v196 offset:4096
    ds_read_b64_tr_b16 v[242:243], v196 offset:6144
    v_mfma_f32_16x16x32_bf16 v[180:183], v[248:251], a[252:255], v[180:183]
    ds_read_b64_tr_b16 v[244:245], v197 offset:4096
    ds_read_b64_tr_b16 v[246:247], v197 offset:6144
    v_mfma_f32_16x16x32_bf16 v[184:187], v[252:255], a[248:251], v[184:187]
    buffer_load_dwordx4 a[124:127], v128, s[52:55], s33 offen offset:3072 sc1
    v_mfma_f32_16x16x32_bf16 v[188:191], v[252:255], a[252:255], v[188:191]
    s_waitcnt lgkmcnt(4) vmcnt(11)
    v_mfma_f32_16x16x32_bf16 v[160:163], v[224:227], a[80:83], v[160:163]
    ds_read_b64_tr_b16 v[248:249], v198 offset:4096
    ds_read_b64_tr_b16 v[250:251], v198 offset:6144
    v_mfma_f32_16x16x32_bf16 v[164:167], v[224:227], a[84:87], v[164:167]
    ds_read_b64_tr_b16 v[252:253], v199 offset:4096
    ds_read_b64_tr_b16 v[254:255], v199 offset:6144
    v_mfma_f32_16x16x32_bf16 v[168:171], v[228:231], a[80:83], v[168:171]
    s_add_u32 s33, s6, 49152
    v_mfma_f32_16x16x32_bf16 v[172:175], v[228:231], a[84:87], v[172:175]
    buffer_load_dwordx4 a[128:131], v128, s[52:55], s33 offen offset:0 sc1
    v_mfma_f32_16x16x32_bf16 v[176:179], v[232:235], a[80:83], v[176:179]
    ds_read_b64_tr_b16 v[224:225], v196 offset:8192
    ds_read_b64_tr_b16 v[226:227], v196 offset:10240
    v_mfma_f32_16x16x32_bf16 v[180:183], v[232:235], a[84:87], v[180:183]
    ds_read_b64_tr_b16 v[228:229], v197 offset:8192
    ds_read_b64_tr_b16 v[230:231], v197 offset:10240
    v_mfma_f32_16x16x32_bf16 v[184:187], v[236:239], a[80:83], v[184:187]
    buffer_load_dwordx4 a[132:135], v128, s[52:55], s33 offen offset:1024 sc1
    v_mfma_f32_16x16x32_bf16 v[188:191], v[236:239], a[84:87], v[188:191]
    s_waitcnt lgkmcnt(4) vmcnt(11)
    v_mfma_f32_16x16x32_bf16 v[160:163], v[240:243], a[88:91], v[160:163]
    ds_read_b64_tr_b16 v[232:233], v198 offset:8192
    ds_read_b64_tr_b16 v[234:235], v198 offset:10240
    v_mfma_f32_16x16x32_bf16 v[164:167], v[240:243], a[92:95], v[164:167]
    ds_read_b64_tr_b16 v[236:237], v199 offset:8192
    ds_read_b64_tr_b16 v[238:239], v199 offset:10240
    v_mfma_f32_16x16x32_bf16 v[168:171], v[244:247], a[88:91], v[168:171]
    v_mfma_f32_16x16x32_bf16 v[172:175], v[244:247], a[92:95], v[172:175]
    buffer_load_dwordx4 a[136:139], v128, s[52:55], s33 offen offset:2048 sc1
    v_mfma_f32_16x16x32_bf16 v[176:179], v[248:251], a[88:91], v[176:179]
    ds_read_b64_tr_b16 v[240:241], v196 offset:12288
    ds_read_b64_tr_b16 v[242:243], v196 offset:14336
    ds_read_b64_tr_b16 v[244:245], v197 offset:12288
    ds_read_b64_tr_b16 v[246:247], v197 offset:14336
    v_mfma_f32_16x16x32_bf16 v[180:183], v[248:251], a[92:95], v[180:183]
    s_waitcnt vmcnt(10)
    v_cmp_ne_u32 vcc, v137, v139
    s_and_b32 vcc_lo, vcc_lo, 0xffff
    s_cbranch_scc1 L_spin2
L_back2:
    v_mfma_f32_16x16x32_bf16 v[184:187], v[252:255], a[88:91], v[184:187]
    buffer_load_dwordx4 a[140:143], v128, s[52:55], s33 offen offset:3072 sc1
    v_mfma_f32_16x16x32_bf16 v[188:191], v[252:255], a[92:95], v[188:191]
    buffer_load_dword v40, v155, s[52:55], s61 offen offset:0 sc1
    s_waitcnt lgkmcnt(4) vmcnt(11)
    v_mfma_f32_16x16x32_bf16 v[160:163], v[224:227], a[96:99], v[160:163]
    ds_read_b64_tr_b16 v[248:249], v198 offset:12288
    ds_read_b64_tr_b16 v[250:251], v198 offset:14336
    v_mfma_f32_16x16x32_bf16 v[164:167], v[224:227], a[100:103], v[164:167]
    ds_read_b64_tr_b16 v[252:253], v199 offset:12288
    ds_read_b64_tr_b16 v[254:255], v199 offset:14336
    v_mfma_f32_16x16x32_bf16 v[168:171], v[228:231], a[96:99], v[168:171]
    s_add_u32 s33, s7, 49152
    buffer_load_dwordx4 a[144:147], v128, s[52:55], s33 offen offset:0 sc1
    v_mfma_f32_16x16x32_bf16 v[172:175], v[228:231], a[100:103], v[172:175]
    buffer_load_dword v41, v155, s[52:55], s61 offen offset:256 sc1
    v_mfma_f32_16x16x32_bf16 v[176:179], v[232:235], a[96:99], v[176:179]
    ds_read_b64_tr_b16 v[224:225], v196 offset:16384
    ds_read_b64_tr_b16 v[226:227], v196 offset:18432
    ds_read_b64_tr_b16 v[228:229], v197 offset:16384
    v_mfma_f32_16x16x32_bf16 v[180:183], v[232:235], a[100:103], v[180:183]
    ds_read_b64_tr_b16 v[230:231], v197 offset:18432
    buffer_load_dword v42, v155, s[52:55], s61 offen offset:512 sc1
    v_mfma_f32_16x16x32_bf16 v[184:187], v[236:239], a[96:99], v[184:187]
    buffer_load_dwordx4 a[148:151], v128, s[52:55], s33 offen offset:1024 sc1
    v_mfma_f32_16x16x32_bf16 v[188:191], v[236:239], a[100:103], v[188:191]
    s_waitcnt lgkmcnt(4) vmcnt(13)
    v_mfma_f32_16x16x32_bf16 v[160:163], v[240:243], a[104:107], v[160:163]
    ds_read_b64_tr_b16 v[232:233], v198 offset:16384
    ds_read_b64_tr_b16 v[234:235], v198 offset:18432
    ds_read_b64_tr_b16 v[236:237], v199 offset:16384
    ds_read_b64_tr_b16 v[238:239], v199 offset:18432
    v_mfma_f32_16x16x32_bf16 v[164:167], v[240:243], a[108:111], v[164:167]
    buffer_load_dwordx4 v[44:47], v154, s[52:55], s41 offen sc1
    s_add_u32 s41, s41, 65536
    v_mfma_f32_16x16x32_bf16 v[168:171], v[244:247], a[104:107], v[168:171]
    buffer_load_dwordx4 a[152:155], v128, s[52:55], s33 offen offset:2048 sc1
    v_mov_b32_e64 v136, 0
    buffer_atomic_or v136, v132, s[52:55], s32 offen offset:768 sc0 sc1
    v_mfma_f32_16x16x32_bf16 v[172:175], v[244:247], a[108:111], v[172:175]
    buffer_load_dwordx4 v[48:51], v154, s[52:55], s41 offen sc1
    s_add_u32 s41, s41, 65536
    v_mfma_f32_16x16x32_bf16 v[176:179], v[248:251], a[104:107], v[176:179]
    ds_read_b64_tr_b16 v[240:241], v196 offset:20480
    ds_read_b64_tr_b16 v[242:243], v196 offset:22528
    v_mfma_f32_16x16x32_bf16 v[180:183], v[248:251], a[108:111], v[180:183]
    ds_read_b64_tr_b16 v[244:245], v197 offset:20480
    ds_read_b64_tr_b16 v[246:247], v197 offset:22528
    v_mfma_f32_16x16x32_bf16 v[184:187], v[252:255], a[104:107], v[184:187]
    buffer_load_dwordx4 a[156:159], v128, s[52:55], s33 offen offset:3072 sc1
    v_mfma_f32_16x16x32_bf16 v[188:191], v[252:255], a[108:111], v[188:191]
    buffer_load_dwordx4 v[52:55], v154, s[52:55], s41 offen sc1
    s_add_u32 s41, s41, 65536
    s_waitcnt lgkmcnt(4) vmcnt(17)
    v_mfma_f32_16x16x32_bf16 v[160:163], v[224:227], a[112:115], v[160:163]
    ds_read_b64_tr_b16 v[248:249], v198 offset:20480
    ds_read_b64_tr_b16 v[250:251], v198 offset:22528
    ds_read_b64_tr_b16 v[252:253], v199 offset:20480
    ds_read_b64_tr_b16 v[254:255], v199 offset:22528
    v_mfma_f32_16x16x32_bf16 v[164:167], v[224:227], a[116:119], v[164:167]
    buffer_load_dwordx4 v[56:59], v154, s[52:55], s41 offen sc1
    s_add_u32 s41, s41, 65536
    v_mfma_f32_16x16x32_bf16 v[168:171], v[228:231], a[112:115], v[168:171]
    s_add_u32 s33, s8, 49152
    v_mfma_f32_16x16x32_bf16 v[172:175], v[228:231], a[116:119], v[172:175]
    buffer_load_dwordx4 a[160:163], v128, s[52:55], s33 offen offset:0 sc1
    v_mfma_f32_16x16x32_bf16 v[176:179], v[232:235], a[112:115], v[176:179]
    ds_read_b64_tr_b16 v[224:225], v196 offset:24576
    ds_read_b64_tr_b16 v[226:227], v196 offset:26624
    v_mfma_f32_16x16x32_bf16 v[180:183], v[232:235], a[116:119], v[180:183]
    ds_read_b64_tr_b16 v[228:229], v197 offset:24576
    ds_read_b64_tr_b16 v[230:231], v197 offset:26624
    v_mfma_f32_16x16x32_bf16 v[184:187], v[236:239], a[112:115], v[184:187]
    buffer_load_dwordx4 a[164:167], v128, s[52:55], s33 offen offset:1024 sc1
    v_mfma_f32_16x16x32_bf16 v[188:191], v[236:239], a[116:119], v[188:191]
    s_waitcnt lgkmcnt(4) vmcnt(18)
    v_mfma_f32_16x16x32_bf16 v[160:163], v[240:243], a[120:123], v[160:163]
    ds_read_b64_tr_b16 v[232:233], v198 offset:24576
    ds_read_b64_tr_b16 v[234:235], v198 offset:26624
    v_mfma_f32_16x16x32_bf16 v[164:167], v[240:243], a[124:127], v[164:167]
    ds_read_b64_tr_b16 v[236:237], v199 offset:24576
    ds_read_b64_tr_b16 v[238:239], v199 offset:26624
    v_mfma_f32_16x16x32_bf16 v[168:171], v[244:247], a[120:123], v[168:171]
    v_mfma_f32_16x16x32_bf16 v[172:175], v[244:247], a[124:127], v[172:175]
    buffer_load_dwordx4 a[168:171], v128, s[52:55], s33 offen offset:2048 sc1
    v_mfma_f32_16x16x32_bf16 v[176:179], v[248:251], a[120:123], v[176:179]
    ds_read_b64_tr_b16 v[240:241], v196 offset:28672
    ds_read_b64_tr_b16 v[242:243], v196 offset:30720
    v_mfma_f32_16x16x32_bf16 v[180:183], v[248:251], a[124:127], v[180:183]
    ds_read_b64_tr_b16 v[244:245], v197 offset:28672
    ds_read_b64_tr_b16 v[246:247], v197 offset:30720
    v_mfma_f32_16x16x32_bf16 v[184:187], v[252:255], a[120:123], v[184:187]
    buffer_load_dwordx4 a[172:175], v128, s[52:55], s33 offen offset:3072 sc1
    v_mfma_f32_16x16x32_bf16 v[188:191], v[252:255], a[124:127], v[188:191]
    s_waitcnt lgkmcnt(4) vmcnt(18)
    v_mfma_f32_16x16x32_bf16 v[160:163], v[224:227], a[128:131], v[160:163]
    ds_read_b64_tr_b16 v[248:249], v198 offset:28672
    ds_read_b64_tr_b16 v[250:251], v198 offset:30720
    v_mfma_f32_16x16x32_bf16 v[164:167], v[224:227], a[132:135], v[164:167]
    ds_read_b64_tr_b16 v[252:253], v199 offset:28672
    ds_read_b64_tr_b16 v[254:255], v199 offset:30720
    v_mfma_f32_16x16x32_bf16 v[168:171], v[228:231], a[128:131], v[168:171]
    s_add_u32 s33, s9, 49152
    v_mfma_f32_16x16x32_bf16 v[172:175], v[228:231], a[132:135], v[172:175]
    buffer_load_dwordx4 a[176:179], v128, s[52:55], s33 offen offset:0 sc1
    v_mfma_f32_16x16x32_bf16 v[176:179], v[232:235], a[128:131], v[176:179]
    ds_read_b64_tr_b16 v[224:225], v144 offset:24576
    ds_read_b64_tr_b16 v[226:227], v144 offset:26624
    v_mfma_f32_16x16x32_bf16 v[180:183], v[232:235], a[132:135], v[180:183]
    ds_read_b64_tr_b16 v[228:229], v145 offset:24576
    ds_read_b64_tr_b16 v[230:231], v145 offset:26624
    v_mfma_f32_16x16x32_bf16 v[184:187], v[236:239], a[128:131], v[184:187]
    buffer_load_dwordx4 a[180:183], v128, s[52:55], s33 offen offset:1024 sc1
    v_mfma_f32_16x16x32_bf16 v[188:191], v[236:239], a[132:135], v[188:191]
    s_waitcnt lgkmcnt(4) vmcnt(18)
    v_mfma_f32_16x16x32_bf16 v[160:163], v[240:243], a[136:139], v[160:163]
    ds_read_b64_tr_b16 v[232:233], v146 offset:24576
    ds_read_b64_tr_b16 v[234:235], v146 offset:26624
    v_mfma_f32_16x16x32_bf16 v[164:167], v[240:243], a[140:143], v[164:167]
    ds_read_b64_tr_b16 v[236:237], v147 offset:24576
    ds_read_b64_tr_b16 v[238:239], v147 offset:26624
    v_mfma_f32_16x16x32_bf16 v[168:171], v[244:247], a[136:139], v[168:171]
    v_mfma_f32_16x16x32_bf16 v[172:175], v[244:247], a[140:143], v[172:175]
    buffer_load_dwordx4 a[184:187], v128, s[52:55], s33 offen offset:2048 sc1
    v_mfma_f32_16x16x32_bf16 v[176:179], v[248:251], a[136:139], v[176:179]
    ds_read_b64_tr_b16 v[240:241], v144 offset:28672
    ds_read_b64_tr_b16 v[242:243], v144 offset:30720
    v_mfma_f32_16x16x32_bf16 v[180:183], v[248:251], a[140:143], v[180:183]
    ds_read_b64_tr_b16 v[244:245], v145 offset:28672
    ds_read_b64_tr_b16 v[246:247], v145 offset:30720
    v_mfma_f32_16x16x32_bf16 v[184:187], v[252:255], a[136:139], v[184:187]
    buffer_load_dwordx4 a[188:191], v128, s[52:55], s33 offen offset:3072 sc1
    v_mfma_f32_16x16x32_bf16 v[188:191], v[252:255], a[140:143], v[188:191]
    s_waitcnt lgkmcnt(4) vmcnt(15)
    v_mfma_f32_16x16x32_bf16 v[160:163], v[224:227], a[144:147], v[160:163]
    ds_read_b64_tr_b16 v[248:249], v146 offset:28672
    ds_read_b64_tr_b16 v[250:251], v146 offset:30720
    ds_read_b64_tr_b16 v[252:253], v147 offset:28672
    ds_read_b64_tr_b16 v[254:255], v147 offset:30720
    v_mfma_f32_16x16x32_bf16 v[164:167], v[224:227], a[148:151], v[164:167]
    s_waitcnt vmcnt(12)
    v_cmp_ne_u32 vcc, v137, v136
    s_and_b32 vcc_lo, vcc_lo, 0xfff
    s_cbranch_scc1 L_spin5
L_back5:
    v_mfma_f32_16x16x32_bf16 v[168:171], v[228:231], a[144:147], v[168:171]
    s_add_u32 s33, s4, 73728
    v_mfma_f32_16x16x32_bf16 v[172:175], v[228:231], a[148:151], v[172:175]
    buffer_load_dwordx4 a[192:195], v128, s[52:55], s33 offen offset:0 sc1
    v_mfma_f32_16x16x32_bf16 v[176:179], v[232:235], a[144:147], v[176:179]
    ds_read_b64_tr_b16 v[224:225], v144 offset:32768
    ds_read_b64_tr_b16 v[226:227], v144 offset:34816
    v_mfma_f32_16x16x32_bf16 v[180:183], v[232:235], a[148:151], v[180:183]
    ds_read_b64_tr_b16 v[228:229], v145 offset:32768
    ds_read_b64_tr_b16 v[230:231], v145 offset:34816
    v_add_f32_e64 v40, v40, v41
    v_mfma_f32_16x16x32_bf16 v[184:187], v[236:239], a[144:147], v[184:187]
    buffer_load_dwordx4 a[196:199], v128, s[52:55], s33 offen offset:1024 sc1
    v_mfma_f32_16x16x32_bf16 v[188:191], v[236:239], a[148:151], v[188:191]
    v_add_f32_e64 v41, v40, v42
    v_add_f32 v40, v40, v42
    s_waitcnt lgkmcnt(4) vmcnt(12)
    v_mfma_f32_16x16x32_bf16 v[160:163], v[240:243], a[152:155], v[160:163]
    ds_read_b64_tr_b16 v[232:233], v146 offset:32768
    ds_read_b64_tr_b16 v[234:235], v146 offset:34816
    ds_read_b64_tr_b16 v[236:237], v147 offset:32768
    v_mfma_f32_16x16x32_bf16 v[164:167], v[240:243], a[156:159], v[164:167]
    ds_read_b64_tr_b16 v[238:239], v147 offset:34816
    s_nop 1
    v_permlane32_swap_b32 v40, v41
    v_mfma_f32_16x16x32_bf16 v[168:171], v[244:247], a[152:155], v[168:171]
    buffer_load_dwordx4 a[200:203], v128, s[52:55], s33 offen offset:2048 sc1
    v_mfma_f32_16x16x32_bf16 v[172:175], v[244:247], a[156:159], v[172:175]
    v_add_f32_e64 v40, v40, v41
    v_mul_f32 v40, 0xbfb8aa3b, v40
    v_mfma_f32_16x16x32_bf16 v[176:179], v[248:251], a[152:155], v[176:179]
    ds_read_b64_tr_b16 v[240:241], v144 offset:36864
    ds_read_b64_tr_b16 v[242:243], v144 offset:38912
    ds_read_b64_tr_b16 v[244:245], v145 offset:36864
    ds_read_b64_tr_b16 v[246:247], v145 offset:38912
    v_mfma_f32_16x16x32_bf16 v[180:183], v[248:251], a[156:159], v[180:183]
    v_exp_f32 v40, v40
    s_nop 0
    ds_read_b32 v60, v213
    v_mfma_f32_16x16x32_bf16 v[184:187], v[252:255], a[152:155], v[184:187]
    buffer_load_dwordx4 a[204:207], v128, s[52:55], s33 offen offset:3072 sc1
    v_mfma_f32_16x16x32_bf16 v[188:191], v[252:255], a[156:159], v[188:191]
    v_add_f32 v40, 1.0, v40
    s_waitcnt lgkmcnt(5) vmcnt(10)
    v_mfma_f32_16x16x32_bf16 v[160:163], v[224:227], a[160:163], v[160:163]
    ds_read_b64_tr_b16 v[248:249], v146 offset:36864
    ds_read_b64_tr_b16 v[250:251], v146 offset:38912
    ds_read_b64_tr_b16 v[252:253], v147 offset:36864
    v_mfma_f32_16x16x32_bf16 v[164:167], v[224:227], a[164:167], v[164:167]
    ds_read_b64_tr_b16 v[254:255], v147 offset:38912
    v_rcp_f32 v156, v40
    s_nop 0
    v_mfma_f32_16x16x32_bf16 v[168:171], v[228:231], a[160:163], v[168:171]
    s_add_u32 s33, s5, 73728
    v_mfma_f32_16x16x32_bf16 v[172:175], v[228:231], a[164:167], v[172:175]
    buffer_load_dwordx4 a[208:211], v128, s[52:55], s33 offen offset:0 sc1
    v_mov_b32_e64 v158, v156
    v_mfma_f32_16x16x32_bf16 v[176:179], v[232:235], a[160:163], v[176:179]
    s_waitcnt lgkmcnt(4)
    v_cmp_gt_u32 vcc, 2, v60
    s_cbranch_vccnz L_sy2
L_syb2:
    ds_read_b64_tr_b16 v[224:225], v144 offset:8192
    ds_read_b64_tr_b16 v[226:227], v144 offset:10240
    v_mfma_f32_16x16x32_bf16 v[180:183], v[232:235], a[164:167], v[180:183]
    ds_read_b64_tr_b16 v[228:229], v145 offset:8192
    ds_read_b64_tr_b16 v[230:231], v145 offset:10240
    s_nop 1
    v_permlane16_swap_b32 v156, v158
    v_sub_f32 v157, 1.0, v156
    v_mfma_f32_16x16x32_bf16 v[184:187], v[236:239], a[160:163], v[184:187]
    buffer_load_dwordx4 a[212:215], v128, s[52:55], s33 offen offset:1024 sc1
    v_mfma_f32_16x16x32_bf16 v[188:191], v[236:239], a[164:167], v[188:191]
    v_sub_f32 v159, 1.0, v158
    s_waitcnt lgkmcnt(4) vmcnt(10)
    v_mfma_f32_16x16x32_bf16 v[160:163], v[240:243], a[168:171], v[160:163]
    ds_read_b64_tr_b16 v[232:233], v146 offset:8192
    ds_read_b64_tr_b16 v[234:235], v146 offset:10240
    v_mfma_f32_16x16x32_bf16 v[164:167], v[240:243], a[172:175], v[164:167]
    ds_read_b64_tr_b16 v[236:237], v147 offset:8192
    ds_read_b64_tr_b16 v[238:239], v147 offset:10240
    v_mfma_f32_16x16x32_bf16 v[168:171], v[244:247], a[168:171], v[168:171]
    buffer_load_dwordx4 a[216:219], v128, s[52:55], s33 offen offset:2048 sc1
    v_mfma_f32_16x16x32_bf16 v[172:175], v[244:247], a[172:175], v[172:175]
    v_lshlrev_b32_e64 v8, 16, v44
    v_and_b32 v9, 0xffff0000, v44
    v_mfma_f32_16x16x32_bf16 v[176:179], v[248:251], a[168:171], v[176:179]
    ds_read_b64_tr_b16 v[240:241], v144 offset:12288
    ds_read_b64_tr_b16 v[242:243], v144 offset:14336
    v_mfma_f32_16x16x32_bf16 v[180:183], v[248:251], a[172:175], v[180:183]
    ds_read_b64_tr_b16 v[244:245], v145 offset:12288
    ds_read_b64_tr_b16 v[246:247], v145 offset:14336
    v_mul_f32_e64 v8, v8, v156
    v_mfma_f32_16x16x32_bf16 v[184:187], v[252:255], a[168:171], v[184:187]
    buffer_load_dwordx4 a[220:223], v128, s[52:55], s33 offen offset:3072 sc1
L_ptB4:
    s_cbranch_execz L_ptdB
    v_mfma_f32_16x16x32_bf16 v[188:191], v[252:255], a[172:175], v[188:191]
    v_mul_f32_e64 v9, v9, v156
    s_waitcnt lgkmcnt(4) vmcnt(10)
    v_mfma_f32_16x16x32_bf16 v[160:163], v[224:227], a[176:179], v[160:163]
    ds_read_b64_tr_b16 v[248:249], v146 offset:12288
    ds_read_b64_tr_b16 v[250:251], v146 offset:14336
    v_mfma_f32_16x16x32_bf16 v[164:167], v[224:227], a[180:183], v[164:167]
    ds_read_b64_tr_b16 v[252:253], v147 offset:12288
    ds_read_b64_tr_b16 v[254:255], v147 offset:14336
    v_lshlrev_b32_e64 v10, 16, v45
    v_mfma_f32_16x16x32_bf16 v[168:171], v[228:231], a[176:179], v[168:171]
    s_add_u32 s33, s6, 73728
    buffer_load_dwordx4 a[224:227], v128, s[52:55], s33 offen offset:0 sc1
    v_mfma_f32_16x16x32_bf16 v[172:175], v[228:231], a[180:183], v[172:175]
    v_and_b32 v11, 0xffff0000, v45
    v_mfma_f32_16x16x32_bf16 v[176:179], v[232:235], a[176:179], v[176:179]
    ds_read_b64_tr_b16 v[224:225], v144 offset:16384
    ds_read_b64_tr_b16 v[226:227], v144 offset:18432
    v_mfma_f32_16x16x32_bf16 v[180:183], v[232:235], a[180:183], v[180:183]
    ds_read_b64_tr_b16 v[228:229], v145 offset:16384
    ds_read_b64_tr_b16 v[230:231], v145 offset:18432
    v_mul_f32_e64 v10, v10, v156
    v_mfma_f32_16x16x32_bf16 v[184:187], v[236:239], a[176:179], v[184:187]
    buffer_load_dwordx4 a[228:231], v128, s[52:55], s33 offen offset:1024 sc1
    v_mfma_f32_16x16x32_bf16 v[188:191], v[236:239], a[180:183], v[188:191]
    v_mul_f32_e64 v11, v11, v156
    v_lshlrev_b32 v12, 16, v46
    s_waitcnt lgkmcnt(4) vmcnt(10)
    v_mfma_f32_16x16x32_bf16 v[160:163], v[240:243], a[184:187], v[160:163]
    ds_read_b64_tr_b16 v[232:233], v146 offset:16384
    ds_read_b64_tr_b16 v[234:235], v146 offset:18432
    ds_read_b64_tr_b16 v[236:237], v147 offset:16384
    v_mfma_f32_16x16x32_bf16 v[164:167], v[240:243], a[188:191], v[164:167]
    ds_read_b64_tr_b16 v[238:239], v147 offset:18432
    v_and_b32 v13, 0xffff0000, v46
    v_mfma_f32_16x16x32_bf16 v[168:171], v[244:247], a[184:187], v[168:171]
    buffer_load_dwordx4 a[232:235], v128, s[52:55], s33 offen offset:2048 sc1
    v_mfma_f32_16x16x32_bf16 v[172:175], v[244:247], a[188:191], v[172:175]
    v_mul_f32 v12, v12, v158
    v_mul_f32 v13, v13, v158
    v_mfma_f32_16x16x32_bf16 v[176:179], v[248:251], a[184:187], v[176:179]
    ds_read_b64_tr_b16 v[240:241], v144 offset:20480
    ds_read_b64_tr_b16 v[242:243], v144 offset:22528
    v_mfma_f32_16x16x32_bf16 v[180:183], v[248:251], a[188:191], v[180:183]
    ds_read_b64_tr_b16 v[244:245], v145 offset:20480
    ds_read_b64_tr_b16 v[246:247], v145 offset:22528
    v_mfma_f32_16x16x32_bf16 v[184:187], v[252:255], a[184:187], v[184:187]
    buffer_load_dwordx4 a[236:239], v128, s[52:55], s33 offen offset:3072 sc1
    v_mfma_f32_16x16x32_bf16 v[188:191], v[252:255], a[188:191], v[188:191]
    v_lshlrev_b32_e64 v14, 16, v47
    v_and_b32 v15, 0xffff0000, v47
    s_waitcnt lgkmcnt(4) vmcnt(10)
    v_mfma_f32_16x16x32_bf16 v[160:163], v[224:227], a[192:195], v[160:163]
    ds_read_b64_tr_b16 v[248:249], v146 offset:20480
    ds_read_b64_tr_b16 v[250:251], v146 offset:22528
    v_mfma_f32_16x16x32_bf16 v[164:167], v[224:227], a[196:199], v[164:167]
    ds_read_b64_tr_b16 v[252:253], v147 offset:20480
    ds_read_b64_tr_b16 v[254:255], v147 offset:22528
    v_mul_f32 v14, v14, v158
    v_mfma_f32_16x16x32_bf16 v[168:171], v[228:231], a[192:195], v[168:171]
    s_add_u32 s33, s7, 73728
    v_mfma_f32_16x16x32_bf16 v[172:175], v[228:231], a[196:199], v[172:175]
    buffer_load_dwordx4 a[240:243], v128, s[52:55], s33 offen offset:0 sc1
    v_mul_f32_e64 v15, v15, v158
    v_mfma_f32_16x16x32_bf16 v[176:179], v[232:235], a[192:195], v[176:179]
    ds_read_b64_tr_b16 v[224:225], v144 offset:40960
    ds_read_b64_tr_b16 v[226:227], v144 offset:43008
    v_mfma_f32_16x16x32_bf16 v[180:183], v[232:235], a[196:199], v[180:183]
    ds_read_b64_tr_b16 v[228:229], v145 offset:40960
    ds_read_b64_tr_b16 v[230:231], v145 offset:43008
    v_mfma_f32_16x16x32_bf16 v[184:187], v[236:239], a[192:195], v[184:187]
    buffer_load_dwordx4 a[244:247], v128, s[52:55], s33 offen offset:1024 sc1
    v_mfma_f32_16x16x32_bf16 v[188:191], v[236:239], a[196:199], v[188:191]
    v_lshlrev_b32_e64 v16, 16, v48
    v_and_b32 v17, 0xffff0000, v48
    s_waitcnt lgkmcnt(4) vmcnt(10)
    v_mfma_f32_16x16x32_bf16 v[160:163], v[240:243], a[200:203], v[160:163]
    ds_read_b64_tr_b16 v[232:233], v146 offset:40960
    ds_read_b64_tr_b16 v[234:235], v146 offset:43008
    v_mfma_f32_16x16x32_bf16 v[164:167], v[240:243], a[204:207], v[164:167]
    ds_read_b64_tr_b16 v[236:237], v147 offset:40960
    ds_read_b64_tr_b16 v[238:239], v147 offset:43008
    v_mul_f32 v16, v16, v156
    v_mfma_f32_16x16x32_bf16 v[168:171], v[244:247], a[200:203], v[168:171]
    buffer_load_dwordx4 a[248:251], v128, s[52:55], s33 offen offset:2048 sc1
    v_mfma_f32_16x16x32_bf16 v[172:175], v[244:247], a[204:207], v[172:175]
    v_mul_f32 v17, v17, v156
    v_lshlrev_b32 v18, 16, v49
    v_mfma_f32_16x16x32_bf16 v[176:179], v[248:251], a[200:203], v[176:179]
    ds_read_b64_tr_b16 v[240:241], v144 offset:45056
    ds_read_b64_tr_b16 v[242:243], v144 offset:47104
    v_mfma_f32_16x16x32_bf16 v[180:183], v[248:251], a[204:207], v[180:183]
    ds_read_b64_tr_b16 v[244:245], v145 offset:45056
    ds_read_b64_tr_b16 v[246:247], v145 offset:47104
    v_mfma_f32_16x16x32_bf16 v[184:187], v[252:255], a[200:203], v[184:187]
    buffer_load_dwordx4 a[252:255], v128, s[52:55], s33 offen offset:3072 sc1
    v_mfma_f32_16x16x32_bf16 v[188:191], v[252:255], a[204:207], v[188:191]
    v_and_b32 v19, 0xffff0000, v49
    s_waitcnt lgkmcnt(4) vmcnt(10)
    v_mfma_f32_16x16x32_bf16 v[160:163], v[224:227], a[208:211], v[160:163]
    ds_read_b64_tr_b16 v[248:249], v146 offset:45056
    ds_read_b64_tr_b16 v[250:251], v146 offset:47104
    ds_read_b64_tr_b16 v[252:253], v147 offset:45056
    v_mfma_f32_16x16x32_bf16 v[164:167], v[224:227], a[212:215], v[164:167]
    ds_read_b64_tr_b16 v[254:255], v147 offset:47104
    v_mul_f32 v18, v18, v156
    v_mul_f32_e64 v19, v19, v156
    v_mfma_f32_16x16x32_bf16 v[168:171], v[228:231], a[208:211], v[168:171]
    s_add_u32 s33, s8, 73728
    v_mfma_f32_16x16x32_bf16 v[172:175], v[228:231], a[212:215], v[172:175]
    buffer_load_dwordx4 a[80:83], v128, s[52:55], s33 offen offset:0 sc1
    v_lshlrev_b32_e64 v20, 16, v50
    v_mfma_f32_16x16x32_bf16 v[176:179], v[232:235], a[208:211], v[176:179]
    ds_read_b64_tr_b16 v[224:225], v144 offset:49152
    ds_read_b64_tr_b16 v[226:227], v144 offset:51200
    ds_read_b64_tr_b16 v[228:229], v145 offset:49152
    v_mfma_f32_16x16x32_bf16 v[180:183], v[232:235], a[212:215], v[180:183]
    ds_read_b64_tr_b16 v[230:231], v145 offset:51200
    v_and_b32 v21, 0xffff0000, v50
    v_mfma_f32_16x16x32_bf16 v[184:187], v[236:239], a[208:211], v[184:187]
    buffer_load_dwordx4 a[84:87], v128, s[52:55], s33 offen offset:1024 sc1
    v_mfma_f32_16x16x32_bf16 v[188:191], v[236:239], a[212:215], v[188:191]
    v_mul_f32 v20, v20, v158
    s_waitcnt lgkmcnt(4) vmcnt(10)
    v_mfma_f32_16x16x32_bf16 v[160:163], v[240:243], a[216:219], v[160:163]
    ds_read_b64_tr_b16 v[232:233], v146 offset:49152
    ds_read_b64_tr_b16 v[234:235], v146 offset:51200
    ds_read_b64_tr_b16 v[236:237], v147 offset:49152
    v_mfma_f32_16x16x32_bf16 v[164:167], v[240:243], a[220:223], v[164:167]
    ds_read_b64_tr_b16 v[238:239], v147 offset:51200
    v_mul_f32 v21, v21, v158
    v_lshlrev_b32 v22, 16, v51
    v_mfma_f32_16x16x32_bf16 v[168:171], v[244:247], a[216:219], v[168:171]
    buffer_load_dwordx4 a[88:91], v128, s[52:55], s33 offen offset:2048 sc1
    v_mfma_f32_16x16x32_bf16 v[172:175], v[244:247], a[220:223], v[172:175]
    v_and_b32 v23, 0xffff0000, v51
    v_mul_f32_e64 v22, v22, v158
    v_mfma_f32_16x16x32_bf16 v[176:179], v[248:251], a[216:219], v[176:179]
    ds_read_b64_tr_b16 v[240:241], v144 offset:53248
    ds_read_b64_tr_b16 v[242:243], v144 offset:55296
    v_mfma_f32_16x16x32_bf16 v[180:183], v[248:251], a[220:223], v[180:183]
    ds_read_b64_tr_b16 v[244:245], v145 offset:53248
    ds_read_b64_tr_b16 v[246:247], v145 offset:55296
    v_mfma_f32_16x16x32_bf16 v[184:187], v[252:255], a[216:219], v[184:187]
    buffer_load_dwordx4 a[92:95], v128, s[52:55], s33 offen offset:3072 sc1
    v_mfma_f32_16x16x32_bf16 v[188:191], v[252:255], a[220:223], v[188:191]
    v_mul_f32 v23, v23, v158
    s_waitcnt lgkmcnt(4) vmcnt(10)
    v_mfma_f32_16x16x32_bf16 v[160:163], v[224:227], a[224:227], v[160:163]
    ds_read_b64_tr_b16 v[248:249], v146 offset:53248
    ds_read_b64_tr_b16 v[250:251], v146 offset:55296
    ds_read_b64_tr_b16 v[252:253], v147 offset:53248
    v_mfma_f32_16x16x32_bf16 v[164:167], v[224:227], a[228:231], v[164:167]
    ds_read_b64_tr_b16 v[254:255], v147 offset:55296
    v_lshlrev_b32_e64 v24, 16, v52
    v_mfma_f32_16x16x32_bf16 v[168:171], v[228:231], a[224:227], v[168:171]
    s_add_u32 s33, s9, 73728
    buffer_load_dwordx4 a[96:99], v128, s[52:55], s33 offen offset:0 sc1
    v_mfma_f32_16x16x32_bf16 v[172:175], v[228:231], a[228:231], v[172:175]
    v_and_b32 v25, 0xffff0000, v52
    v_mfma_f32_16x16x32_bf16 v[176:179], v[232:235], a[224:227], v[176:179]
    ds_read_b64_tr_b16 v[224:225], v144 offset:57344
    ds_read_b64_tr_b16 v[226:227], v144 offset:59392
    v_mfma_f32_16x16x32_bf16 v[180:183], v[232:235], a[228:231], v[180:183]
    ds_read_b64_tr_b16 v[228:229], v145 offset:57344
    ds_read_b64_tr_b16 v[230:231], v145 offset:59392
    v_mul_f32_e64 v24, v24, v156
    v_mfma_f32_16x16x32_bf16 v[184:187], v[236:239], a[224:227], v[184:187]
    buffer_load_dwordx4 a[100:103], v128, s[52:55], s33 offen offset:1024 sc1
    v_mfma_f32_16x16x32_bf16 v[188:191], v[236:239], a[228:231], v[188:191]
    v_mul_f32 v25, v25, v156
    s_waitcnt lgkmcnt(4) vmcnt(10)
    v_mfma_f32_16x16x32_bf16 v[160:163], v[240:243], a[232:235], v[160:163]
    ds_read_b64_tr_b16 v[232:233], v146 offset:57344
    ds_read_b64_tr_b16 v[234:235], v146 offset:59392
    v_mfma_f32_16x16x32_bf16 v[164:167], v[240:243], a[236:239], v[164:167]
    ds_read_b64_tr_b16 v[236:237], v147 offset:57344
    ds_read_b64_tr_b16 v[238:239], v147 offset:59392
    v_lshlrev_b32_e64 v26, 16, v53
    v_mfma_f32_16x16x32_bf16 v[168:171], v[244:247], a[232:235], v[168:171]
    buffer_load_dwordx4 a[104:107], v128, s[52:55], s33 offen offset:2048 sc1
    v_mfma_f32_16x16x32_bf16 v[172:175], v[244:247], a[236:239], v[172:175]
    v_and_b32 v27, 0xffff0000, v53
    v_mul_f32_e64 v26, v26, v156
    v_mfma_f32_16x16x32_bf16 v[176:179], v[248:251], a[232:235], v[176:179]
    ds_read_b64_tr_b16 v[240:241], v144 offset:61440
    ds_read_b64_tr_b16 v[242:243], v144 offset:63488
    v_mfma_f32_16x16x32_bf16 v[180:183], v[248:251], a[236:239], v[180:183]
    ds_read_b64_tr_b16 v[244:245], v145 offset:61440
    ds_read_b64_tr_b16 v[246:247], v145 offset:63488
    v_mul_f32_e64 v27, v27, v156
    v_mfma_f32_16x16x32_bf16 v[184:187], v[252:255], a[232:235], v[184:187]
    buffer_load_dwordx4 a[108:111], v128, s[52:55], s33 offen offset:3072 sc1
    v_mfma_f32_16x16x32_bf16 v[188:191], v[252:255], a[236:239], v[188:191]
    v_lshlrev_b32 v28, 16, v54
    s_waitcnt lgkmcnt(4) vmcnt(10)
    v_mfma_f32_16x16x32_bf16 v[160:163], v[224:227], a[240:243], v[160:163]
    ds_read_b64_tr_b16 v[248:249], v146 offset:61440
    ds_read_b64_tr_b16 v[250:251], v146 offset:63488
    ds_read_b64_tr_b16 v[252:253], v147 offset:61440
    v_mfma_f32_16x16x32_bf16 v[164:167], v[224:227], a[244:247], v[164:167]
    ds_read_b64_tr_b16 v[254:255], v147 offset:63488
    v_and_b32 v29, 0xffff0000, v54
    v_mfma_f32_16x16x32_bf16 v[168:171], v[228:231], a[240:243], v[168:171]
    v_mul_f32 v28, v28, v158
    v_mul_f32 v29, v29, v158
    v_mfma_f32_16x16x32_bf16 v[172:175], v[228:231], a[244:247], v[172:175]
    v_lshlrev_b32_e64 v30, 16, v55
    v_and_b32 v31, 0xffff0000, v55
    v_mfma_f32_16x16x32_bf16 v[176:179], v[232:235], a[240:243], v[176:179]
    ds_read_b64_tr_b16 v[224:225], v192 offset:0
    ds_read_b64_tr_b16 v[226:227], v192 offset:2048
    v_mfma_f32_16x16x32_bf16 v[180:183], v[232:235], a[244:247], v[180:183]
    ds_read_b64_tr_b16 v[228:229], v193 offset:0
    ds_read_b64_tr_b16 v[230:231], v193 offset:2048
    v_mfma_f32_16x16x32_bf16 v[184:187], v[236:239], a[240:243], v[184:187]
    v_mul_f32 v30, v30, v158
    v_mul_f32 v31, v31, v158
    v_mfma_f32_16x16x32_bf16 v[188:191], v[236:239], a[244:247], v[188:191]
    s_waitcnt lgkmcnt(4) vmcnt(8)
    v_mfma_f32_16x16x32_bf16 v[160:163], v[240:243], a[248:251], v[160:163]
    ds_read_b64_tr_b16 v[232:233], v194 offset:0
    ds_read_b64_tr_b16 v[234:235], v194 offset:2048
    v_mfma_f32_16x16x32_bf16 v[164:167], v[240:243], a[252:255], v[164:167]
    ds_read_b64_tr_b16 v[236:237], v195 offset:0
    ds_read_b64_tr_b16 v[238:239], v195 offset:2048
    v_mfma_f32_16x16x32_bf16 v[168:171], v[244:247], a[248:251], v[168:171]
    v_lshlrev_b32 v32, 16, v56
    v_mfma_f32_16x16x32_bf16 v[172:175], v[244:247], a[252:255], v[172:175]
    v_and_b32 v33, 0xffff0000, v56
    v_mfma_f32_16x16x32_bf16 v[176:179], v[248:251], a[248:251], v[176:179]
    ds_read_b64_tr_b16 v[240:241], v192 offset:4096
    ds_read_b64_tr_b16 v[242:243], v192 offset:6144
    v_mfma_f32_16x16x32_bf16 v[180:183], v[248:251], a[252:255], v[180:183]
    ds_read_b64_tr_b16 v[244:245], v193 offset:4096
    ds_read_b64_tr_b16 v[246:247], v193 offset:6144
    v_mfma_f32_16x16x32_bf16 v[184:187], v[252:255], a[248:251], v[184:187]
    v_mul_f32_e64 v32, v32, v156
    v_mfma_f32_16x16x32_bf16 v[188:191], v[252:255], a[252:255], v[188:191]
    v_mul_f32 v33, v33, v156
    s_waitcnt lgkmcnt(4) vmcnt(6)
    v_mfma_f32_16x16x32_bf16 v[160:163], v[224:227], a[80:83], v[160:163]
    ds_read_b64_tr_b16 v[248:249], v194 offset:4096
    ds_read_b64_tr_b16 v[250:251], v194 offset:6144
    v_mfma_f32_16x16x32_bf16 v[164:167], v[224:227], a[84:87], v[164:167]
    ds_read_b64_tr_b16 v[252:253], v195 offset:4096
    ds_read_b64_tr_b16 v[254:255], v195 offset:6144
    v_mfma_f32_16x16x32_bf16 v[168:171], v[228:231], a[80:83], v[168:171]
    v_lshlrev_b32_e64 v34, 16, v57
    v_mfma_f32_16x16x32_bf16 v[172:175], v[228:231], a[84:87], v[172:175]
    v_and_b32 v35, 0xffff0000, v57
    v_mul_f32_e64 v34, v34, v156
    v_mfma_f32_16x16x32_bf16 v[176:179], v[232:235], a[80:83], v[176:179]
    ds_read_b64_tr_b16 v[224:225], v192 offset:8192
    ds_read_b64_tr_b16 v[226:227], v192 offset:10240
    v_mfma_f32_16x16x32_bf16 v[180:183], v[232:235], a[84:87], v[180:183]
    ds_read_b64_tr_b16 v[228:229], v193 offset:8192
    ds_read_b64_tr_b16 v[230:231], v193 offset:10240
    v_mfma_f32_16x16x32_bf16 v[184:187], v[236:239], a[80:83], v[184:187]
    v_mul_f32_e64 v35, v35, v156
    v_mfma_f32_16x16x32_bf16 v[188:191], v[236:239], a[84:87], v[188:191]
    v_lshlrev_b32 v36, 16, v58
    s_waitcnt lgkmcnt(4) vmcnt(4)
    v_mfma_f32_16x16x32_bf16 v[160:163], v[240:243], a[88:91], v[160:163]
    ds_read_b64_tr_b16 v[232:233], v194 offset:8192
    ds_read_b64_tr_b16 v[234:235], v194 offset:10240
    v_mfma_f32_16x16x32_bf16 v[164:167], v[240:243], a[92:95], v[164:167]
    ds_read_b64_tr_b16 v[236:237], v195 offset:8192
    ds_read_b64_tr_b16 v[238:239], v195 offset:10240
    v_mfma_f32_16x16x32_bf16 v[168:171], v[244:247], a[88:91], v[168:171]
    v_and_b32 v37, 0xffff0000, v58
    v_mfma_f32_16x16x32_bf16 v[172:175], v[244:247], a[92:95], v[172:175]
    v_mul_f32 v36, v36, v158
    v_mul_f32 v37, v37, v158
    v_mfma_f32_16x16x32_bf16 v[176:179], v[248:251], a[88:91], v[176:179]
    ds_read_b64_tr_b16 v[240:241], v192 offset:12288
    ds_read_b64_tr_b16 v[242:243], v192 offset:14336
    v_mfma_f32_16x16x32_bf16 v[180:183], v[248:251], a[92:95], v[180:183]
    ds_read_b64_tr_b16 v[244:245], v193 offset:12288
    ds_read_b64_tr_b16 v[246:247], v193 offset:14336
    v_mfma_f32_16x16x32_bf16 v[184:187], v[252:255], a[88:91], v[184:187]
    v_lshlrev_b32_e64 v38, 16, v59
    v_mfma_f32_16x16x32_bf16 v[188:191], v[252:255], a[92:95], v[188:191]
    v_and_b32 v39, 0xffff0000, v59
    s_waitcnt lgkmcnt(4) vmcnt(2)
    v_mfma_f32_16x16x32_bf16 v[160:163], v[224:227], a[96:99], v[160:163]
    ds_read_b64_tr_b16 v[248:249], v194 offset:12288
    ds_read_b64_tr_b16 v[250:251], v194 offset:14336
    v_mfma_f32_16x16x32_bf16 v[164:167], v[224:227], a[100:103], v[164:167]
    ds_read_b64_tr_b16 v[252:253], v195 offset:12288
    ds_read_b64_tr_b16 v[254:255], v195 offset:14336
    v_mfma_f32_16x16x32_bf16 v[168:171], v[228:231], a[96:99], v[168:171]
    v_mul_f32 v38, v38, v158
    v_mfma_f32_16x16x32_bf16 v[172:175], v[228:231], a[100:103], v[172:175]
    v_mul_f32 v39, v39, v158
    s_mov_b32 s56, s34
    v_mfma_f32_16x16x32_bf16 v[176:179], v[232:235], a[96:99], v[176:179]
    v_mfma_f32_16x16x32_bf16 v[180:183], v[232:235], a[100:103], v[180:183]
    s_mov_b32 s57, s35
    v_mfma_f32_16x16x32_bf16 v[184:187], v[236:239], a[96:99], v[184:187]
    s_mov_b32 s58, 0x00280000
    v_mfma_f32_16x16x32_bf16 v[188:191], v[236:239], a[100:103], v[188:191]
    s_waitcnt lgkmcnt(0) vmcnt(0)
    v_mfma_f32_16x16x32_bf16 v[160:163], v[240:243], a[104:107], v[160:163]
    v_mfma_f32_16x16x32_bf16 v[164:167], v[240:243], a[108:111], v[164:167]
    s_mov_b32 s59, 0x20000
    v_mfma_f32_16x16x32_bf16 v[168:171], v[244:247], a[104:107], v[168:171]
    v_mfma_f32_16x16x32_bf16 v[172:175], v[244:247], a[108:111], v[172:175]
    v_mfma_f32_16x16x32_bf16 v[176:179], v[248:251], a[104:107], v[176:179]
    v_mfma_f32_16x16x32_bf16 v[180:183], v[248:251], a[108:111], v[180:183]
    v_mfma_f32_16x16x32_bf16 v[184:187], v[252:255], a[104:107], v[184:187]
    v_mfma_f32_16x16x32_bf16 v[188:191], v[252:255], a[108:111], v[188:191]
    s_add_u32 s67, s42, 10240
    s_add_u32 s68, s42, 20480
    s_add_u32 s69, s42, 30720
    v_pk_fma_f32 v[8:9], v[160:161], v[156:157], v[8:9] op_sel:[0,1,0]
    v_pk_fma_f32 v[10:11], v[162:163], v[156:157], v[10:11] op_sel:[0,1,0]
    v_pk_fma_f32 v[12:13], v[164:165], v[158:159], v[12:13] op_sel:[0,1,0]
    v_pk_fma_f32 v[14:15], v[166:167], v[158:159], v[14:15] op_sel:[0,1,0]
    v_cvt_pk_bf16_f32 v224, v8, v9
    v_cvt_pk_bf16_f32 v225, v10, v11
    v_cvt_pk_bf16_f32 v226, v12, v13
    v_cvt_pk_bf16_f32 v227, v14, v15
    ds_write_b64 v208, v[224:225] offset:0
    ds_write_b64 v208, v[226:227] offset:2048
    v_pk_fma_f32 v[16:17], v[168:169], v[156:157], v[16:17] op_sel:[0,1,0]
    v_pk_fma_f32 v[18:19], v[170:171], v[156:157], v[18:19] op_sel:[0,1,0]
    v_pk_fma_f32 v[20:21], v[172:173], v[158:159], v[20:21] op_sel:[0,1,0]
    v_pk_fma_f32 v[22:23], v[174:175], v[158:159], v[22:23] op_sel:[0,1,0]
    v_cvt_pk_bf16_f32 v228, v16, v17
    v_cvt_pk_bf16_f32 v229, v18, v19
    v_cvt_pk_bf16_f32 v230, v20, v21
    v_cvt_pk_bf16_f32 v231, v22, v23
    ds_write_b64 v209, v[228:229] offset:0
    ds_write_b64 v209, v[230:231] offset:2048
    v_pk_fma_f32 v[24:25], v[176:177], v[156:157], v[24:25] op_sel:[0,1,0]
    v_pk_fma_f32 v[26:27], v[178:179], v[156:157], v[26:27] op_sel:[0,1,0]
    v_pk_fma_f32 v[28:29], v[180:181], v[158:159], v[28:29] op_sel:[0,1,0]
    v_pk_fma_f32 v[30:31], v[182:183], v[158:159], v[30:31] op_sel:[0,1,0]
    v_cvt_pk_bf16_f32 v232, v24, v25
    v_cvt_pk_bf16_f32 v233, v26, v27
    v_cvt_pk_bf16_f32 v234, v28, v29
    v_cvt_pk_bf16_f32 v235, v30, v31
    ds_write_b64 v210, v[232:233] offset:0
    ds_write_b64 v210, v[234:235] offset:2048
    v_pk_fma_f32 v[32:33], v[184:185], v[156:157], v[32:33] op_sel:[0,1,0]
    v_pk_fma_f32 v[34:35], v[186:187], v[156:157], v[34:35] op_sel:[0,1,0]
    v_pk_fma_f32 v[36:37], v[188:189], v[158:159], v[36:37] op_sel:[0,1,0]
    v_pk_fma_f32 v[38:39], v[190:191], v[158:159], v[38:39] op_sel:[0,1,0]
    v_cvt_pk_bf16_f32 v236, v32, v33
    v_cvt_pk_bf16_f32 v237, v34, v35
    v_cvt_pk_bf16_f32 v238, v36, v37
    v_cvt_pk_bf16_f32 v239, v38, v39
    ds_write_b64 v211, v[236:237] offset:0
    ds_write_b64 v211, v[238:239] offset:2048
    ds_read_b128 v[240:243], v152 offset:0
    ds_read_b128 v[244:247], v152 offset:1024
    ds_read_b128 v[248:251], v152 offset:2048
    ds_read_b128 v[252:255], v152 offset:3072
    s_waitcnt lgkmcnt(3)
    buffer_store_dwordx4 v[240:243], v153, s[56:59], s42 offen sc1
    s_waitcnt lgkmcnt(2)
    buffer_store_dwordx4 v[244:247], v153, s[56:59], s67 offen sc1
    s_waitcnt lgkmcnt(1)
    buffer_store_dwordx4 v[248:251], v153, s[56:59], s68 offen sc1
    s_waitcnt lgkmcnt(0)
    buffer_store_dwordx4 v[252:255], v153, s[56:59], s69 offen sc1
L_exit:
    s_endpgm
L_spin0:
    s_add_u32 s100, s100, 1
    s_cmp_gt_u32 s100, 2000000
    s_cbranch_scc1 L_exit
    v_mov_b32 v136, 0
    buffer_atomic_or v136, v129, s[52:55], s37 offen offset:0 sc0 sc1
    s_waitcnt vmcnt(0)
    v_cmp_ne_u32 vcc, v137, v136
    s_and_b32 vcc_lo, vcc_lo, 0xffff
    s_cbranch_scc1 L_spin0
    s_branch L_back0
L_spin1:
    s_add_u32 s100, s100, 1
    s_cmp_gt_u32 s100, 2000000
    s_cbranch_scc1 L_exit
    v_mov_b32_e64 v136, 0
    buffer_atomic_or v136, v132, s[52:55], s32 offen offset:0 sc0 sc1
    s_waitcnt vmcnt(0)
    v_cmp_ne_u32 vcc, v137, v136
    s_and_b32 vcc_lo, vcc_lo, 0xfff
    s_cbranch_scc1 L_spin1
    s_branch L_back1
L_spin2:
    s_add_u32 s100, s100, 1
    s_cmp_gt_u32 s100, 2000000
    s_cbranch_scc1 L_exit
    v_mov_b32_e64 v139, 0
    buffer_atomic_or v139, v129, s[52:55], s36 offen offset:0 sc0 sc1
    s_waitcnt vmcnt(0)
    v_cmp_ne_u32 vcc, v137, v139
    s_and_b32 vcc_lo, vcc_lo, 0xffff
    s_cbranch_scc1 L_spin2
    s_branch L_back2
L_sy2:
    s_add_u32 s100, s100, 1
    s_cmp_gt_u32 s100, 2000000
    s_cbranch_scc1 L_exit
    ds_read_b32 v60, v213
    s_waitcnt lgkmcnt(0)
    v_cmp_gt_u32 vcc, 2, v60
    s_cbranch_vccnz L_sy2
    s_branch L_syb2
L_spin3:
    s_add_u32 s100, s100, 1
    s_cmp_gt_u32 s100, 2000000
    s_cbranch_scc1 L_exit
    v_mov_b32_e64 v136, 0
    buffer_atomic_or v136, v132, s[52:55], s32 offen offset:256 sc0 sc1
    s_waitcnt vmcnt(0)
    v_cmp_ne_u32 vcc, v137, v136
    s_and_b32 vcc_lo, vcc_lo, 0xfff
    s_cbranch_scc1 L_spin3
    s_branch L_back3
L_spin4:
    s_add_u32 s100, s100, 1
    s_cmp_gt_u32 s100, 2000000
    s_cbranch_scc1 L_exit
    v_mov_b32_e64 v136, 0
    buffer_atomic_or v136, v132, s[52:55], s32 offen offset:512 sc0 sc1
    s_waitcnt vmcnt(0)
    v_cmp_ne_u32 vcc, v137, v136
    s_and_b32 vcc_lo, vcc_lo, 0xfff
    s_cbranch_scc1 L_spin4
    s_branch L_back4
L_spin5:
    s_add_u32 s100, s100, 1
    s_cmp_gt_u32 s100, 2000000
    s_cbranch_scc1 L_exit
    v_mov_b32_e64 v136, 0
    buffer_atomic_or v136, v132, s[52:55], s32 offen offset:768 sc0 sc1
    s_waitcnt vmcnt(0)
    v_cmp_ne_u32 vcc, v137, v136
    s_and_b32 vcc_lo, vcc_lo, 0xfff
    s_cbranch_scc1 L_spin5
    s_branch L_back5
L_sy1:
    s_add_u32 s100, s100, 1
    s_cmp_gt_u32 s100, 2000000
    s_cbranch_scc1 L_exit
    ds_read_b32 v60, v213
    s_waitcnt lgkmcnt(0)
    v_cmp_gt_u32 vcc, 1, v60
    s_cbranch_vccnz L_sy1
    s_branch L_syb1
L_bodyA:
    s_mov_b32 s52, s38
    s_mov_b32 s53, s39
    s_mov_b32 s54, 0x10000000
    s_mov_b32 s55, 0x20000
    s_and_b32 s67, s40, 1
    s_lshl_b32 s66, s61, 1
    s_add_u32 s66, s66, s67
    s_lshr_b32 s43, s65, 1
    s_lshl_b32 s43, s43, 9
    s_add_u32 s43, s43, s66
    s_lshl_b32 s43, s43, 2
    s_add_u32 s43, s43, 12648448
    s_lshl_b32 s66, s66, 11
    s_mul_i32 s56, s65, 98304
    s_add_u32 s56, s56, s66
    s_xor_b32 s57, s65, 1
    s_mul_i32 s57, s57, 98304
    s_add_u32 s57, s57, s66
    v_lshlrev_b32 v23, 4, v1
    v_mov_b32 v22, 12644352
    v_and_b32 v24, 15, v1
    v_add_u32 v24, s68, v24
    v_subrev_u32 v25, 80, v24
    v_min_u32_e64 v24, v24, v25
    v_lshlrev_b32 v31, 4, v24
    s_lshr_b32 s68, s64, 1
    s_add_u32 s68, s68, 131072
    v_add_u32_e64 v32, s68, v23
    v_bfe_u32 v2, v1, 2, 2
    v_bfe_u32 v25, v1, 4, 1
    v_lshl_add_u32 v24, v25, 3, v2
    v_lshlrev_b32_e64 v24, 7, v24
    v_lshl_add_u32 v24, v25, 5, v24
    v_lshrrev_b32 v2, 1, v2
    v_xor_b32 v2, s67, v2
    v_lshl_add_u32 v24, v2, 6, v24
    v_lshrrev_b32_e64 v2, 5, v1
    v_lshl_add_u32 v24, v2, 12, v24
    v_and_b32_e64 v2, 3, v1
    v_lshl_add_u32 v16, v2, 3, v24
    v_xor_b32_e64 v17, 32, v16
    v_add_u32 v18, 0x10000, v16
    v_add_u32 v19, 0x10000, v17
    v_lshrrev_b32 v3, 4, v1
    v_and_b32 v2, 15, v1
    v_bfe_u32 v24, v1, 1, 3
    v_xor_b32 v24, v24, v3
    v_lshlrev_b32 v24, 4, v24
    v_lshl_add_u32 v24, v2, 7, v24
    v_add_u32 v12, s64, v24
    v_and_b32 v2, 31, v1
    v_lshl_add_u32 v3, v3, 4, s68
    s_lshl_b32 s67, s67, 7
    v_add_u32 v30, s67, v3
    v_xor_b32_e64 v13, 64, v12
    v_xor_b32 v14, 4096, v12
    v_xor_b32 v15, 4160, v12
    s_lshl_b32 s66, s69, 7
    s_add_u32 s5, s66, s62
    s_mul_i32 s66, s69, 196608
    s_add_u32 s15, s66, s63
    s_add_u32 s69, s69, 1
    s_cmp_eq_u32 s69, 10
    s_cselect_b32 s69, 0, s69
    s_lshl_b32 s66, s69, 7
    s_add_u32 s6, s66, s62
    s_mul_i32 s66, s69, 196608
    s_add_u32 s16, s66, s63
    s_add_u32 s69, s69, 1
    s_cmp_eq_u32 s69, 10
    s_cselect_b32 s69, 0, s69
    s_lshl_b32 s66, s69, 7
    s_add_u32 s7, s66, s62
    s_mul_i32 s66, s69, 196608
    s_add_u32 s17, s66, s63
    s_add_u32 s69, s69, 1
    s_cmp_eq_u32 s69, 10
    s_cselect_b32 s69, 0, s69
    s_lshl_b32 s66, s69, 7
    s_add_u32 s8, s66, s62
    s_mul_i32 s66, s69, 196608
    s_add_u32 s18, s66, s63
    s_add_u32 s69, s69, 1
    s_cmp_eq_u32 s69, 10
    s_cselect_b32 s69, 0, s69
    s_lshl_b32 s66, s69, 7
    s_add_u32 s9, s66, s62
    s_mul_i32 s66, s69, 196608
    s_add_u32 s19, s66, s63
    s_add_u32 s69, s69, 1
    s_cmp_eq_u32 s69, 10
    s_cselect_b32 s69, 0, s69
    s_lshl_b32 s66, s69, 7
    s_add_u32 s10, s66, s62
    s_mul_i32 s66, s69, 196608
    s_add_u32 s20, s66, s63
    s_add_u32 s69, s69, 1
    s_cmp_eq_u32 s69, 10
    s_cselect_b32 s69, 0, s69
    s_lshl_b32 s66, s69, 7
    s_add_u32 s11, s66, s62
    s_mul_i32 s66, s69, 196608
    s_add_u32 s21, s66, s63
    s_add_u32 s69, s69, 1
    s_cmp_eq_u32 s69, 10
    s_cselect_b32 s69, 0, s69
    s_lshl_b32 s66, s69, 7
    s_add_u32 s12, s66, s62
    s_mul_i32 s66, s69, 196608
    s_add_u32 s22, s66, s63
    s_add_u32 s69, s69, 1
    s_cmp_eq_u32 s69, 10
    s_cselect_b32 s69, 0, s69
    s_lshl_b32 s66, s69, 7
    s_add_u32 s13, s66, s62
    s_mul_i32 s66, s69, 196608
    s_add_u32 s23, s66, s63
    s_mov_b64 exec, 0
    s_cmp_eq_u32 s40, 0
    s_cbranch_scc1 L_ptA0
    s_cmp_eq_u32 s40, 1
    s_cbranch_scc1 L_ptA1
    s_cmp_eq_u32 s40, 2
    s_cbranch_scc1 L_ptA2
    s_cmp_eq_u32 s40, 3
    s_cbranch_scc1 L_ptA3
L_ptdA:
    s_mov_b64 exec, -1
    s_add_u32 m0, s68, 1024
    s_nop 0
    global_load_lds_dwordx4 v31, s[32:33]
    global_load_dword v0, v22, s[38:39] sc1
    s_add_u32 m0, s64, 16384
    s_nop 0
    buffer_load_dwordx4 v4, s[44:47], s5 offen offset:0 lds
    buffer_load_dwordx4 v5, s[44:47], s5 offen offset:1024 lds
    buffer_load_dwordx4 v6, s[44:47], s5 offen offset:2048 lds
    buffer_load_dwordx4 v7, s[44:47], s5 offen offset:3072 lds
    s_waitcnt vmcnt(12)
    v_lshlrev_b32_e64 v24, 16, v28
    v_and_b32 v25, 0xffff0000, v28
    v_lshlrev_b32_e64 v26, 16, v29
    v_and_b32 v27, 0xffff0000, v29
    ds_write_b128 v32, v[24:27]
    v_min_u32 v29, 1, v1
    v_sub_u32 v29, 0, v29
    v_and_b32 v29, 0x7ffff000, v29
    ds_read_b128 v[128:131], v30 offset:0
    ds_read_b128 v[132:135], v30 offset:64
    ds_read_b128 v[136:139], v30 offset:0
    ds_read_b128 v[140:143], v30 offset:64
    ds_read_b128 v[144:147], v30 offset:0
    ds_read_b128 v[148:151], v30 offset:64
    ds_read_b128 v[152:155], v30 offset:0
    ds_read_b128 v[156:159], v30 offset:64
    ds_read_b128 v[160:163], v30 offset:256
    ds_read_b128 v[164:167], v30 offset:320
    ds_read_b128 v[168:171], v30 offset:256
    ds_read_b128 v[172:175], v30 offset:320
    ds_read_b128 v[176:179], v30 offset:256
    ds_read_b128 v[180:183], v30 offset:320
    ds_read_b128 v[184:187], v30 offset:256
    ds_read_b128 v[188:191], v30 offset:320
L_ptA0:
    s_cbranch_execz L_ptdA
    s_add_u32 m0, s64, 81920
    s_nop 0
    buffer_load_dwordx4 v10, s[48:51], s15 offen offset:2048 lds
    buffer_load_dwordx4 v11, s[48:51], s15 offen offset:3072 lds
    s_waitcnt vmcnt(8)
    s_barrier
    ds_read_b128 a[0:3], v12 offset:0
    ds_read_b128 a[4:7], v12 offset:2048
    ds_read_b128 a[8:11], v14 offset:0
    ds_read_b128 a[12:15], v14 offset:2048
    ds_read_b64_tr_b16 v[32:33], v18 offset:16384
    ds_read_b64_tr_b16 v[34:35], v18 offset:16896
    ds_read_b128 a[16:19], v13 offset:0
    ds_read_b128 a[20:23], v13 offset:2048
    s_waitcnt vmcnt(7)
    s_nop 0
    ds_read_b128 v[48:51], v3 offset:1024
    ds_read_b64_tr_b16 v[36:37], v19 offset:16384
    ds_read_b64_tr_b16 v[38:39], v19 offset:16896
    ds_read_b128 a[24:27], v15 offset:0
    ds_read_b128 a[28:31], v15 offset:2048
    ds_read_b64_tr_b16 v[40:41], v18 offset:24576
    ds_read_b64_tr_b16 v[42:43], v18 offset:25088
    s_waitcnt lgkmcnt(9)
    v_mfma_f32_16x16x32_bf16 v[128:131], v[32:35], a[0:3], v[128:131]
    s_add_u32 m0, s64, 32768
    ds_read_b128 v[52:55], v3 offset:1088
    v_mfma_f32_16x16x32_bf16 v[136:139], v[32:35], a[4:7], v[136:139]
    ds_read_b64_tr_b16 v[44:45], v19 offset:24576
    ds_read_b64_tr_b16 v[46:47], v19 offset:25088
    v_mfma_f32_16x16x32_bf16 v[144:147], v[32:35], a[8:11], v[144:147]
    buffer_load_dwordx4 v4, s[44:47], s6 offen offset:0 lds
    v_mfma_f32_16x16x32_bf16 v[152:155], v[32:35], a[12:15], v[152:155]
    buffer_load_dwordx4 v5, s[44:47], s6 offen offset:1024 lds
    buffer_load_dwordx4 v6, s[44:47], s6 offen offset:2048 lds
    buffer_load_dwordx4 v7, s[44:47], s6 offen offset:3072 lds
    s_add_u32 m0, s64, 98304
    s_nop 0
    buffer_load_dwordx4 v8, s[48:51], s16 offen offset:0 lds
    buffer_load_dwordx4 v9, s[48:51], s16 offen offset:1024 lds
    s_waitcnt lgkmcnt(7)
    v_mfma_f32_16x16x32_bf16 v[132:135], v[36:39], a[0:3], v[132:135]
    s_waitcnt vmcnt(6)
    s_barrier
    v_mfma_f32_16x16x32_bf16 v[140:143], v[36:39], a[4:7], v[140:143]
    s_add_u32 m0, s64, 49152
    ds_read_b128 a[32:35], v12 offset:16384
    v_mfma_f32_16x16x32_bf16 v[148:151], v[36:39], a[8:11], v[148:151]
    ds_read_b128 a[36:39], v12 offset:18432
    ds_read_b128 a[40:43], v14 offset:16384
    v_mfma_f32_16x16x32_bf16 v[156:159], v[36:39], a[12:15], v[156:159]
    buffer_load_dwordx4 v4, s[44:47], s7 offen offset:0 lds
    ds_read_b128 a[44:47], v14 offset:18432
    ds_read_b64_tr_b16 v[32:33], v18 offset:18432
    ds_read_b64_tr_b16 v[34:35], v18 offset:18944
    v_mfma_f32_16x16x32_bf16 v[224:227], v[48:51], a[0:3], 0
    buffer_load_dwordx4 v5, s[44:47], s7 offen offset:1024 lds
    v_mfma_f32_16x16x32_bf16 v[228:231], v[48:51], a[4:7], 0
    s_waitcnt lgkmcnt(6)
    v_mfma_f32_16x16x32_bf16 v[128:131], v[40:43], a[16:19], v[128:131]
    buffer_load_dwordx4 v6, s[44:47], s7 offen offset:2048 lds
    v_mfma_f32_16x16x32_bf16 v[136:139], v[40:43], a[20:23], v[136:139]
    ds_read_b128 a[48:51], v13 offset:16384
    ds_read_b128 a[52:55], v13 offset:18432
    v_mfma_f32_16x16x32_bf16 v[144:147], v[40:43], a[24:27], v[144:147]
    buffer_load_dwordx4 v7, s[44:47], s7 offen offset:3072 lds
    v_mfma_f32_16x16x32_bf16 v[152:155], v[40:43], a[28:31], v[152:155]
    ds_read_b128 v[56:59], v3 offset:1152
    ds_read_b64_tr_b16 v[36:37], v19 offset:18432
    ds_read_b64_tr_b16 v[38:39], v19 offset:18944
    v_mfma_f32_16x16x32_bf16 v[132:135], v[44:47], a[16:19], v[132:135]
    s_add_u32 m0, s64, 98304
    ds_read_b128 a[56:59], v15 offset:16384
    v_mfma_f32_16x16x32_bf16 v[140:143], v[44:47], a[20:23], v[140:143]
    ds_read_b128 a[60:63], v15 offset:18432
    ds_read_b64_tr_b16 v[40:41], v18 offset:26624
    v_mfma_f32_16x16x32_bf16 v[148:151], v[44:47], a[24:27], v[148:151]
    buffer_load_dwordx4 v10, s[48:51], s17 offen offset:2048 lds
    v_mfma_f32_16x16x32_bf16 v[156:159], v[44:47], a[28:31], v[156:159]
    ds_read_b64_tr_b16 v[42:43], v18 offset:27136
    v_mfma_f32_16x16x32_bf16 v[224:227], v[52:55], a[16:19], v[224:227]
    buffer_load_dwordx4 v11, s[48:51], s17 offen offset:3072 lds
    v_mfma_f32_16x16x32_bf16 v[228:231], v[52:55], a[20:23], v[228:231]
    s_waitcnt lgkmcnt(4)
    v_mfma_f32_16x16x32_bf16 v[128:131], v[32:35], a[32:35], v[128:131]
    ds_read_b128 v[60:63], v3 offset:1216
    ds_read_b64_tr_b16 v[44:45], v19 offset:26624
    v_mfma_f32_16x16x32_bf16 v[136:139], v[32:35], a[36:39], v[136:139]
    ds_read_b64_tr_b16 v[46:47], v19 offset:27136
    ds_read_b128 v[192:195], v30 offset:512
    v_mfma_f32_16x16x32_bf16 v[144:147], v[32:35], a[40:43], v[144:147]
    ds_read_b128 v[196:199], v30 offset:576
    ds_read_b128 v[200:203], v30 offset:512
    v_mfma_f32_16x16x32_bf16 v[152:155], v[32:35], a[44:47], v[152:155]
    ds_read_b128 v[204:207], v30 offset:576
    ds_read_b128 v[208:211], v30 offset:512
    v_mfma_f32_16x16x32_bf16 v[132:135], v[36:39], a[32:35], v[132:135]
    s_waitcnt vmcnt(6)
    s_barrier
    v_mfma_f32_16x16x32_bf16 v[140:143], v[36:39], a[36:39], v[140:143]
    s_add_u32 m0, s64, 0
    ds_read_b128 a[64:67], v12 offset:32768
    v_mfma_f32_16x16x32_bf16 v[148:151], v[36:39], a[40:43], v[148:151]
    ds_read_b128 a[68:71], v12 offset:34816
    ds_read_b128 a[72:75], v14 offset:32768
    v_mfma_f32_16x16x32_bf16 v[156:159], v[36:39], a[44:47], v[156:159]
    buffer_load_dwordx4 v4, s[44:47], s8 offen offset:0 lds
    ds_read_b128 a[76:79], v14 offset:34816
    ds_read_b64_tr_b16 v[32:33], v18 offset:32768
    ds_read_b64_tr_b16 v[34:35], v18 offset:33280
    v_mfma_f32_16x16x32_bf16 v[224:227], v[56:59], a[32:35], v[224:227]
    buffer_load_dwordx4 v5, s[44:47], s8 offen offset:1024 lds
    v_mfma_f32_16x16x32_bf16 v[228:231], v[56:59], a[36:39], v[228:231]
    ds_read_b128 v[212:215], v30 offset:576
    s_waitcnt lgkmcnt(12)
    v_mfma_f32_16x16x32_bf16 v[128:131], v[40:43], a[48:51], v[128:131]
    buffer_load_dwordx4 v6, s[44:47], s8 offen offset:2048 lds
    v_mfma_f32_16x16x32_bf16 v[136:139], v[40:43], a[52:55], v[136:139]
    ds_read_b128 a[80:83], v13 offset:32768
    ds_read_b128 a[84:87], v13 offset:34816
    v_mfma_f32_16x16x32_bf16 v[144:147], v[40:43], a[56:59], v[144:147]
    buffer_load_dwordx4 v7, s[44:47], s8 offen offset:3072 lds
    v_mfma_f32_16x16x32_bf16 v[152:155], v[40:43], a[60:63], v[152:155]
    ds_read_b64_tr_b16 v[36:37], v19 offset:32768
    ds_read_b64_tr_b16 v[38:39], v19 offset:33280
    v_mfma_f32_16x16x32_bf16 v[132:135], v[44:47], a[48:51], v[132:135]
    v_add_u32 v10, 0x80, v10
    ds_read_b128 a[88:91], v15 offset:32768
    v_mfma_f32_16x16x32_bf16 v[140:143], v[44:47], a[52:55], v[140:143]
    ds_read_b128 a[92:95], v15 offset:34816
    ds_read_b64_tr_b16 v[40:41], v18 offset:40960
    v_mfma_f32_16x16x32_bf16 v[148:151], v[44:47], a[56:59], v[148:151]
    v_add_u32 v11, 0x80, v11
    ds_read_b64_tr_b16 v[42:43], v18 offset:41472
    v_mfma_f32_16x16x32_bf16 v[156:159], v[44:47], a[60:63], v[156:159]
    ds_read_b128 v[216:219], v30 offset:512
    ds_read_b128 v[220:223], v30 offset:576
    v_mfma_f32_16x16x32_bf16 v[224:227], v[60:63], a[48:51], v[224:227]
    s_add_u32 m0, s64, 114688
    v_mfma_f32_16x16x32_bf16 v[228:231], v[60:63], a[52:55], v[228:231]
    s_waitcnt lgkmcnt(6)
    v_mfma_f32_16x16x32_bf16 v[128:131], v[32:35], a[64:67], v[128:131]
    buffer_load_dwordx4 v8, s[48:51], s18 offen offset:0 lds
    v_mfma_f32_16x16x32_bf16 v[136:139], v[32:35], a[68:71], v[136:139]
    ds_read_b64_tr_b16 v[44:45], v19 offset:40960
    ds_read_b64_tr_b16 v[46:47], v19 offset:41472
    v_mfma_f32_16x16x32_bf16 v[144:147], v[32:35], a[72:75], v[144:147]
    buffer_load_dwordx4 v9, s[48:51], s18 offen offset:1024 lds
    v_mfma_f32_16x16x32_bf16 v[152:155], v[32:35], a[76:79], v[152:155]
    buffer_load_dwordx4 v10, s[48:51], s18 offen offset:2048 lds
    buffer_load_dwordx4 v11, s[48:51], s18 offen offset:3072 lds
    v_mfma_f32_16x16x32_bf16 v[132:135], v[36:39], a[64:67], v[132:135]
    s_waitcnt vmcnt(8)
    s_barrier
    v_mfma_f32_16x16x32_bf16 v[140:143], v[36:39], a[68:71], v[140:143]
    s_add_u32 m0, s64, 16384
    ds_read_b128 a[96:99], v12 offset:49152
    v_mfma_f32_16x16x32_bf16 v[148:151], v[36:39], a[72:75], v[148:151]
    ds_read_b128 a[100:103], v12 offset:51200
    ds_read_b128 a[104:107], v14 offset:49152
    v_mfma_f32_16x16x32_bf16 v[156:159], v[36:39], a[76:79], v[156:159]
    buffer_load_dwordx4 v4, s[44:47], s9 offen offset:0 lds
    ds_read_b128 a[108:111], v14 offset:51200
    ds_read_b64_tr_b16 v[32:33], v18 offset:34816
    ds_read_b64_tr_b16 v[34:35], v18 offset:35328
    s_waitcnt lgkmcnt(6)
    v_mfma_f32_16x16x32_bf16 v[128:131], v[40:43], a[80:83], v[128:131]
    buffer_load_dwordx4 v5, s[44:47], s9 offen offset:1024 lds
    v_mfma_f32_16x16x32_bf16 v[136:139], v[40:43], a[84:87], v[136:139]
    ds_read_b128 a[112:115], v13 offset:49152
    ds_read_b128 a[116:119], v13 offset:51200
    v_mfma_f32_16x16x32_bf16 v[144:147], v[40:43], a[88:91], v[144:147]
    buffer_load_dwordx4 v6, s[44:47], s9 offen offset:2048 lds
    v_mfma_f32_16x16x32_bf16 v[152:155], v[40:43], a[92:95], v[152:155]
    ds_read_b64_tr_b16 v[36:37], v19 offset:34816
    ds_read_b64_tr_b16 v[38:39], v19 offset:35328
    v_mfma_f32_16x16x32_bf16 v[132:135], v[44:47], a[80:83], v[132:135]
    buffer_load_dwordx4 v7, s[44:47], s9 offen offset:3072 lds
    v_mfma_f32_16x16x32_bf16 v[140:143], v[44:47], a[84:87], v[140:143]
    ds_read_b128 a[120:123], v15 offset:49152
    ds_read_b128 a[124:127], v15 offset:51200
    v_mfma_f32_16x16x32_bf16 v[148:151], v[44:47], a[88:91], v[148:151]
    s_add_u32 m0, s64, 65536
    ds_read_b64_tr_b16 v[40:41], v18 offset:43008
    v_mfma_f32_16x16x32_bf16 v[156:159], v[44:47], a[92:95], v[156:159]
    ds_read_b64_tr_b16 v[42:43], v18 offset:43520
    s_waitcnt lgkmcnt(4)
    v_mfma_f32_16x16x32_bf16 v[128:131], v[32:35], a[96:99], v[128:131]
    s_mov_b32 vcc_lo, 0xffff0000
    s_mov_b32 vcc_hi, 0xffff0000
    v_cndmask_b32 v224, v224, v228, vcc
    v_mfma_f32_16x16x32_bf16 v[136:139], v[32:35], a[100:103], v[136:139]
    buffer_load_dwordx4 v8, s[48:51], s19 offen offset:0 lds
    v_mfma_f32_16x16x32_bf16 v[144:147], v[32:35], a[104:107], v[144:147]
    ds_read_b64_tr_b16 v[44:45], v19 offset:43008
    ds_read_b64_tr_b16 v[46:47], v19 offset:43520
    s_cmp_eq_u32 s61, 5
    s_cselect_b32 s67, 0, -1
    v_and_b32_e64 v31, s67, v224
    s_nop 0
    v_mfma_f32_16x16x32_bf16 v[152:155], v[32:35], a[108:111], v[152:155]
    buffer_load_dwordx4 v9, s[48:51], s19 offen offset:1024 lds
    buffer_load_dwordx4 v10, s[48:51], s19 offen offset:2048 lds
    buffer_load_dwordx4 v11, s[48:51], s19 offen offset:3072 lds
    v_mfma_f32_16x16x32_bf16 v[132:135], v[36:39], a[96:99], v[132:135]
    s_waitcnt vmcnt(8)
    s_barrier
    v_mfma_f32_16x16x32_bf16 v[140:143], v[36:39], a[100:103], v[140:143]
    s_add_u32 m0, s64, 32768
    ds_read_b128 a[128:131], v12 offset:0
    v_mfma_f32_16x16x32_bf16 v[148:151], v[36:39], a[104:107], v[148:151]
    ds_read_b128 a[132:135], v12 offset:2048
    ds_read_b128 a[136:139], v14 offset:0
    v_mfma_f32_16x16x32_bf16 v[156:159], v[36:39], a[108:111], v[156:159]
    ds_read_b128 a[140:143], v14 offset:2048
    ds_read_b64_tr_b16 v[32:33], v18 offset:49152
    ds_read_b64_tr_b16 v[34:35], v18 offset:49664
    s_waitcnt lgkmcnt(6)
    v_mfma_f32_16x16x32_bf16 v[128:131], v[40:43], a[112:115], v[128:131]
    buffer_load_dwordx4 v4, s[44:47], s10 offen offset:0 lds
    v_mfma_f32_16x16x32_bf16 v[136:139], v[40:43], a[116:119], v[136:139]
    ds_read_b128 a[144:147], v13 offset:0
    ds_read_b64_tr_b16 v[36:37], v18 offset:51200
    v_mfma_f32_16x16x32_bf16 v[144:147], v[40:43], a[120:123], v[144:147]
    buffer_load_dwordx4 v5, s[44:47], s10 offen offset:1024 lds
    v_mfma_f32_16x16x32_bf16 v[152:155], v[40:43], a[124:127], v[152:155]
    ds_read_b64_tr_b16 v[38:39], v18 offset:51712
    ds_read_b128 v[224:227], v30 offset:768
    v_mfma_f32_16x16x32_bf16 v[132:135], v[44:47], a[112:115], v[132:135]
    ds_read_b128 a[148:151], v13 offset:2048
    ds_read_b64_tr_b16 v[40:41], v19 offset:49152
    v_mfma_f32_16x16x32_bf16 v[140:143], v[44:47], a[116:119], v[140:143]
    ds_read_b64_tr_b16 v[42:43], v19 offset:49664
    ds_read_b128 v[228:231], v30 offset:832
    v_mfma_f32_16x16x32_bf16 v[148:151], v[44:47], a[120:123], v[148:151]
    buffer_load_dwordx4 v6, s[44:47], s10 offen offset:2048 lds
    v_mfma_f32_16x16x32_bf16 v[156:159], v[44:47], a[124:127], v[156:159]
    ds_read_b128 v[232:235], v30 offset:768
    s_waitcnt lgkmcnt(6)
    v_mfma_f32_16x16x32_bf16 v[128:131], v[32:35], a[128:131], v[128:131]
    ds_read_b128 a[152:155], v15 offset:0
    ds_read_b64_tr_b16 v[44:45], v19 offset:51200
    v_mfma_f32_16x16x32_bf16 v[136:139], v[32:35], a[132:135], v[136:139]
    buffer_load_dwordx4 v7, s[44:47], s10 offen offset:3072 lds
    v_mfma_f32_16x16x32_bf16 v[144:147], v[32:35], a[136:139], v[144:147]
    ds_read_b64_tr_b16 v[46:47], v19 offset:51712
    ds_read_b128 v[236:239], v30 offset:832
    v_mfma_f32_16x16x32_bf16 v[152:155], v[32:35], a[140:143], v[152:155]
    ds_read_b128 v[240:243], v30 offset:768
    ds_read_b128 v[244:247], v30 offset:832
    v_mfma_f32_16x16x32_bf16 v[160:163], v[36:39], a[128:131], v[160:163]
    ds_read_b128 a[156:159], v15 offset:2048
    ds_read_b64_tr_b16 v[32:33], v18 offset:57344
    v_mfma_f32_16x16x32_bf16 v[168:171], v[36:39], a[132:135], v[168:171]
    s_add_u32 m0, s64, 81920
    ds_read_b64_tr_b16 v[34:35], v18 offset:57856
    v_mfma_f32_16x16x32_bf16 v[176:179], v[36:39], a[136:139], v[176:179]
    ds_read_b128 v[248:251], v30 offset:768
    ds_read_b128 v[252:255], v30 offset:832
    v_mfma_f32_16x16x32_bf16 v[184:187], v[36:39], a[140:143], v[184:187]
    s_waitcnt lgkmcnt(8)
    v_mfma_f32_16x16x32_bf16 v[132:135], v[40:43], a[128:131], v[132:135]
    buffer_load_dwordx4 v8, s[48:51], s20 offen offset:0 lds
    v_mfma_f32_16x16x32_bf16 v[140:143], v[40:43], a[132:135], v[140:143]
    ds_read_b64_tr_b16 v[36:37], v18 offset:59392
    ds_read_b64_tr_b16 v[38:39], v18 offset:59904
    v_mfma_f32_16x16x32_bf16 v[148:151], v[40:43], a[136:139], v[148:151]
    v_add_u32 v28, 0x9e3779b1, v0
    v_mfma_f32_16x16x32_bf16 v[156:159], v[40:43], a[140:143], v[156:159]
    buffer_load_dwordx4 v9, s[48:51], s20 offen offset:1024 lds
    v_mfma_f32_16x16x32_bf16 v[164:167], v[44:47], a[128:131], v[164:167]
    ds_read_b64_tr_b16 v[40:41], v19 offset:57344
    ds_read_b64_tr_b16 v[42:43], v19 offset:57856
    v_mfma_f32_16x16x32_bf16 v[172:175], v[44:47], a[132:135], v[172:175]
    v_mfma_f32_16x16x32_bf16 v[180:183], v[44:47], a[136:139], v[180:183]
    v_mfma_f32_16x16x32_bf16 v[188:191], v[44:47], a[140:143], v[188:191]
    s_waitcnt lgkmcnt(2)
    v_mfma_f32_16x16x32_bf16 v[128:131], v[32:35], a[144:147], v[128:131]
    buffer_load_dwordx4 v10, s[48:51], s20 offen offset:2048 lds
    v_mfma_f32_16x16x32_bf16 v[136:139], v[32:35], a[148:151], v[136:139]
    ds_read_b64_tr_b16 v[44:45], v19 offset:59392
    ds_read_b64_tr_b16 v[46:47], v19 offset:59904
    v_mfma_f32_16x16x32_bf16 v[144:147], v[32:35], a[152:155], v[144:147]
    buffer_load_dwordx4 v11, s[48:51], s20 offen offset:3072 lds
    v_mfma_f32_16x16x32_bf16 v[152:155], v[32:35], a[156:159], v[152:155]
    v_mfma_f32_16x16x32_bf16 v[160:163], v[36:39], a[144:147], v[160:163]
    s_waitcnt vmcnt(8)
    s_barrier
    v_mfma_f32_16x16x32_bf16 v[168:171], v[36:39], a[148:151], v[168:171]
    s_add_u32 m0, s64, 49152
    ds_read_b128 a[160:163], v12 offset:16384
    v_mfma_f32_16x16x32_bf16 v[176:179], v[36:39], a[152:155], v[176:179]
    ds_read_b128 a[164:167], v12 offset:18432
    ds_read_b128 a[168:171], v14 offset:16384
    v_mfma_f32_16x16x32_bf16 v[184:187], v[36:39], a[156:159], v[184:187]
    ds_read_b128 a[172:175], v14 offset:18432
    ds_read_b64_tr_b16 v[32:33], v18 offset:0
    ds_read_b64_tr_b16 v[34:35], v18 offset:512
    s_waitcnt lgkmcnt(6)
    v_mfma_f32_16x16x32_bf16 v[132:135], v[40:43], a[144:147], v[132:135]
    buffer_load_dwordx4 v4, s[44:47], s11 offen offset:0 lds
    v_mfma_f32_16x16x32_bf16 v[140:143], v[40:43], a[148:151], v[140:143]
    ds_read_b128 a[176:179], v13 offset:16384
    ds_read_b64_tr_b16 v[36:37], v18 offset:2048
    v_mfma_f32_16x16x32_bf16 v[148:151], v[40:43], a[152:155], v[148:151]
    buffer_load_dwordx4 v5, s[44:47], s11 offen offset:1024 lds
    v_mfma_f32_16x16x32_bf16 v[156:159], v[40:43], a[156:159], v[156:159]
    ds_read_b64_tr_b16 v[38:39], v18 offset:2560
    v_mfma_f32_16x16x32_bf16 v[164:167], v[44:47], a[144:147], v[164:167]
    ds_read_b128 a[180:183], v13 offset:18432
    ds_read_b64_tr_b16 v[40:41], v19 offset:0
    v_mfma_f32_16x16x32_bf16 v[172:175], v[44:47], a[148:151], v[172:175]
    ds_read_b64_tr_b16 v[42:43], v19 offset:512
    v_mfma_f32_16x16x32_bf16 v[180:183], v[44:47], a[152:155], v[180:183]
    buffer_load_dwordx4 v6, s[44:47], s11 offen offset:2048 lds
    v_mfma_f32_16x16x32_bf16 v[188:191], v[44:47], a[156:159], v[188:191]
    s_waitcnt lgkmcnt(3)
    v_mfma_f32_16x16x32_bf16 v[128:131], v[32:35], a[160:163], v[128:131]
    ds_read_b128 a[184:187], v15 offset:16384
    ds_read_b64_tr_b16 v[44:45], v19 offset:2048
    v_mfma_f32_16x16x32_bf16 v[136:139], v[32:35], a[164:167], v[136:139]
    buffer_load_dwordx4 v7, s[44:47], s11 offen offset:3072 lds
    v_mfma_f32_16x16x32_bf16 v[144:147], v[32:35], a[168:171], v[144:147]
    ds_read_b64_tr_b16 v[46:47], v19 offset:2560
    v_mfma_f32_16x16x32_bf16 v[152:155], v[32:35], a[172:175], v[152:155]
    v_mfma_f32_16x16x32_bf16 v[160:163], v[36:39], a[160:163], v[160:163]
    ds_read_b128 a[188:191], v15 offset:18432
    ds_read_b64_tr_b16 v[32:33], v18 offset:8192
    v_mfma_f32_16x16x32_bf16 v[168:171], v[36:39], a[164:167], v[168:171]
    s_add_u32 m0, s64, 98304
    ds_read_b64_tr_b16 v[34:35], v18 offset:8704
    v_mfma_f32_16x16x32_bf16 v[176:179], v[36:39], a[168:171], v[176:179]
    v_mfma_f32_16x16x32_bf16 v[184:187], v[36:39], a[172:175], v[184:187]
    s_waitcnt lgkmcnt(3)
    v_mfma_f32_16x16x32_bf16 v[132:135], v[40:43], a[160:163], v[132:135]
    buffer_load_dwordx4 v8, s[48:51], s21 offen offset:0 lds
    v_mfma_f32_16x16x32_bf16 v[140:143], v[40:43], a[164:167], v[140:143]
    ds_read_b64_tr_b16 v[36:37], v18 offset:10240
    ds_read_b64_tr_b16 v[38:39], v18 offset:10752
    v_mfma_f32_16x16x32_bf16 v[148:151], v[40:43], a[168:171], v[148:151]
    v_mfma_f32_16x16x32_bf16 v[156:159], v[40:43], a[172:175], v[156:159]
    buffer_load_dwordx4 v9, s[48:51], s21 offen offset:1024 lds
    v_mfma_f32_16x16x32_bf16 v[164:167], v[44:47], a[160:163], v[164:167]
    ds_read_b64_tr_b16 v[40:41], v19 offset:8192
    ds_read_b64_tr_b16 v[42:43], v19 offset:8704
    v_mfma_f32_16x16x32_bf16 v[172:175], v[44:47], a[164:167], v[172:175]
    v_mfma_f32_16x16x32_bf16 v[180:183], v[44:47], a[168:171], v[180:183]
    v_mfma_f32_16x16x32_bf16 v[188:191], v[44:47], a[172:175], v[188:191]
    s_waitcnt lgkmcnt(2)
    v_mfma_f32_16x16x32_bf16 v[128:131], v[32:35], a[176:179], v[128:131]
    buffer_load_dwordx4 v10, s[48:51], s21 offen offset:2048 lds
    v_mfma_f32_16x16x32_bf16 v[136:139], v[32:35], a[180:183], v[136:139]
    ds_read_b64_tr_b16 v[44:45], v19 offset:10240
    ds_read_b64_tr_b16 v[46:47], v19 offset:10752
    v_mfma_f32_16x16x32_bf16 v[144:147], v[32:35], a[184:187], v[144:147]
    buffer_load_dwordx4 v11, s[48:51], s21 offen offset:3072 lds
    v_mfma_f32_16x16x32_bf16 v[152:155], v[32:35], a[188:191], v[152:155]
    v_mfma_f32_16x16x32_bf16 v[160:163], v[36:39], a[176:179], v[160:163]
    s_waitcnt vmcnt(8)
    s_barrier
    v_mfma_f32_16x16x32_bf16 v[168:171], v[36:39], a[180:183], v[168:171]
    s_add_u32 m0, s64, 0
    ds_read_b128 a[192:195], v12 offset:32768
    v_mfma_f32_16x16x32_bf16 v[176:179], v[36:39], a[184:187], v[176:179]
    ds_read_b128 a[196:199], v12 offset:34816
    ds_read_b128 a[200:203], v14 offset:32768
    v_mfma_f32_16x16x32_bf16 v[184:187], v[36:39], a[188:191], v[184:187]
    ds_read_b128 a[204:207], v14 offset:34816
    ds_read_b64_tr_b16 v[32:33], v18 offset:16384
    ds_read_b64_tr_b16 v[34:35], v18 offset:16896
    s_waitcnt lgkmcnt(6)
    v_mfma_f32_16x16x32_bf16 v[132:135], v[40:43], a[176:179], v[132:135]
    buffer_load_dwordx4 v4, s[44:47], s12 offen offset:0 lds
    v_mfma_f32_16x16x32_bf16 v[140:143], v[40:43], a[180:183], v[140:143]
    ds_read_b128 a[208:211], v13 offset:32768
    ds_read_b64_tr_b16 v[36:37], v18 offset:18432
    v_mfma_f32_16x16x32_bf16 v[148:151], v[40:43], a[184:187], v[148:151]
    buffer_load_dwordx4 v5, s[44:47], s12 offen offset:1024 lds
    v_mfma_f32_16x16x32_bf16 v[156:159], v[40:43], a[188:191], v[156:159]
    ds_read_b64_tr_b16 v[38:39], v18 offset:18944
    v_mfma_f32_16x16x32_bf16 v[164:167], v[44:47], a[176:179], v[164:167]
    ds_read_b128 a[212:215], v13 offset:34816
    ds_read_b64_tr_b16 v[40:41], v19 offset:16384
    v_mfma_f32_16x16x32_bf16 v[172:175], v[44:47], a[180:183], v[172:175]
    ds_read_b64_tr_b16 v[42:43], v19 offset:16896
    v_mfma_f32_16x16x32_bf16 v[180:183], v[44:47], a[184:187], v[180:183]
    buffer_load_dwordx4 v6, s[44:47], s12 offen offset:2048 lds
    v_mfma_f32_16x16x32_bf16 v[188:191], v[44:47], a[188:191], v[188:191]
    s_waitcnt lgkmcnt(3)
    v_mfma_f32_16x16x32_bf16 v[128:131], v[32:35], a[192:195], v[128:131]
    ds_read_b128 a[216:219], v15 offset:32768
    ds_read_b64_tr_b16 v[44:45], v19 offset:18432
    v_mfma_f32_16x16x32_bf16 v[136:139], v[32:35], a[196:199], v[136:139]
    buffer_load_dwordx4 v7, s[44:47], s12 offen offset:3072 lds
    v_mfma_f32_16x16x32_bf16 v[144:147], v[32:35], a[200:203], v[144:147]
    ds_read_b64_tr_b16 v[46:47], v19 offset:18944
    v_mfma_f32_16x16x32_bf16 v[152:155], v[32:35], a[204:207], v[152:155]
    v_mfma_f32_16x16x32_bf16 v[160:163], v[36:39], a[192:195], v[160:163]
    ds_read_b128 a[220:223], v15 offset:34816
    ds_read_b64_tr_b16 v[32:33], v18 offset:24576
    v_mfma_f32_16x16x32_bf16 v[168:171], v[36:39], a[196:199], v[168:171]
    s_add_u32 m0, s64, 114688
    ds_read_b64_tr_b16 v[34:35], v18 offset:25088
    v_mfma_f32_16x16x32_bf16 v[176:179], v[36:39], a[200:203], v[176:179]
    v_mfma_f32_16x16x32_bf16 v[184:187], v[36:39], a[204:207], v[184:187]
    s_waitcnt lgkmcnt(3)
    v_mfma_f32_16x16x32_bf16 v[132:135], v[40:43], a[192:195], v[132:135]
    buffer_load_dwordx4 v8, s[48:51], s22 offen offset:0 lds
    v_mfma_f32_16x16x32_bf16 v[140:143], v[40:43], a[196:199], v[140:143]
    ds_read_b64_tr_b16 v[36:37], v18 offset:26624
    ds_read_b64_tr_b16 v[38:39], v18 offset:27136
    v_mfma_f32_16x16x32_bf16 v[148:151], v[40:43], a[200:203], v[148:151]
    v_mfma_f32_16x16x32_bf16 v[156:159], v[40:43], a[204:207], v[156:159]
    buffer_load_dwordx4 v9, s[48:51], s22 offen offset:1024 lds
    v_mfma_f32_16x16x32_bf16 v[164:167], v[44:47], a[192:195], v[164:167]
    ds_read_b64_tr_b16 v[40:41], v19 offset:24576
    ds_read_b64_tr_b16 v[42:43], v19 offset:25088
    v_mfma_f32_16x16x32_bf16 v[172:175], v[44:47], a[196:199], v[172:175]
    v_mfma_f32_16x16x32_bf16 v[180:183], v[44:47], a[200:203], v[180:183]
    v_mfma_f32_16x16x32_bf16 v[188:191], v[44:47], a[204:207], v[188:191]
    s_waitcnt lgkmcnt(2)
    v_mfma_f32_16x16x32_bf16 v[128:131], v[32:35], a[208:211], v[128:131]
    buffer_load_dwordx4 v10, s[48:51], s22 offen offset:2048 lds
    v_mfma_f32_16x16x32_bf16 v[136:139], v[32:35], a[212:215], v[136:139]
    ds_read_b64_tr_b16 v[44:45], v19 offset:26624
    ds_read_b64_tr_b16 v[46:47], v19 offset:27136
    v_mfma_f32_16x16x32_bf16 v[144:147], v[32:35], a[216:219], v[144:147]
    buffer_load_dwordx4 v11, s[48:51], s22 offen offset:3072 lds
    v_mfma_f32_16x16x32_bf16 v[152:155], v[32:35], a[220:223], v[152:155]
    v_mfma_f32_16x16x32_bf16 v[160:163], v[36:39], a[208:211], v[160:163]
    s_waitcnt vmcnt(8)
    s_barrier
    v_mfma_f32_16x16x32_bf16 v[168:171], v[36:39], a[212:215], v[168:171]
    s_add_u32 m0, s64, 16384
    ds_read_b128 a[224:227], v12 offset:49152
    v_mfma_f32_16x16x32_bf16 v[176:179], v[36:39], a[216:219], v[176:179]
    ds_read_b128 a[228:231], v12 offset:51200
    ds_read_b128 a[232:235], v14 offset:49152
    v_mfma_f32_16x16x32_bf16 v[184:187], v[36:39], a[220:223], v[184:187]
    ds_read_b128 a[236:239], v14 offset:51200
    ds_read_b64_tr_b16 v[32:33], v18 offset:32768
    ds_read_b64_tr_b16 v[34:35], v18 offset:33280
    s_waitcnt lgkmcnt(6)
    v_mfma_f32_16x16x32_bf16 v[132:135], v[40:43], a[208:211], v[132:135]
    buffer_load_dwordx4 v4, s[44:47], s13 offen offset:0 lds
    v_mfma_f32_16x16x32_bf16 v[140:143], v[40:43], a[212:215], v[140:143]
    ds_read_b128 a[240:243], v13 offset:49152
    ds_read_b64_tr_b16 v[36:37], v18 offset:34816
    v_mfma_f32_16x16x32_bf16 v[148:151], v[40:43], a[216:219], v[148:151]
    buffer_load_dwordx4 v5, s[44:47], s13 offen offset:1024 lds
    v_mfma_f32_16x16x32_bf16 v[156:159], v[40:43], a[220:223], v[156:159]
    ds_read_b64_tr_b16 v[38:39], v18 offset:35328
    v_mfma_f32_16x16x32_bf16 v[164:167], v[44:47], a[208:211], v[164:167]
    ds_read_b128 a[244:247], v13 offset:51200
    ds_read_b64_tr_b16 v[40:41], v19 offset:32768
    v_mfma_f32_16x16x32_bf16 v[172:175], v[44:47], a[212:215], v[172:175]
    ds_read_b64_tr_b16 v[42:43], v19 offset:33280
    v_mfma_f32_16x16x32_bf16 v[180:183], v[44:47], a[216:219], v[180:183]
    buffer_load_dwordx4 v6, s[44:47], s13 offen offset:2048 lds
    v_mfma_f32_16x16x32_bf16 v[188:191], v[44:47], a[220:223], v[188:191]
    s_waitcnt lgkmcnt(3)
    v_mfma_f32_16x16x32_bf16 v[128:131], v[32:35], a[224:227], v[128:131]
    ds_read_b128 a[248:251], v15 offset:49152
    ds_read_b64_tr_b16 v[44:45], v19 offset:34816
    v_mfma_f32_16x16x32_bf16 v[136:139], v[32:35], a[228:231], v[136:139]
    buffer_load_dwordx4 v7, s[44:47], s13 offen offset:3072 lds
    v_mfma_f32_16x16x32_bf16 v[144:147], v[32:35], a[232:235], v[144:147]
    ds_read_b64_tr_b16 v[46:47], v19 offset:35328
    v_mfma_f32_16x16x32_bf16 v[152:155], v[32:35], a[236:239], v[152:155]
    v_mfma_f32_16x16x32_bf16 v[160:163], v[36:39], a[224:227], v[160:163]
    ds_read_b128 a[252:255], v15 offset:51200
    ds_read_b64_tr_b16 v[32:33], v18 offset:40960
    v_mfma_f32_16x16x32_bf16 v[168:171], v[36:39], a[228:231], v[168:171]
    s_add_u32 m0, s64, 65536
    ds_read_b64_tr_b16 v[34:35], v18 offset:41472
    v_mfma_f32_16x16x32_bf16 v[176:179], v[36:39], a[232:235], v[176:179]
    v_mfma_f32_16x16x32_bf16 v[184:187], v[36:39], a[236:239], v[184:187]
    s_waitcnt lgkmcnt(3)
    v_mfma_f32_16x16x32_bf16 v[132:135], v[40:43], a[224:227], v[132:135]
    buffer_load_dwordx4 v8, s[48:51], s23 offen offset:0 lds
    v_mfma_f32_16x16x32_bf16 v[140:143], v[40:43], a[228:231], v[140:143]
    ds_read_b64_tr_b16 v[36:37], v18 offset:43008
    ds_read_b64_tr_b16 v[38:39], v18 offset:43520
    v_mfma_f32_16x16x32_bf16 v[148:151], v[40:43], a[232:235], v[148:151]
    v_mfma_f32_16x16x32_bf16 v[156:159], v[40:43], a[236:239], v[156:159]
    buffer_load_dwordx4 v9, s[48:51], s23 offen offset:1024 lds
    v_mfma_f32_16x16x32_bf16 v[164:167], v[44:47], a[224:227], v[164:167]
    ds_read_b64_tr_b16 v[40:41], v19 offset:40960
    ds_read_b64_tr_b16 v[42:43], v19 offset:41472
    v_mfma_f32_16x16x32_bf16 v[172:175], v[44:47], a[228:231], v[172:175]
    v_mfma_f32_16x16x32_bf16 v[180:183], v[44:47], a[232:235], v[180:183]
    v_mfma_f32_16x16x32_bf16 v[188:191], v[44:47], a[236:239], v[188:191]
    s_waitcnt lgkmcnt(2)
    v_mfma_f32_16x16x32_bf16 v[128:131], v[32:35], a[240:243], v[128:131]
    buffer_load_dwordx4 v10, s[48:51], s23 offen offset:2048 lds
    v_mfma_f32_16x16x32_bf16 v[136:139], v[32:35], a[244:247], v[136:139]
    ds_read_b64_tr_b16 v[44:45], v19 offset:43008
    ds_read_b64_tr_b16 v[46:47], v19 offset:43520
    v_mfma_f32_16x16x32_bf16 v[144:147], v[32:35], a[248:251], v[144:147]
    buffer_load_dwordx4 v11, s[48:51], s23 offen offset:3072 lds
    v_mfma_f32_16x16x32_bf16 v[152:155], v[32:35], a[252:255], v[152:155]
    v_mfma_f32_16x16x32_bf16 v[160:163], v[36:39], a[240:243], v[160:163]
    s_waitcnt vmcnt(8)
    s_barrier
    v_mfma_f32_16x16x32_bf16 v[168:171], v[36:39], a[244:247], v[168:171]
    v_add_u32 v8, 0x80, v8
    ds_read_b128 v[64:67], v12 offset:0
    v_mfma_f32_16x16x32_bf16 v[176:179], v[36:39], a[248:251], v[176:179]
    ds_read_b128 v[68:71], v12 offset:2048
    ds_read_b128 v[72:75], v14 offset:0
    v_mfma_f32_16x16x32_bf16 v[184:187], v[36:39], a[252:255], v[184:187]
    ds_read_b128 v[76:79], v14 offset:2048
    ds_read_b64_tr_b16 v[32:33], v18 offset:49152
    ds_read_b64_tr_b16 v[34:35], v18 offset:49664
    s_waitcnt lgkmcnt(6)
    v_mfma_f32_16x16x32_bf16 v[132:135], v[40:43], a[240:243], v[132:135]
    v_add_u32 v9, 0x80, v9
    ds_read_b128 v[80:83], v13 offset:0
    v_mfma_f32_16x16x32_bf16 v[140:143], v[40:43], a[244:247], v[140:143]
    ds_read_b64_tr_b16 v[36:37], v18 offset:51200
    ds_read_b64_tr_b16 v[38:39], v18 offset:51712
    v_mfma_f32_16x16x32_bf16 v[148:151], v[40:43], a[248:251], v[148:151]
    s_add_u32 m0, s64, 81920
    v_mfma_f32_16x16x32_bf16 v[156:159], v[40:43], a[252:255], v[156:159]
    v_mfma_f32_16x16x32_bf16 v[164:167], v[44:47], a[240:243], v[164:167]
    ds_read_b128 v[84:87], v13 offset:2048
    ds_read_b64_tr_b16 v[40:41], v19 offset:49152
    v_mfma_f32_16x16x32_bf16 v[172:175], v[44:47], a[244:247], v[172:175]
    ds_read_b64_tr_b16 v[42:43], v19 offset:49664
    v_mfma_f32_16x16x32_bf16 v[180:183], v[44:47], a[248:251], v[180:183]
    buffer_load_dwordx4 v8, s[48:51], s14 offen offset:0 lds
    v_mfma_f32_16x16x32_bf16 v[188:191], v[44:47], a[252:255], v[188:191]
    s_waitcnt lgkmcnt(3)
    v_mfma_f32_16x16x32_bf16 v[128:131], v[32:35], v[64:67], v[128:131]
    ds_read_b128 v[88:91], v15 offset:0
    ds_read_b64_tr_b16 v[44:45], v19 offset:51200
    v_mfma_f32_16x16x32_bf16 v[136:139], v[32:35], v[68:71], v[136:139]
    buffer_load_dwordx4 v9, s[48:51], s14 offen offset:1024 lds
    v_mfma_f32_16x16x32_bf16 v[144:147], v[32:35], v[72:75], v[144:147]
L_ptA1:
    s_cbranch_execz L_ptdA
    ds_read_b64_tr_b16 v[46:47], v19 offset:51712
    v_mfma_f32_16x16x32_bf16 v[152:155], v[32:35], v[76:79], v[152:155]
    v_mfma_f32_16x16x32_bf16 v[160:163], v[36:39], v[64:67], v[160:163]
    ds_read_b128 v[92:95], v15 offset:2048
    ds_read_b64_tr_b16 v[32:33], v18 offset:57344
    v_mfma_f32_16x16x32_bf16 v[168:171], v[36:39], v[68:71], v[168:171]
    buffer_load_dwordx4 v10, s[48:51], s15 offen offset:2048 lds
    v_mfma_f32_16x16x32_bf16 v[176:179], v[36:39], v[72:75], v[176:179]
    ds_read_b64_tr_b16 v[34:35], v18 offset:57856
    v_mfma_f32_16x16x32_bf16 v[184:187], v[36:39], v[76:79], v[184:187]
    s_waitcnt lgkmcnt(3)
    v_mfma_f32_16x16x32_bf16 v[132:135], v[40:43], v[64:67], v[132:135]
    buffer_load_dwordx4 v11, s[48:51], s15 offen offset:3072 lds
    v_mfma_f32_16x16x32_bf16 v[140:143], v[40:43], v[68:71], v[140:143]
    ds_read_b64_tr_b16 v[36:37], v18 offset:59392
    ds_read_b64_tr_b16 v[38:39], v18 offset:59904
    v_mfma_f32_16x16x32_bf16 v[148:151], v[40:43], v[72:75], v[148:151]
    v_mfma_f32_16x16x32_bf16 v[156:159], v[40:43], v[76:79], v[156:159]
    s_add_u32 m0, s64, 32768
    v_mfma_f32_16x16x32_bf16 v[164:167], v[44:47], v[64:67], v[164:167]
    ds_read_b64_tr_b16 v[40:41], v19 offset:57344
    ds_read_b64_tr_b16 v[42:43], v19 offset:57856
    v_mfma_f32_16x16x32_bf16 v[172:175], v[44:47], v[68:71], v[172:175]
    v_mfma_f32_16x16x32_bf16 v[180:183], v[44:47], v[72:75], v[180:183]
    v_mfma_f32_16x16x32_bf16 v[188:191], v[44:47], v[76:79], v[188:191]
    s_waitcnt lgkmcnt(2)
    v_mfma_f32_16x16x32_bf16 v[128:131], v[32:35], v[80:83], v[128:131]
    buffer_load_dwordx4 v8, s[48:51], s16 offen offset:0 lds
    v_mfma_f32_16x16x32_bf16 v[136:139], v[32:35], v[84:87], v[136:139]
    ds_read_b64_tr_b16 v[44:45], v19 offset:59392
    ds_read_b64_tr_b16 v[46:47], v19 offset:59904
    v_mfma_f32_16x16x32_bf16 v[144:147], v[32:35], v[88:91], v[144:147]
    buffer_load_dwordx4 v9, s[48:51], s16 offen offset:1024 lds
    v_mfma_f32_16x16x32_bf16 v[152:155], v[32:35], v[92:95], v[152:155]
    buffer_load_dwordx4 v10, s[48:51], s17 offen offset:2048 lds
    buffer_load_dwordx4 v11, s[48:51], s17 offen offset:3072 lds
    v_mfma_f32_16x16x32_bf16 v[160:163], v[36:39], v[80:83], v[160:163]
    s_waitcnt vmcnt(8)
    s_barrier
    v_mfma_f32_16x16x32_bf16 v[168:171], v[36:39], v[84:87], v[168:171]
    v_add_u32 v8, 0x80, v8
    ds_read_b128 v[96:99], v12 offset:16384
    v_mfma_f32_16x16x32_bf16 v[176:179], v[36:39], v[88:91], v[176:179]
    ds_read_b128 v[100:103], v12 offset:18432
    ds_read_b128 v[104:107], v14 offset:16384
    v_mfma_f32_16x16x32_bf16 v[184:187], v[36:39], v[92:95], v[184:187]
    ds_read_b128 v[108:111], v14 offset:18432
    ds_read_b64_tr_b16 v[32:33], v18 offset:0
    ds_read_b64_tr_b16 v[34:35], v18 offset:512
    s_waitcnt lgkmcnt(6)
    v_mfma_f32_16x16x32_bf16 v[132:135], v[40:43], v[80:83], v[132:135]
    v_add_u32 v9, 0x80, v9
    ds_read_b128 v[112:115], v13 offset:16384
    v_mfma_f32_16x16x32_bf16 v[140:143], v[40:43], v[84:87], v[140:143]
    ds_read_b128 v[116:119], v13 offset:18432
    ds_read_b64_tr_b16 v[36:37], v19 offset:0
    v_mfma_f32_16x16x32_bf16 v[148:151], v[40:43], v[88:91], v[148:151]
    v_add_u32 v10, 0x80, v10
    ds_read_b64_tr_b16 v[38:39], v19 offset:512
    v_mfma_f32_16x16x32_bf16 v[156:159], v[40:43], v[92:95], v[156:159]
    v_mfma_f32_16x16x32_bf16 v[164:167], v[44:47], v[80:83], v[164:167]
    ds_read_b128 v[120:123], v15 offset:16384
    ds_read_b128 v[124:127], v15 offset:18432
    v_mfma_f32_16x16x32_bf16 v[172:175], v[44:47], v[84:87], v[172:175]
    ds_read_b64_tr_b16 v[40:41], v18 offset:8192
    ds_read_b64_tr_b16 v[42:43], v18 offset:8704
    v_mfma_f32_16x16x32_bf16 v[180:183], v[44:47], v[88:91], v[180:183]
    v_add_u32 v11, 0x80, v11
    v_mfma_f32_16x16x32_bf16 v[188:191], v[44:47], v[92:95], v[188:191]
    s_waitcnt lgkmcnt(4)
    v_mfma_f32_16x16x32_bf16 v[128:131], v[32:35], v[96:99], v[128:131]
    ds_read_b64_tr_b16 v[44:45], v19 offset:8192
    ds_read_b64_tr_b16 v[46:47], v19 offset:8704
    v_mfma_f32_16x16x32_bf16 v[136:139], v[32:35], v[100:103], v[136:139]
    s_add_u32 m0, s64, 98304
    v_mfma_f32_16x16x32_bf16 v[144:147], v[32:35], v[104:107], v[144:147]
    v_mfma_f32_16x16x32_bf16 v[152:155], v[32:35], v[108:111], v[152:155]
    v_mfma_f32_16x16x32_bf16 v[132:135], v[36:39], v[96:99], v[132:135]
    ds_read_b64_tr_b16 v[32:33], v18 offset:2048
    ds_read_b64_tr_b16 v[34:35], v18 offset:2560
    v_mfma_f32_16x16x32_bf16 v[140:143], v[36:39], v[100:103], v[140:143]
    buffer_load_dwordx4 v8, s[48:51], s14 offen offset:0 lds
    v_mfma_f32_16x16x32_bf16 v[148:151], v[36:39], v[104:107], v[148:151]
    v_mfma_f32_16x16x32_bf16 v[156:159], v[36:39], v[108:111], v[156:159]
    s_waitcnt lgkmcnt(2)
    v_mfma_f32_16x16x32_bf16 v[128:131], v[40:43], v[112:115], v[128:131]
    buffer_load_dwordx4 v9, s[48:51], s14 offen offset:1024 lds
    v_mfma_f32_16x16x32_bf16 v[136:139], v[40:43], v[116:119], v[136:139]
    ds_read_b64_tr_b16 v[36:37], v19 offset:2048
    ds_read_b64_tr_b16 v[38:39], v19 offset:2560
    v_mfma_f32_16x16x32_bf16 v[144:147], v[40:43], v[120:123], v[144:147]
    v_mfma_f32_16x16x32_bf16 v[152:155], v[40:43], v[124:127], v[152:155]
    buffer_load_dwordx4 v10, s[48:51], s15 offen offset:2048 lds
    v_mfma_f32_16x16x32_bf16 v[132:135], v[44:47], v[112:115], v[132:135]
    ds_read_b64_tr_b16 v[40:41], v18 offset:10240
    ds_read_b64_tr_b16 v[42:43], v18 offset:10752
    v_mfma_f32_16x16x32_bf16 v[140:143], v[44:47], v[116:119], v[140:143]
    v_mfma_f32_16x16x32_bf16 v[148:151], v[44:47], v[120:123], v[148:151]
    v_mfma_f32_16x16x32_bf16 v[156:159], v[44:47], v[124:127], v[156:159]
    s_waitcnt lgkmcnt(2)
    v_mfma_f32_16x16x32_bf16 v[160:163], v[32:35], v[96:99], v[160:163]
    buffer_load_dwordx4 v11, s[48:51], s15 offen offset:3072 lds
    v_mfma_f32_16x16x32_bf16 v[168:171], v[32:35], v[100:103], v[168:171]
    ds_read_b64_tr_b16 v[44:45], v19 offset:10240
    ds_read_b64_tr_b16 v[46:47], v19 offset:10752
    v_mfma_f32_16x16x32_bf16 v[176:179], v[32:35], v[104:107], v[176:179]
    s_add_u32 m0, s64, 49152
    v_mfma_f32_16x16x32_bf16 v[184:187], v[32:35], v[108:111], v[184:187]
    buffer_load_dwordx4 v8, s[48:51], s16 offen offset:0 lds
    v_mfma_f32_16x16x32_bf16 v[164:167], v[36:39], v[96:99], v[164:167]
    s_waitcnt vmcnt(9)
    s_barrier
    s_add_u32 s58, s56, 0
    s_add_u32 s59, s57, 0
    v_mul_f32_e64 v128, v128, |v128|
    v_mul_f32_e64 v129, v129, |v129|
    v_mfma_f32_16x16x32_bf16 v[172:175], v[36:39], v[100:103], v[172:175]
    v_mul_f32_e64 v130, v130, |v130|
    v_mul_f32_e64 v131, v131, |v131|
    v_mul_f32_e64 v132, v132, |v132|
    v_mul_f32_e64 v133, v133, |v133|
    v_mfma_f32_16x16x32_bf16 v[180:183], v[36:39], v[104:107], v[180:183]
    ds_read_b64_tr_b16 v[32:33], v18 offset:16384
    ds_read_b64_tr_b16 v[34:35], v18 offset:16896
    v_mul_f32_e64 v134, v134, |v134|
    v_mul_f32_e64 v135, v135, |v135|
    v_cvt_pk_bf16_f32 v48, v128, v129
    v_cvt_pk_bf16_f32 v49, v130, v131
    v_mfma_f32_16x16x32_bf16 v[188:191], v[36:39], v[108:111], v[188:191]
    v_cvt_pk_bf16_f32 v50, v132, v133
    v_cvt_pk_bf16_f32 v51, v134, v135
    v_pk_max_i16 v48, v48, 0
    v_pk_max_i16 v49, v49, 0
    s_waitcnt lgkmcnt(2)
    v_mfma_f32_16x16x32_bf16 v[160:163], v[40:43], v[112:115], v[160:163]
    v_pk_max_i16 v50, v50, 0
    v_pk_max_i16 v51, v51, 0
    buffer_store_dwordx4 v[48:51], v23, s[52:55], s58 offen offset:0 sc1
    v_mul_f32_e64 v136, v136, |v136|
    v_mfma_f32_16x16x32_bf16 v[168:171], v[40:43], v[116:119], v[168:171]
    v_mul_f32_e64 v137, v137, |v137|
    v_mul_f32_e64 v138, v138, |v138|
    v_mul_f32_e64 v139, v139, |v139|
    v_mul_f32_e64 v140, v140, |v140|
    v_mfma_f32_16x16x32_bf16 v[176:179], v[40:43], v[120:123], v[176:179]
    ds_read_b64_tr_b16 v[36:37], v19 offset:16384
    ds_read_b64_tr_b16 v[38:39], v19 offset:16896
    v_mul_f32_e64 v141, v141, |v141|
    v_mul_f32_e64 v142, v142, |v142|
    v_mul_f32_e64 v143, v143, |v143|
    v_cvt_pk_bf16_f32 v52, v136, v137
    v_mfma_f32_16x16x32_bf16 v[184:187], v[40:43], v[124:127], v[184:187]
    v_cvt_pk_bf16_f32 v53, v138, v139
    v_cvt_pk_bf16_f32 v54, v140, v141
    v_cvt_pk_bf16_f32 v55, v142, v143
    v_pk_max_i16 v52, v52, 0
    v_mfma_f32_16x16x32_bf16 v[164:167], v[44:47], v[112:115], v[164:167]
    v_pk_max_i16 v53, v53, 0
    v_pk_max_i16 v54, v54, 0
    v_pk_max_i16 v55, v55, 0
    buffer_store_dwordx4 v[52:55], v23, s[52:55], s58 offen offset:1024 sc1
    v_mfma_f32_16x16x32_bf16 v[172:175], v[44:47], v[116:119], v[172:175]
    v_mul_f32_e64 v144, v144, |v144|
    v_mul_f32_e64 v145, v145, |v145|
    v_mul_f32_e64 v146, v146, |v146|
    v_mul_f32_e64 v147, v147, |v147|
    v_mfma_f32_16x16x32_bf16 v[180:183], v[44:47], v[120:123], v[180:183]
    ds_read_b64_tr_b16 v[40:41], v18 offset:24576
    ds_read_b64_tr_b16 v[42:43], v18 offset:25088
    v_mul_f32_e64 v148, v148, |v148|
    v_mul_f32_e64 v149, v149, |v149|
    v_mul_f32_e64 v150, v150, |v150|
    v_mul_f32_e64 v151, v151, |v151|
    v_mfma_f32_16x16x32_bf16 v[188:191], v[44:47], v[124:127], v[188:191]
    v_cvt_pk_bf16_f32 v56, v144, v145
    v_cvt_pk_bf16_f32 v57, v146, v147
    v_cvt_pk_bf16_f32 v58, v148, v149
    v_cvt_pk_bf16_f32 v59, v150, v151
    s_waitcnt lgkmcnt(2)
    v_mfma_f32_16x16x32_bf16 v[160:163], v[32:35], a[0:3], v[160:163]
    v_pk_max_i16 v56, v56, 0
    v_pk_max_i16 v57, v57, 0
    v_pk_max_i16 v58, v58, 0
    v_pk_max_i16 v59, v59, 0
    v_mfma_f32_16x16x32_bf16 v[168:171], v[32:35], a[4:7], v[168:171]
    buffer_store_dwordx4 v[56:59], v23, s[52:55], s59 offen offset:0 sc1
    v_mul_f32_e64 v152, v152, |v152|
    v_mul_f32_e64 v153, v153, |v153|
    v_mul_f32_e64 v154, v154, |v154|
    v_mfma_f32_16x16x32_bf16 v[176:179], v[32:35], a[8:11], v[176:179]
    ds_read_b64_tr_b16 v[44:45], v19 offset:24576
    ds_read_b64_tr_b16 v[46:47], v19 offset:25088
    v_mul_f32_e64 v155, v155, |v155|
    v_mul_f32_e64 v156, v156, |v156|
    v_mul_f32_e64 v157, v157, |v157|
    v_mul_f32_e64 v158, v158, |v158|
    v_mfma_f32_16x16x32_bf16 v[184:187], v[32:35], a[12:15], v[184:187]
    v_mul_f32_e64 v159, v159, |v159|
    v_cvt_pk_bf16_f32 v60, v152, v153
    v_cvt_pk_bf16_f32 v61, v154, v155
    v_cvt_pk_bf16_f32 v62, v156, v157
    v_mfma_f32_16x16x32_bf16 v[164:167], v[36:39], a[0:3], v[164:167]
    v_cvt_pk_bf16_f32 v63, v158, v159
    v_pk_max_i16 v60, v60, 0
    v_pk_max_i16 v61, v61, 0
    v_pk_max_i16 v62, v62, 0
    v_mfma_f32_16x16x32_bf16 v[172:175], v[36:39], a[4:7], v[172:175]
    v_pk_max_i16 v63, v63, 0
    buffer_store_dwordx4 v[60:63], v23, s[52:55], s59 offen offset:1024 sc1
    v_mfma_f32_16x16x32_bf16 v[180:183], v[36:39], a[8:11], v[180:183]
    ds_read_b64_tr_b16 v[32:33], v18 offset:18432
    ds_read_b64_tr_b16 v[34:35], v18 offset:18944
    v_mfma_f32_16x16x32_bf16 v[188:191], v[36:39], a[12:15], v[188:191]
    s_waitcnt lgkmcnt(2)
    v_mfma_f32_16x16x32_bf16 v[160:163], v[40:43], a[16:19], v[160:163]
    buffer_load_dwordx4 v9, s[48:51], s16 offen offset:1024 lds
    v_mfma_f32_16x16x32_bf16 v[168:171], v[40:43], a[20:23], v[168:171]
    buffer_load_dwordx4 v10, s[48:51], s17 offen offset:2048 lds
    v_mfma_f32_16x16x32_bf16 v[176:179], v[40:43], a[24:27], v[176:179]
    ds_read_b64_tr_b16 v[36:37], v19 offset:18432
    ds_read_b64_tr_b16 v[38:39], v19 offset:18944
    v_mfma_f32_16x16x32_bf16 v[184:187], v[40:43], a[28:31], v[184:187]
    buffer_load_dwordx4 v11, s[48:51], s17 offen offset:3072 lds
    v_mfma_f32_16x16x32_bf16 v[164:167], v[44:47], a[16:19], v[164:167]
    s_add_u32 m0, s64, 114688
    ds_read_b64_tr_b16 v[40:41], v18 offset:26624
    v_mfma_f32_16x16x32_bf16 v[172:175], v[44:47], a[20:23], v[172:175]
    buffer_load_dwordx4 v8, s[48:51], s18 offen offset:0 lds
    v_mfma_f32_16x16x32_bf16 v[180:183], v[44:47], a[24:27], v[180:183]
    ds_read_b64_tr_b16 v[42:43], v18 offset:27136
    v_mfma_f32_16x16x32_bf16 v[188:191], v[44:47], a[28:31], v[188:191]
    s_waitcnt lgkmcnt(2)
    v_mfma_f32_16x16x32_bf16 v[160:163], v[32:35], a[32:35], v[160:163]
    buffer_load_dwordx4 v9, s[48:51], s18 offen offset:1024 lds
    v_mfma_f32_16x16x32_bf16 v[168:171], v[32:35], a[36:39], v[168:171]
    buffer_load_dwordx4 v10, s[48:51], s19 offen offset:2048 lds
    v_mfma_f32_16x16x32_bf16 v[176:179], v[32:35], a[40:43], v[176:179]
    ds_read_b64_tr_b16 v[44:45], v19 offset:26624
    ds_read_b64_tr_b16 v[46:47], v19 offset:27136
    v_mfma_f32_16x16x32_bf16 v[184:187], v[32:35], a[44:47], v[184:187]
    buffer_load_dwordx4 v11, s[48:51], s19 offen offset:3072 lds
    v_mfma_f32_16x16x32_bf16 v[164:167], v[36:39], a[32:35], v[164:167]
    s_waitcnt vmcnt(16)
    s_barrier
    v_mfma_f32_16x16x32_bf16 v[172:175], v[36:39], a[36:39], v[172:175]
    s_add_u32 m0, s64, 0
    ds_read_b64_tr_b16 v[32:33], v16 offset:32768
    v_mfma_f32_16x16x32_bf16 v[180:183], v[36:39], a[40:43], v[180:183]
    ds_read_b64_tr_b16 v[34:35], v16 offset:33280
    v_mfma_f32_16x16x32_bf16 v[188:191], v[36:39], a[44:47], v[188:191]
    s_waitcnt lgkmcnt(2)
    v_mfma_f32_16x16x32_bf16 v[160:163], v[40:43], a[48:51], v[160:163]
    buffer_load_dwordx4 v8, s[48:51], s20 offen offset:0 lds
    v_mfma_f32_16x16x32_bf16 v[168:171], v[40:43], a[52:55], v[168:171]
    ds_read_b64_tr_b16 v[36:37], v17 offset:32768
    ds_read_b64_tr_b16 v[38:39], v17 offset:33280
    v_mfma_f32_16x16x32_bf16 v[176:179], v[40:43], a[56:59], v[176:179]
    buffer_load_dwordx4 v9, s[48:51], s20 offen offset:1024 lds
    v_mfma_f32_16x16x32_bf16 v[184:187], v[40:43], a[60:63], v[184:187]
    v_mfma_f32_16x16x32_bf16 v[164:167], v[44:47], a[48:51], v[164:167]
    ds_read_b64_tr_b16 v[40:41], v16 offset:40960
    ds_read_b64_tr_b16 v[42:43], v16 offset:41472
    v_mfma_f32_16x16x32_bf16 v[172:175], v[44:47], a[52:55], v[172:175]
    v_mfma_f32_16x16x32_bf16 v[180:183], v[44:47], a[56:59], v[180:183]
    buffer_load_dwordx4 v10, s[48:51], s21 offen offset:2048 lds
    v_mfma_f32_16x16x32_bf16 v[188:191], v[44:47], a[60:63], v[188:191]
    s_waitcnt lgkmcnt(2)
    v_mfma_f32_16x16x32_bf16 v[160:163], v[32:35], a[64:67], v[160:163]
    ds_read_b64_tr_b16 v[44:45], v17 offset:40960
    ds_read_b64_tr_b16 v[46:47], v17 offset:41472
    v_mfma_f32_16x16x32_bf16 v[168:171], v[32:35], a[68:71], v[168:171]
    buffer_load_dwordx4 v11, s[48:51], s21 offen offset:3072 lds
    v_mfma_f32_16x16x32_bf16 v[176:179], v[32:35], a[72:75], v[176:179]
    v_mfma_f32_16x16x32_bf16 v[184:187], v[32:35], a[76:79], v[184:187]
    v_mfma_f32_16x16x32_bf16 v[164:167], v[36:39], a[64:67], v[164:167]
    ds_read_b64_tr_b16 v[32:33], v16 offset:34816
    ds_read_b64_tr_b16 v[34:35], v16 offset:35328
    v_mfma_f32_16x16x32_bf16 v[172:175], v[36:39], a[68:71], v[172:175]
    v_mfma_f32_16x16x32_bf16 v[180:183], v[36:39], a[72:75], v[180:183]
    v_mfma_f32_16x16x32_bf16 v[188:191], v[36:39], a[76:79], v[188:191]
    s_waitcnt lgkmcnt(2)
    v_mfma_f32_16x16x32_bf16 v[160:163], v[40:43], a[80:83], v[160:163]
    ds_read_b64_tr_b16 v[36:37], v17 offset:34816
    ds_read_b64_tr_b16 v[38:39], v17 offset:35328
    v_mfma_f32_16x16x32_bf16 v[168:171], v[40:43], a[84:87], v[168:171]
    v_mfma_f32_16x16x32_bf16 v[176:179], v[40:43], a[88:91], v[176:179]
    v_mfma_f32_16x16x32_bf16 v[184:187], v[40:43], a[92:95], v[184:187]
    v_mfma_f32_16x16x32_bf16 v[164:167], v[44:47], a[80:83], v[164:167]
    ds_read_b64_tr_b16 v[40:41], v16 offset:43008
    ds_read_b64_tr_b16 v[42:43], v16 offset:43520
    v_mfma_f32_16x16x32_bf16 v[172:175], v[44:47], a[84:87], v[172:175]
    s_waitcnt vmcnt(11)
    buffer_atomic_swap v28, v29, s[52:55], s43 offen offset:0 sc1
    v_mfma_f32_16x16x32_bf16 v[180:183], v[44:47], a[88:91], v[180:183]
    v_mfma_f32_16x16x32_bf16 v[188:191], v[44:47], a[92:95], v[188:191]
    s_waitcnt lgkmcnt(2)
    v_mfma_f32_16x16x32_bf16 v[160:163], v[32:35], a[96:99], v[160:163]
    ds_read_b64_tr_b16 v[44:45], v17 offset:43008
    ds_read_b64_tr_b16 v[46:47], v17 offset:43520
    v_mfma_f32_16x16x32_bf16 v[168:171], v[32:35], a[100:103], v[168:171]
    v_mfma_f32_16x16x32_bf16 v[176:179], v[32:35], a[104:107], v[176:179]
    v_mfma_f32_16x16x32_bf16 v[184:187], v[32:35], a[108:111], v[184:187]
    v_mfma_f32_16x16x32_bf16 v[164:167], v[36:39], a[96:99], v[164:167]
    s_barrier
    v_mfma_f32_16x16x32_bf16 v[172:175], v[36:39], a[100:103], v[172:175]
    s_add_u32 m0, s64, 65536
    ds_read_b64_tr_b16 v[32:33], v18 offset:32768
    v_mfma_f32_16x16x32_bf16 v[180:183], v[36:39], a[104:107], v[180:183]
    ds_read_b64_tr_b16 v[34:35], v18 offset:33280
    v_mfma_f32_16x16x32_bf16 v[188:191], v[36:39], a[108:111], v[188:191]
    s_waitcnt lgkmcnt(2)
    v_mfma_f32_16x16x32_bf16 v[160:163], v[40:43], a[112:115], v[160:163]
    buffer_load_dwordx4 v8, s[48:51], s22 offen offset:0 lds
    v_mfma_f32_16x16x32_bf16 v[168:171], v[40:43], a[116:119], v[168:171]
    ds_read_b64_tr_b16 v[36:37], v19 offset:32768
    ds_read_b64_tr_b16 v[38:39], v19 offset:33280
    v_mfma_f32_16x16x32_bf16 v[176:179], v[40:43], a[120:123], v[176:179]
    buffer_load_dwordx4 v9, s[48:51], s22 offen offset:1024 lds
    v_mfma_f32_16x16x32_bf16 v[184:187], v[40:43], a[124:127], v[184:187]
    v_mfma_f32_16x16x32_bf16 v[164:167], v[44:47], a[112:115], v[164:167]
    ds_read_b64_tr_b16 v[40:41], v18 offset:40960
    ds_read_b64_tr_b16 v[42:43], v18 offset:41472
    v_mfma_f32_16x16x32_bf16 v[172:175], v[44:47], a[116:119], v[172:175]
    v_mfma_f32_16x16x32_bf16 v[180:183], v[44:47], a[120:123], v[180:183]
    buffer_load_dwordx4 v10, s[48:51], s23 offen offset:2048 lds
    v_mfma_f32_16x16x32_bf16 v[188:191], v[44:47], a[124:127], v[188:191]
    s_waitcnt lgkmcnt(2)
    v_mfma_f32_16x16x32_bf16 v[192:195], v[32:35], a[0:3], v[192:195]
    ds_read_b64_tr_b16 v[44:45], v19 offset:40960
    ds_read_b64_tr_b16 v[46:47], v19 offset:41472
    v_mfma_f32_16x16x32_bf16 v[200:203], v[32:35], a[4:7], v[200:203]
    buffer_load_dwordx4 v11, s[48:51], s23 offen offset:3072 lds
    v_mfma_f32_16x16x32_bf16 v[208:211], v[32:35], a[8:11], v[208:211]
    v_mfma_f32_16x16x32_bf16 v[216:219], v[32:35], a[12:15], v[216:219]
    s_add_u32 s58, s56, 24576
    s_add_u32 s59, s57, 24576
    v_mfma_f32_16x16x32_bf16 v[196:199], v[36:39], a[0:3], v[196:199]
    ds_read_b64_tr_b16 v[32:33], v18 offset:34816
    ds_read_b64_tr_b16 v[34:35], v18 offset:35328
    v_mfma_f32_16x16x32_bf16 v[204:207], v[36:39], a[4:7], v[204:207]
    v_mul_f32_e64 v160, v160, |v160|
    v_mul_f32_e64 v161, v161, |v161|
    v_mfma_f32_16x16x32_bf16 v[212:215], v[36:39], a[8:11], v[212:215]
    v_mul_f32_e64 v162, v162, |v162|
    v_mul_f32_e64 v163, v163, |v163|
    v_mfma_f32_16x16x32_bf16 v[220:223], v[36:39], a[12:15], v[220:223]
    v_mul_f32_e64 v164, v164, |v164|
    v_mul_f32_e64 v165, v165, |v165|
    s_waitcnt lgkmcnt(2)
    v_mfma_f32_16x16x32_bf16 v[192:195], v[40:43], a[16:19], v[192:195]
    v_mul_f32_e64 v166, v166, |v166|
    v_mul_f32_e64 v167, v167, |v167|
    v_mfma_f32_16x16x32_bf16 v[200:203], v[40:43], a[20:23], v[200:203]
    v_cvt_pk_bf16_f32 v48, v160, v161
    v_cvt_pk_bf16_f32 v49, v162, v163
    v_mfma_f32_16x16x32_bf16 v[208:211], v[40:43], a[24:27], v[208:211]
    ds_read_b64_tr_b16 v[36:37], v19 offset:34816
    ds_read_b64_tr_b16 v[38:39], v19 offset:35328
    v_cvt_pk_bf16_f32 v50, v164, v165
    v_cvt_pk_bf16_f32 v51, v166, v167
    v_mfma_f32_16x16x32_bf16 v[216:219], v[40:43], a[28:31], v[216:219]
    v_pk_max_i16 v48, v48, 0
    v_pk_max_i16 v49, v49, 0
    v_mfma_f32_16x16x32_bf16 v[196:199], v[44:47], a[16:19], v[196:199]
    v_pk_max_i16 v50, v50, 0
    v_pk_max_i16 v51, v51, 0
    v_mfma_f32_16x16x32_bf16 v[204:207], v[44:47], a[20:23], v[204:207]
    buffer_store_dwordx4 v[48:51], v23, s[52:55], s58 offen offset:0 sc1
    v_mul_f32_e64 v168, v168, |v168|
    v_mfma_f32_16x16x32_bf16 v[212:215], v[44:47], a[24:27], v[212:215]
    ds_read_b64_tr_b16 v[40:41], v18 offset:43008
    ds_read_b64_tr_b16 v[42:43], v18 offset:43520
    v_mul_f32_e64 v169, v169, |v169|
    v_mul_f32_e64 v170, v170, |v170|
    v_mfma_f32_16x16x32_bf16 v[220:223], v[44:47], a[28:31], v[220:223]
    v_mul_f32_e64 v171, v171, |v171|
    v_mul_f32_e64 v172, v172, |v172|
    s_waitcnt lgkmcnt(2)
    v_mfma_f32_16x16x32_bf16 v[192:195], v[32:35], a[32:35], v[192:195]
    v_mul_f32_e64 v173, v173, |v173|
    v_mul_f32_e64 v174, v174, |v174|
    v_mfma_f32_16x16x32_bf16 v[200:203], v[32:35], a[36:39], v[200:203]
    v_mul_f32_e64 v175, v175, |v175|
    v_cvt_pk_bf16_f32 v52, v168, v169
    v_mfma_f32_16x16x32_bf16 v[208:211], v[32:35], a[40:43], v[208:211]
    ds_read_b64_tr_b16 v[44:45], v19 offset:43008
    ds_read_b64_tr_b16 v[46:47], v19 offset:43520
    v_cvt_pk_bf16_f32 v53, v170, v171
    v_cvt_pk_bf16_f32 v54, v172, v173
    v_mfma_f32_16x16x32_bf16 v[216:219], v[32:35], a[44:47], v[216:219]
    v_cvt_pk_bf16_f32 v55, v174, v175
    v_pk_max_i16 v52, v52, 0
    v_mfma_f32_16x16x32_bf16 v[196:199], v[36:39], a[32:35], v[196:199]
    s_waitcnt vmcnt(14)
    s_barrier
    v_pk_max_i16 v53, v53, 0
    v_pk_max_i16 v54, v54, 0
    v_mfma_f32_16x16x32_bf16 v[204:207], v[36:39], a[36:39], v[204:207]
    v_pk_max_i16 v55, v55, 0
    buffer_store_dwordx4 v[52:55], v23, s[52:55], s58 offen offset:1024 sc1
    v_mfma_f32_16x16x32_bf16 v[212:215], v[36:39], a[40:43], v[212:215]
    ds_read_b64_tr_b16 v[32:33], v16 offset:49152
    ds_read_b64_tr_b16 v[34:35], v16 offset:49664
    v_mul_f32_e64 v176, v176, |v176|
    v_mul_f32_e64 v177, v177, |v177|
    v_mfma_f32_16x16x32_bf16 v[220:223], v[36:39], a[44:47], v[220:223]
    v_mul_f32_e64 v178, v178, |v178|
    v_mul_f32_e64 v179, v179, |v179|
    s_waitcnt lgkmcnt(2)
    v_mfma_f32_16x16x32_bf16 v[192:195], v[40:43], a[48:51], v[192:195]
    v_mul_f32_e64 v180, v180, |v180|
    v_mul_f32_e64 v181, v181, |v181|
    v_mfma_f32_16x16x32_bf16 v[200:203], v[40:43], a[52:55], v[200:203]
    v_mul_f32_e64 v182, v182, |v182|
    v_mul_f32_e64 v183, v183, |v183|
    v_mfma_f32_16x16x32_bf16 v[208:211], v[40:43], a[56:59], v[208:211]
    ds_read_b64_tr_b16 v[36:37], v17 offset:49152
    ds_read_b64_tr_b16 v[38:39], v17 offset:49664
    v_cvt_pk_bf16_f32 v56, v176, v177
    v_cvt_pk_bf16_f32 v57, v178, v179
    v_mfma_f32_16x16x32_bf16 v[216:219], v[40:43], a[60:63], v[216:219]
    v_cvt_pk_bf16_f32 v58, v180, v181
    v_cvt_pk_bf16_f32 v59, v182, v183
    v_mfma_f32_16x16x32_bf16 v[196:199], v[44:47], a[48:51], v[196:199]
    v_pk_max_i16 v56, v56, 0
    v_pk_max_i16 v57, v57, 0
    v_mfma_f32_16x16x32_bf16 v[204:207], v[44:47], a[52:55], v[204:207]
    v_pk_max_i16 v58, v58, 0
    v_pk_max_i16 v59, v59, 0
    v_mfma_f32_16x16x32_bf16 v[212:215], v[44:47], a[56:59], v[212:215]
    ds_read_b64_tr_b16 v[40:41], v16 offset:57344
    ds_read_b64_tr_b16 v[42:43], v16 offset:57856
    buffer_store_dwordx4 v[56:59], v23, s[52:55], s59 offen offset:0 sc1
    v_mul_f32_e64 v184, v184, |v184|
    v_mfma_f32_16x16x32_bf16 v[220:223], v[44:47], a[60:63], v[220:223]
    v_mul_f32_e64 v185, v185, |v185|
    v_mul_f32_e64 v186, v186, |v186|
    s_waitcnt lgkmcnt(2)
    v_mfma_f32_16x16x32_bf16 v[192:195], v[32:35], a[64:67], v[192:195]
    v_mul_f32_e64 v187, v187, |v187|
    v_mul_f32_e64 v188, v188, |v188|
    v_mfma_f32_16x16x32_bf16 v[200:203], v[32:35], a[68:71], v[200:203]
    v_mul_f32_e64 v189, v189, |v189|
    v_mul_f32_e64 v190, v190, |v190|
    v_mfma_f32_16x16x32_bf16 v[208:211], v[32:35], a[72:75], v[208:211]
    ds_read_b64_tr_b16 v[44:45], v17 offset:57344
    ds_read_b64_tr_b16 v[46:47], v17 offset:57856
    v_mul_f32_e64 v191, v191, |v191|
    v_cvt_pk_bf16_f32 v60, v184, v185
    v_mfma_f32_16x16x32_bf16 v[216:219], v[32:35], a[76:79], v[216:219]
    v_cvt_pk_bf16_f32 v61, v186, v187
    v_cvt_pk_bf16_f32 v62, v188, v189
    v_mfma_f32_16x16x32_bf16 v[196:199], v[36:39], a[64:67], v[196:199]
    v_cvt_pk_bf16_f32 v63, v190, v191
    v_pk_max_i16 v60, v60, 0
    v_mfma_f32_16x16x32_bf16 v[204:207], v[36:39], a[68:71], v[204:207]
    v_pk_max_i16 v61, v61, 0
    v_pk_max_i16 v62, v62, 0
    v_mfma_f32_16x16x32_bf16 v[212:215], v[36:39], a[72:75], v[212:215]
    ds_read_b64_tr_b16 v[32:33], v16 offset:51200
    ds_read_b64_tr_b16 v[34:35], v16 offset:51712
    v_pk_max_i16 v63, v63, 0
    buffer_store_dwordx4 v[60:63], v23, s[52:55], s59 offen offset:1024 sc1
    v_mfma_f32_16x16x32_bf16 v[220:223], v[36:39], a[76:79], v[220:223]
    v_add_u32 v8, 0x80, v8
    s_waitcnt lgkmcnt(2)
    v_mfma_f32_16x16x32_bf16 v[192:195], v[40:43], a[80:83], v[192:195]
    v_add_u32 v9, 0x80, v9
    v_add_u32 v10, 0x80, v10
    v_mfma_f32_16x16x32_bf16 v[200:203], v[40:43], a[84:87], v[200:203]
    v_add_u32 v11, 0x80, v11
    s_add_u32 m0, s64, 16384
    v_mfma_f32_16x16x32_bf16 v[208:211], v[40:43], a[88:91], v[208:211]
    ds_read_b64_tr_b16 v[36:37], v17 offset:51200
    ds_read_b64_tr_b16 v[38:39], v17 offset:51712
    v_mfma_f32_16x16x32_bf16 v[216:219], v[40:43], a[92:95], v[216:219]
    buffer_load_dwordx4 v8, s[48:51], s14 offen offset:0 lds
    v_mfma_f32_16x16x32_bf16 v[196:199], v[44:47], a[80:83], v[196:199]
    buffer_load_dwordx4 v9, s[48:51], s14 offen offset:1024 lds
    v_mfma_f32_16x16x32_bf16 v[204:207], v[44:47], a[84:87], v[204:207]
    buffer_load_dwordx4 v10, s[48:51], s15 offen offset:2048 lds
    v_mfma_f32_16x16x32_bf16 v[212:215], v[44:47], a[88:91], v[212:215]
    ds_read_b64_tr_b16 v[40:41], v16 offset:59392
    ds_read_b64_tr_b16 v[42:43], v16 offset:59904
    v_mfma_f32_16x16x32_bf16 v[220:223], v[44:47], a[92:95], v[220:223]
    s_lshl_b32 s67, s65, 10
    s_waitcnt lgkmcnt(2)
    v_mfma_f32_16x16x32_bf16 v[192:195], v[32:35], a[96:99], v[192:195]
    buffer_load_dwordx4 v11, s[48:51], s15 offen offset:3072 lds
    v_mfma_f32_16x16x32_bf16 v[200:203], v[32:35], a[100:103], v[200:203]
    ds_read_b64_tr_b16 v[44:45], v17 offset:59392
    ds_read_b64_tr_b16 v[46:47], v17 offset:59904
    v_mfma_f32_16x16x32_bf16 v[208:211], v[32:35], a[104:107], v[208:211]
    s_add_u32 s67, s67, 11534336
    s_lshl_b32 s68, s61, 7
    v_mfma_f32_16x16x32_bf16 v[216:219], v[32:35], a[108:111], v[216:219]
    v_lshl_add_u32 v25, v2, 2, s68
    buffer_store_dword v31, v25, s[52:55], s67 offen sc1
    v_mfma_f32_16x16x32_bf16 v[196:199], v[36:39], a[96:99], v[196:199]
    s_waitcnt vmcnt(14)
    s_barrier
    v_mfma_f32_16x16x32_bf16 v[204:207], v[36:39], a[100:103], v[204:207]
    s_add_u32 m0, s64, 81920
    ds_read_b64_tr_b16 v[32:33], v18 offset:49152
    v_mfma_f32_16x16x32_bf16 v[212:215], v[36:39], a[104:107], v[212:215]
    ds_read_b64_tr_b16 v[34:35], v18 offset:49664
    v_mfma_f32_16x16x32_bf16 v[220:223], v[36:39], a[108:111], v[220:223]
    s_waitcnt lgkmcnt(2)
    v_mfma_f32_16x16x32_bf16 v[192:195], v[40:43], a[112:115], v[192:195]
    buffer_load_dwordx4 v8, s[48:51], s16 offen offset:0 lds
    v_mfma_f32_16x16x32_bf16 v[200:203], v[40:43], a[116:119], v[200:203]
    ds_read_b64_tr_b16 v[36:37], v19 offset:49152
    ds_read_b64_tr_b16 v[38:39], v19 offset:49664
    v_mfma_f32_16x16x32_bf16 v[208:211], v[40:43], a[120:123], v[208:211]
    buffer_load_dwordx4 v9, s[48:51], s16 offen offset:1024 lds
    v_mfma_f32_16x16x32_bf16 v[216:219], v[40:43], a[124:127], v[216:219]
    v_mfma_f32_16x16x32_bf16 v[196:199], v[44:47], a[112:115], v[196:199]
    ds_read_b64_tr_b16 v[40:41], v18 offset:57344
    ds_read_b64_tr_b16 v[42:43], v18 offset:57856
    v_mfma_f32_16x16x32_bf16 v[204:207], v[44:47], a[116:119], v[204:207]
    v_mfma_f32_16x16x32_bf16 v[212:215], v[44:47], a[120:123], v[212:215]
    buffer_load_dwordx4 v10, s[48:51], s17 offen offset:2048 lds
    v_mfma_f32_16x16x32_bf16 v[220:223], v[44:47], a[124:127], v[220:223]
    s_waitcnt lgkmcnt(2)
    v_mfma_f32_16x16x32_bf16 v[192:195], v[32:35], a[128:131], v[192:195]
    ds_read_b64_tr_b16 v[44:45], v19 offset:57344
    ds_read_b64_tr_b16 v[46:47], v19 offset:57856
    v_mfma_f32_16x16x32_bf16 v[200:203], v[32:35], a[132:135], v[200:203]
    buffer_load_dwordx4 v11, s[48:51], s17 offen offset:3072 lds
    v_mfma_f32_16x16x32_bf16 v[208:211], v[32:35], a[136:139], v[208:211]
    v_mfma_f32_16x16x32_bf16 v[216:219], v[32:35], a[140:143], v[216:219]
    v_mfma_f32_16x16x32_bf16 v[196:199], v[36:39], a[128:131], v[196:199]
L_ptA2:
    s_cbranch_execz L_ptdA
    ds_read_b64_tr_b16 v[32:33], v18 offset:51200
    ds_read_b64_tr_b16 v[34:35], v18 offset:51712
    v_mfma_f32_16x16x32_bf16 v[204:207], v[36:39], a[132:135], v[204:207]
    v_mfma_f32_16x16x32_bf16 v[212:215], v[36:39], a[136:139], v[212:215]
    v_mfma_f32_16x16x32_bf16 v[220:223], v[36:39], a[140:143], v[220:223]
    s_waitcnt lgkmcnt(2)
    v_mfma_f32_16x16x32_bf16 v[192:195], v[40:43], a[144:147], v[192:195]
    ds_read_b64_tr_b16 v[36:37], v19 offset:51200
    ds_read_b64_tr_b16 v[38:39], v19 offset:51712
    v_mfma_f32_16x16x32_bf16 v[200:203], v[40:43], a[148:151], v[200:203]
    v_mfma_f32_16x16x32_bf16 v[208:211], v[40:43], a[152:155], v[208:211]
    v_mfma_f32_16x16x32_bf16 v[216:219], v[40:43], a[156:159], v[216:219]
    v_mfma_f32_16x16x32_bf16 v[196:199], v[44:47], a[144:147], v[196:199]
    ds_read_b64_tr_b16 v[40:41], v18 offset:59392
    ds_read_b64_tr_b16 v[42:43], v18 offset:59904
    v_mfma_f32_16x16x32_bf16 v[204:207], v[44:47], a[148:151], v[204:207]
    v_mfma_f32_16x16x32_bf16 v[212:215], v[44:47], a[152:155], v[212:215]
    s_waitcnt vmcnt(9)
    buffer_atomic_swap v28, v29, s[52:55], s43 offen offset:256 sc1
    v_mfma_f32_16x16x32_bf16 v[220:223], v[44:47], a[156:159], v[220:223]
    s_waitcnt lgkmcnt(2)
    v_mfma_f32_16x16x32_bf16 v[192:195], v[32:35], a[160:163], v[192:195]
    ds_read_b64_tr_b16 v[44:45], v19 offset:59392
    ds_read_b64_tr_b16 v[46:47], v19 offset:59904
    v_mfma_f32_16x16x32_bf16 v[200:203], v[32:35], a[164:167], v[200:203]
    v_mfma_f32_16x16x32_bf16 v[208:211], v[32:35], a[168:171], v[208:211]
    v_mfma_f32_16x16x32_bf16 v[216:219], v[32:35], a[172:175], v[216:219]
    v_mfma_f32_16x16x32_bf16 v[196:199], v[36:39], a[160:163], v[196:199]
    s_add_u32 m0, s64, 32768
    ds_read_b64_tr_b16 v[32:33], v16 offset:0
    v_mfma_f32_16x16x32_bf16 v[204:207], v[36:39], a[164:167], v[204:207]
    ds_read_b64_tr_b16 v[34:35], v16 offset:512
    v_mfma_f32_16x16x32_bf16 v[212:215], v[36:39], a[168:171], v[212:215]
    v_mfma_f32_16x16x32_bf16 v[220:223], v[36:39], a[172:175], v[220:223]
    s_waitcnt lgkmcnt(2)
    v_mfma_f32_16x16x32_bf16 v[192:195], v[40:43], a[176:179], v[192:195]
    buffer_load_dwordx4 v8, s[48:51], s18 offen offset:0 lds
    v_mfma_f32_16x16x32_bf16 v[200:203], v[40:43], a[180:183], v[200:203]
    ds_read_b64_tr_b16 v[36:37], v17 offset:0
    ds_read_b64_tr_b16 v[38:39], v17 offset:512
    v_mfma_f32_16x16x32_bf16 v[208:211], v[40:43], a[184:187], v[208:211]
    buffer_load_dwordx4 v9, s[48:51], s18 offen offset:1024 lds
    v_mfma_f32_16x16x32_bf16 v[216:219], v[40:43], a[188:191], v[216:219]
    v_mfma_f32_16x16x32_bf16 v[196:199], v[44:47], a[176:179], v[196:199]
    ds_read_b64_tr_b16 v[40:41], v16 offset:8192
    ds_read_b64_tr_b16 v[42:43], v16 offset:8704
    v_mfma_f32_16x16x32_bf16 v[204:207], v[44:47], a[180:183], v[204:207]
    v_mfma_f32_16x16x32_bf16 v[212:215], v[44:47], a[184:187], v[212:215]
    buffer_load_dwordx4 v10, s[48:51], s19 offen offset:2048 lds
    v_mfma_f32_16x16x32_bf16 v[220:223], v[44:47], a[188:191], v[220:223]
    s_waitcnt lgkmcnt(2)
    v_mfma_f32_16x16x32_bf16 v[192:195], v[32:35], a[192:195], v[192:195]
    ds_read_b64_tr_b16 v[44:45], v17 offset:8192
    ds_read_b64_tr_b16 v[46:47], v17 offset:8704
    v_mfma_f32_16x16x32_bf16 v[200:203], v[32:35], a[196:199], v[200:203]
    buffer_load_dwordx4 v11, s[48:51], s19 offen offset:3072 lds
    v_mfma_f32_16x16x32_bf16 v[208:211], v[32:35], a[200:203], v[208:211]
    v_mfma_f32_16x16x32_bf16 v[216:219], v[32:35], a[204:207], v[216:219]
    v_mfma_f32_16x16x32_bf16 v[196:199], v[36:39], a[192:195], v[196:199]
    ds_read_b64_tr_b16 v[32:33], v16 offset:2048
    ds_read_b64_tr_b16 v[34:35], v16 offset:2560
    v_mfma_f32_16x16x32_bf16 v[204:207], v[36:39], a[196:199], v[204:207]
    v_mfma_f32_16x16x32_bf16 v[212:215], v[36:39], a[200:203], v[212:215]
    v_mfma_f32_16x16x32_bf16 v[220:223], v[36:39], a[204:207], v[220:223]
    s_waitcnt lgkmcnt(2)
    v_mfma_f32_16x16x32_bf16 v[192:195], v[40:43], a[208:211], v[192:195]
    ds_read_b64_tr_b16 v[36:37], v17 offset:2048
    ds_read_b64_tr_b16 v[38:39], v17 offset:2560
    v_mfma_f32_16x16x32_bf16 v[200:203], v[40:43], a[212:215], v[200:203]
    v_mfma_f32_16x16x32_bf16 v[208:211], v[40:43], a[216:219], v[208:211]
    v_mfma_f32_16x16x32_bf16 v[216:219], v[40:43], a[220:223], v[216:219]
    v_mfma_f32_16x16x32_bf16 v[196:199], v[44:47], a[208:211], v[196:199]
    ds_read_b64_tr_b16 v[40:41], v16 offset:10240
    ds_read_b64_tr_b16 v[42:43], v16 offset:10752
    v_mfma_f32_16x16x32_bf16 v[204:207], v[44:47], a[212:215], v[204:207]
    v_mfma_f32_16x16x32_bf16 v[212:215], v[44:47], a[216:219], v[212:215]
    v_mfma_f32_16x16x32_bf16 v[220:223], v[44:47], a[220:223], v[220:223]
    s_waitcnt lgkmcnt(2)
    v_mfma_f32_16x16x32_bf16 v[192:195], v[32:35], a[224:227], v[192:195]
    ds_read_b64_tr_b16 v[44:45], v17 offset:10240
    ds_read_b64_tr_b16 v[46:47], v17 offset:10752
    v_mfma_f32_16x16x32_bf16 v[200:203], v[32:35], a[228:231], v[200:203]
    v_mfma_f32_16x16x32_bf16 v[208:211], v[32:35], a[232:235], v[208:211]
    v_mfma_f32_16x16x32_bf16 v[216:219], v[32:35], a[236:239], v[216:219]
    v_mfma_f32_16x16x32_bf16 v[196:199], v[36:39], a[224:227], v[196:199]
    s_waitcnt vmcnt(10)
    s_barrier
    v_mfma_f32_16x16x32_bf16 v[204:207], v[36:39], a[228:231], v[204:207]
    s_add_u32 m0, s64, 98304
    ds_read_b64_tr_b16 v[32:33], v18 offset:0
    v_mfma_f32_16x16x32_bf16 v[212:215], v[36:39], a[232:235], v[212:215]
    ds_read_b64_tr_b16 v[34:35], v18 offset:512
    v_mfma_f32_16x16x32_bf16 v[220:223], v[36:39], a[236:239], v[220:223]
    s_waitcnt lgkmcnt(2)
    v_mfma_f32_16x16x32_bf16 v[192:195], v[40:43], a[240:243], v[192:195]
    buffer_load_dwordx4 v8, s[48:51], s20 offen offset:0 lds
    v_mfma_f32_16x16x32_bf16 v[200:203], v[40:43], a[244:247], v[200:203]
    ds_read_b64_tr_b16 v[36:37], v19 offset:0
    ds_read_b64_tr_b16 v[38:39], v19 offset:512
    v_mfma_f32_16x16x32_bf16 v[208:211], v[40:43], a[248:251], v[208:211]
    buffer_load_dwordx4 v9, s[48:51], s20 offen offset:1024 lds
    v_mfma_f32_16x16x32_bf16 v[216:219], v[40:43], a[252:255], v[216:219]
    v_mfma_f32_16x16x32_bf16 v[196:199], v[44:47], a[240:243], v[196:199]
    ds_read_b64_tr_b16 v[40:41], v18 offset:8192
    ds_read_b64_tr_b16 v[42:43], v18 offset:8704
    v_mfma_f32_16x16x32_bf16 v[204:207], v[44:47], a[244:247], v[204:207]
    v_mfma_f32_16x16x32_bf16 v[212:215], v[44:47], a[248:251], v[212:215]
    buffer_load_dwordx4 v10, s[48:51], s21 offen offset:2048 lds
    v_mfma_f32_16x16x32_bf16 v[220:223], v[44:47], a[252:255], v[220:223]
    s_waitcnt lgkmcnt(2)
    v_mfma_f32_16x16x32_bf16 v[192:195], v[32:35], v[64:67], v[192:195]
    ds_read_b64_tr_b16 v[44:45], v19 offset:8192
    ds_read_b64_tr_b16 v[46:47], v19 offset:8704
    v_mfma_f32_16x16x32_bf16 v[200:203], v[32:35], v[68:71], v[200:203]
    buffer_load_dwordx4 v11, s[48:51], s21 offen offset:3072 lds
    v_mfma_f32_16x16x32_bf16 v[208:211], v[32:35], v[72:75], v[208:211]
    v_mfma_f32_16x16x32_bf16 v[216:219], v[32:35], v[76:79], v[216:219]
    v_mfma_f32_16x16x32_bf16 v[196:199], v[36:39], v[64:67], v[196:199]
    ds_read_b64_tr_b16 v[32:33], v18 offset:2048
    ds_read_b64_tr_b16 v[34:35], v18 offset:2560
    v_mfma_f32_16x16x32_bf16 v[204:207], v[36:39], v[68:71], v[204:207]
    v_mfma_f32_16x16x32_bf16 v[212:215], v[36:39], v[72:75], v[212:215]
    v_mfma_f32_16x16x32_bf16 v[220:223], v[36:39], v[76:79], v[220:223]
    s_waitcnt lgkmcnt(2)
    v_mfma_f32_16x16x32_bf16 v[192:195], v[40:43], v[80:83], v[192:195]
    ds_read_b64_tr_b16 v[36:37], v19 offset:2048
    ds_read_b64_tr_b16 v[38:39], v19 offset:2560
    v_mfma_f32_16x16x32_bf16 v[200:203], v[40:43], v[84:87], v[200:203]
    v_mfma_f32_16x16x32_bf16 v[208:211], v[40:43], v[88:91], v[208:211]
    v_mfma_f32_16x16x32_bf16 v[216:219], v[40:43], v[92:95], v[216:219]
    v_mfma_f32_16x16x32_bf16 v[196:199], v[44:47], v[80:83], v[196:199]
    ds_read_b64_tr_b16 v[40:41], v18 offset:10240
    ds_read_b64_tr_b16 v[42:43], v18 offset:10752
    v_mfma_f32_16x16x32_bf16 v[204:207], v[44:47], v[84:87], v[204:207]
    v_mfma_f32_16x16x32_bf16 v[212:215], v[44:47], v[88:91], v[212:215]
    v_mfma_f32_16x16x32_bf16 v[220:223], v[44:47], v[92:95], v[220:223]
    s_waitcnt lgkmcnt(2)
    v_mfma_f32_16x16x32_bf16 v[192:195], v[32:35], v[96:99], v[192:195]
    ds_read_b64_tr_b16 v[44:45], v19 offset:10240
    ds_read_b64_tr_b16 v[46:47], v19 offset:10752
    v_mfma_f32_16x16x32_bf16 v[200:203], v[32:35], v[100:103], v[200:203]
    v_mfma_f32_16x16x32_bf16 v[208:211], v[32:35], v[104:107], v[208:211]
    v_mfma_f32_16x16x32_bf16 v[216:219], v[32:35], v[108:111], v[216:219]
    v_mfma_f32_16x16x32_bf16 v[196:199], v[36:39], v[96:99], v[196:199]
    s_add_u32 m0, s64, 114688
    ds_read_b64_tr_b16 v[32:33], v16 offset:16384
    v_mfma_f32_16x16x32_bf16 v[204:207], v[36:39], v[100:103], v[204:207]
    ds_read_b64_tr_b16 v[34:35], v16 offset:16896
    v_mfma_f32_16x16x32_bf16 v[212:215], v[36:39], v[104:107], v[212:215]
    v_mfma_f32_16x16x32_bf16 v[220:223], v[36:39], v[108:111], v[220:223]
    s_waitcnt lgkmcnt(2)
    v_mfma_f32_16x16x32_bf16 v[192:195], v[40:43], v[112:115], v[192:195]
    buffer_load_dwordx4 v8, s[48:51], s22 offen offset:0 lds
    v_mfma_f32_16x16x32_bf16 v[200:203], v[40:43], v[116:119], v[200:203]
    ds_read_b64_tr_b16 v[36:37], v17 offset:16384
    ds_read_b64_tr_b16 v[38:39], v17 offset:16896
    v_mfma_f32_16x16x32_bf16 v[208:211], v[40:43], v[120:123], v[208:211]
    buffer_load_dwordx4 v9, s[48:51], s22 offen offset:1024 lds
    v_mfma_f32_16x16x32_bf16 v[216:219], v[40:43], v[124:127], v[216:219]
    v_mfma_f32_16x16x32_bf16 v[196:199], v[44:47], v[112:115], v[196:199]
    ds_read_b64_tr_b16 v[40:41], v16 offset:24576
    ds_read_b64_tr_b16 v[42:43], v16 offset:25088
    v_mfma_f32_16x16x32_bf16 v[204:207], v[44:47], v[116:119], v[204:207]
    v_mfma_f32_16x16x32_bf16 v[212:215], v[44:47], v[120:123], v[212:215]
    buffer_load_dwordx4 v10, s[48:51], s23 offen offset:2048 lds
    v_mfma_f32_16x16x32_bf16 v[220:223], v[44:47], v[124:127], v[220:223]
    s_waitcnt lgkmcnt(2)
    v_mfma_f32_16x16x32_bf16 v[224:227], v[32:35], a[0:3], v[224:227]
    ds_read_b64_tr_b16 v[44:45], v17 offset:24576
    ds_read_b64_tr_b16 v[46:47], v17 offset:25088
    v_mfma_f32_16x16x32_bf16 v[232:235], v[32:35], a[4:7], v[232:235]
    buffer_load_dwordx4 v11, s[48:51], s23 offen offset:3072 lds
    v_mfma_f32_16x16x32_bf16 v[240:243], v[32:35], a[8:11], v[240:243]
    v_mfma_f32_16x16x32_bf16 v[248:251], v[32:35], a[12:15], v[248:251]
    s_add_u32 s58, s56, 49152
    s_add_u32 s59, s57, 49152
    v_mfma_f32_16x16x32_bf16 v[228:231], v[36:39], a[0:3], v[228:231]
    ds_read_b64_tr_b16 v[32:33], v16 offset:18432
    ds_read_b64_tr_b16 v[34:35], v16 offset:18944
    v_mfma_f32_16x16x32_bf16 v[236:239], v[36:39], a[4:7], v[236:239]
    v_mul_f32_e64 v192, v192, |v192|
    v_mul_f32_e64 v193, v193, |v193|
    v_mfma_f32_16x16x32_bf16 v[244:247], v[36:39], a[8:11], v[244:247]
    v_mul_f32_e64 v194, v194, |v194|
    v_mul_f32_e64 v195, v195, |v195|
    v_mfma_f32_16x16x32_bf16 v[252:255], v[36:39], a[12:15], v[252:255]
    v_mul_f32_e64 v196, v196, |v196|
    v_mul_f32_e64 v197, v197, |v197|
    s_waitcnt lgkmcnt(2)
    v_mfma_f32_16x16x32_bf16 v[224:227], v[40:43], a[16:19], v[224:227]
    v_mul_f32_e64 v198, v198, |v198|
    v_mul_f32_e64 v199, v199, |v199|
    v_mfma_f32_16x16x32_bf16 v[232:235], v[40:43], a[20:23], v[232:235]
    v_cvt_pk_bf16_f32 v48, v192, v193
    v_cvt_pk_bf16_f32 v49, v194, v195
    v_mfma_f32_16x16x32_bf16 v[240:243], v[40:43], a[24:27], v[240:243]
    ds_read_b64_tr_b16 v[36:37], v17 offset:18432
    ds_read_b64_tr_b16 v[38:39], v17 offset:18944
    v_cvt_pk_bf16_f32 v50, v196, v197
    v_cvt_pk_bf16_f32 v51, v198, v199
    v_mfma_f32_16x16x32_bf16 v[248:251], v[40:43], a[28:31], v[248:251]
    v_pk_max_i16 v48, v48, 0
    v_pk_max_i16 v49, v49, 0
    v_mfma_f32_16x16x32_bf16 v[228:231], v[44:47], a[16:19], v[228:231]
    v_pk_max_i16 v50, v50, 0
    v_pk_max_i16 v51, v51, 0
    v_mfma_f32_16x16x32_bf16 v[236:239], v[44:47], a[20:23], v[236:239]
    buffer_store_dwordx4 v[48:51], v23, s[52:55], s58 offen offset:0 sc1
    v_mul_f32_e64 v200, v200, |v200|
    v_mfma_f32_16x16x32_bf16 v[244:247], v[44:47], a[24:27], v[244:247]
    ds_read_b64_tr_b16 v[40:41], v16 offset:26624
    ds_read_b64_tr_b16 v[42:43], v16 offset:27136
    v_mul_f32_e64 v201, v201, |v201|
    v_mul_f32_e64 v202, v202, |v202|
    v_mfma_f32_16x16x32_bf16 v[252:255], v[44:47], a[28:31], v[252:255]
    v_mul_f32_e64 v203, v203, |v203|
    v_mul_f32_e64 v204, v204, |v204|
    s_waitcnt lgkmcnt(2)
    v_mfma_f32_16x16x32_bf16 v[224:227], v[32:35], a[32:35], v[224:227]
    v_mul_f32_e64 v205, v205, |v205|
    v_mul_f32_e64 v206, v206, |v206|
    v_mfma_f32_16x16x32_bf16 v[232:235], v[32:35], a[36:39], v[232:235]
    v_mul_f32_e64 v207, v207, |v207|
    v_cvt_pk_bf16_f32 v52, v200, v201
    v_mfma_f32_16x16x32_bf16 v[240:243], v[32:35], a[40:43], v[240:243]
    ds_read_b64_tr_b16 v[44:45], v17 offset:26624
    ds_read_b64_tr_b16 v[46:47], v17 offset:27136
    v_cvt_pk_bf16_f32 v53, v202, v203
    v_cvt_pk_bf16_f32 v54, v204, v205
    v_mfma_f32_16x16x32_bf16 v[248:251], v[32:35], a[44:47], v[248:251]
    v_cvt_pk_bf16_f32 v55, v206, v207
    v_pk_max_i16 v52, v52, 0
    v_mfma_f32_16x16x32_bf16 v[228:231], v[36:39], a[32:35], v[228:231]
    s_waitcnt vmcnt(9)
    s_barrier
    v_pk_max_i16 v53, v53, 0
    v_pk_max_i16 v54, v54, 0
    v_mfma_f32_16x16x32_bf16 v[236:239], v[36:39], a[36:39], v[236:239]
    v_pk_max_i16 v55, v55, 0
    buffer_store_dwordx4 v[52:55], v23, s[52:55], s58 offen offset:1024 sc1
    v_mfma_f32_16x16x32_bf16 v[244:247], v[36:39], a[40:43], v[244:247]
    ds_read_b64_tr_b16 v[32:33], v18 offset:16384
    ds_read_b64_tr_b16 v[34:35], v18 offset:16896
    v_mul_f32_e64 v208, v208, |v208|
    v_mul_f32_e64 v209, v209, |v209|
    v_mfma_f32_16x16x32_bf16 v[252:255], v[36:39], a[44:47], v[252:255]
    v_mul_f32_e64 v210, v210, |v210|
    v_mul_f32_e64 v211, v211, |v211|
    s_waitcnt lgkmcnt(2)
    v_mfma_f32_16x16x32_bf16 v[224:227], v[40:43], a[48:51], v[224:227]
    v_mul_f32_e64 v212, v212, |v212|
    v_mul_f32_e64 v213, v213, |v213|
    v_mfma_f32_16x16x32_bf16 v[232:235], v[40:43], a[52:55], v[232:235]
    v_mul_f32_e64 v214, v214, |v214|
    v_mul_f32_e64 v215, v215, |v215|
    v_mfma_f32_16x16x32_bf16 v[240:243], v[40:43], a[56:59], v[240:243]
    ds_read_b64_tr_b16 v[36:37], v19 offset:16384
    ds_read_b64_tr_b16 v[38:39], v19 offset:16896
    v_cvt_pk_bf16_f32 v56, v208, v209
    v_cvt_pk_bf16_f32 v57, v210, v211
    v_mfma_f32_16x16x32_bf16 v[248:251], v[40:43], a[60:63], v[248:251]
    v_cvt_pk_bf16_f32 v58, v212, v213
    v_cvt_pk_bf16_f32 v59, v214, v215
    v_mfma_f32_16x16x32_bf16 v[228:231], v[44:47], a[48:51], v[228:231]
    v_pk_max_i16 v56, v56, 0
    v_pk_max_i16 v57, v57, 0
    v_mfma_f32_16x16x32_bf16 v[236:239], v[44:47], a[52:55], v[236:239]
    v_pk_max_i16 v58, v58, 0
    v_pk_max_i16 v59, v59, 0
    v_mfma_f32_16x16x32_bf16 v[244:247], v[44:47], a[56:59], v[244:247]
    ds_read_b64_tr_b16 v[40:41], v18 offset:24576
    ds_read_b64_tr_b16 v[42:43], v18 offset:25088
    buffer_store_dwordx4 v[56:59], v23, s[52:55], s59 offen offset:0 sc1
    v_mul_f32_e64 v216, v216, |v216|
    v_mfma_f32_16x16x32_bf16 v[252:255], v[44:47], a[60:63], v[252:255]
    v_mul_f32_e64 v217, v217, |v217|
    v_mul_f32_e64 v218, v218, |v218|
    s_waitcnt lgkmcnt(2)
    v_mfma_f32_16x16x32_bf16 v[224:227], v[32:35], a[64:67], v[224:227]
    v_mul_f32_e64 v219, v219, |v219|
    v_mul_f32_e64 v220, v220, |v220|
    v_mfma_f32_16x16x32_bf16 v[232:235], v[32:35], a[68:71], v[232:235]
    v_mul_f32_e64 v221, v221, |v221|
    v_mul_f32_e64 v222, v222, |v222|
    v_mfma_f32_16x16x32_bf16 v[240:243], v[32:35], a[72:75], v[240:243]
    ds_read_b64_tr_b16 v[44:45], v19 offset:24576
    ds_read_b64_tr_b16 v[46:47], v19 offset:25088
    v_mul_f32_e64 v223, v223, |v223|
    v_cvt_pk_bf16_f32 v60, v216, v217
    v_mfma_f32_16x16x32_bf16 v[248:251], v[32:35], a[76:79], v[248:251]
    v_cvt_pk_bf16_f32 v61, v218, v219
    v_cvt_pk_bf16_f32 v62, v220, v221
    v_mfma_f32_16x16x32_bf16 v[228:231], v[36:39], a[64:67], v[228:231]
    v_cvt_pk_bf16_f32 v63, v222, v223
    v_pk_max_i16 v60, v60, 0
    v_mfma_f32_16x16x32_bf16 v[236:239], v[36:39], a[68:71], v[236:239]
    v_pk_max_i16 v61, v61, 0
    v_pk_max_i16 v62, v62, 0
    v_mfma_f32_16x16x32_bf16 v[244:247], v[36:39], a[72:75], v[244:247]
    ds_read_b64_tr_b16 v[32:33], v18 offset:18432
    ds_read_b64_tr_b16 v[34:35], v18 offset:18944
    v_pk_max_i16 v63, v63, 0
    buffer_store_dwordx4 v[60:63], v23, s[52:55], s59 offen offset:1024 sc1
    v_mfma_f32_16x16x32_bf16 v[252:255], v[36:39], a[76:79], v[252:255]
    s_waitcnt lgkmcnt(2)
    v_mfma_f32_16x16x32_bf16 v[224:227], v[40:43], a[80:83], v[224:227]
    ds_read_b64_tr_b16 v[36:37], v19 offset:18432
    ds_read_b64_tr_b16 v[38:39], v19 offset:18944
    v_mfma_f32_16x16x32_bf16 v[232:235], v[40:43], a[84:87], v[232:235]
    v_mfma_f32_16x16x32_bf16 v[240:243], v[40:43], a[88:91], v[240:243]
    v_mfma_f32_16x16x32_bf16 v[248:251], v[40:43], a[92:95], v[248:251]
    v_mfma_f32_16x16x32_bf16 v[228:231], v[44:47], a[80:83], v[228:231]
    ds_read_b64_tr_b16 v[40:41], v18 offset:26624
    ds_read_b64_tr_b16 v[42:43], v18 offset:27136
    v_mfma_f32_16x16x32_bf16 v[236:239], v[44:47], a[84:87], v[236:239]
    v_mfma_f32_16x16x32_bf16 v[244:247], v[44:47], a[88:91], v[244:247]
    v_mfma_f32_16x16x32_bf16 v[252:255], v[44:47], a[92:95], v[252:255]
    s_waitcnt lgkmcnt(2)
    v_mfma_f32_16x16x32_bf16 v[224:227], v[32:35], a[96:99], v[224:227]
    ds_read_b64_tr_b16 v[44:45], v19 offset:26624
    ds_read_b64_tr_b16 v[46:47], v19 offset:27136
    v_mfma_f32_16x16x32_bf16 v[232:235], v[32:35], a[100:103], v[232:235]
    v_mfma_f32_16x16x32_bf16 v[240:243], v[32:35], a[104:107], v[240:243]
    v_mfma_f32_16x16x32_bf16 v[248:251], v[32:35], a[108:111], v[248:251]
    v_mfma_f32_16x16x32_bf16 v[228:231], v[36:39], a[96:99], v[228:231]
    ds_read_b64_tr_b16 v[32:33], v16 offset:32768
    ds_read_b64_tr_b16 v[34:35], v16 offset:33280
    v_mfma_f32_16x16x32_bf16 v[236:239], v[36:39], a[100:103], v[236:239]
    v_mfma_f32_16x16x32_bf16 v[244:247], v[36:39], a[104:107], v[244:247]
    v_mfma_f32_16x16x32_bf16 v[252:255], v[36:39], a[108:111], v[252:255]
    s_waitcnt lgkmcnt(2)
    v_mfma_f32_16x16x32_bf16 v[224:227], v[40:43], a[112:115], v[224:227]
    ds_read_b64_tr_b16 v[36:37], v17 offset:32768
    ds_read_b64_tr_b16 v[38:39], v17 offset:33280
    v_mfma_f32_16x16x32_bf16 v[232:235], v[40:43], a[116:119], v[232:235]
    v_mfma_f32_16x16x32_bf16 v[240:243], v[40:43], a[120:123], v[240:243]
    v_mfma_f32_16x16x32_bf16 v[248:251], v[40:43], a[124:127], v[248:251]
    v_mfma_f32_16x16x32_bf16 v[228:231], v[44:47], a[112:115], v[228:231]
    ds_read_b64_tr_b16 v[40:41], v16 offset:40960
    ds_read_b64_tr_b16 v[42:43], v16 offset:41472
    v_mfma_f32_16x16x32_bf16 v[236:239], v[44:47], a[116:119], v[236:239]
    v_mfma_f32_16x16x32_bf16 v[244:247], v[44:47], a[120:123], v[244:247]
    v_mfma_f32_16x16x32_bf16 v[252:255], v[44:47], a[124:127], v[252:255]
    s_waitcnt lgkmcnt(2)
    v_mfma_f32_16x16x32_bf16 v[224:227], v[32:35], a[128:131], v[224:227]
    ds_read_b64_tr_b16 v[44:45], v17 offset:40960
    ds_read_b64_tr_b16 v[46:47], v17 offset:41472
    v_mfma_f32_16x16x32_bf16 v[232:235], v[32:35], a[132:135], v[232:235]
    v_mfma_f32_16x16x32_bf16 v[240:243], v[32:35], a[136:139], v[240:243]
    v_mfma_f32_16x16x32_bf16 v[248:251], v[32:35], a[140:143], v[248:251]
    v_mfma_f32_16x16x32_bf16 v[228:231], v[36:39], a[128:131], v[228:231]
    ds_read_b64_tr_b16 v[32:33], v16 offset:34816
    ds_read_b64_tr_b16 v[34:35], v16 offset:35328
    v_mfma_f32_16x16x32_bf16 v[236:239], v[36:39], a[132:135], v[236:239]
    v_mfma_f32_16x16x32_bf16 v[244:247], v[36:39], a[136:139], v[244:247]
    v_mfma_f32_16x16x32_bf16 v[252:255], v[36:39], a[140:143], v[252:255]
    s_waitcnt lgkmcnt(2)
    v_mfma_f32_16x16x32_bf16 v[224:227], v[40:43], a[144:147], v[224:227]
    ds_read_b64_tr_b16 v[36:37], v17 offset:34816
    ds_read_b64_tr_b16 v[38:39], v17 offset:35328
    v_mfma_f32_16x16x32_bf16 v[232:235], v[40:43], a[148:151], v[232:235]
    v_mfma_f32_16x16x32_bf16 v[240:243], v[40:43], a[152:155], v[240:243]
    v_mfma_f32_16x16x32_bf16 v[248:251], v[40:43], a[156:159], v[248:251]
    v_mfma_f32_16x16x32_bf16 v[228:231], v[44:47], a[144:147], v[228:231]
    ds_read_b64_tr_b16 v[40:41], v16 offset:43008
    ds_read_b64_tr_b16 v[42:43], v16 offset:43520
    v_mfma_f32_16x16x32_bf16 v[236:239], v[44:47], a[148:151], v[236:239]
    v_mfma_f32_16x16x32_bf16 v[244:247], v[44:47], a[152:155], v[244:247]
    v_mfma_f32_16x16x32_bf16 v[252:255], v[44:47], a[156:159], v[252:255]
    s_waitcnt lgkmcnt(2)
    v_mfma_f32_16x16x32_bf16 v[224:227], v[32:35], a[160:163], v[224:227]
    ds_read_b64_tr_b16 v[44:45], v17 offset:43008
    ds_read_b64_tr_b16 v[46:47], v17 offset:43520
    v_mfma_f32_16x16x32_bf16 v[232:235], v[32:35], a[164:167], v[232:235]
    v_mfma_f32_16x16x32_bf16 v[240:243], v[32:35], a[168:171], v[240:243]
    s_waitcnt vmcnt(0)
    buffer_atomic_swap v28, v29, s[52:55], s43 offen offset:512 sc1
    v_mfma_f32_16x16x32_bf16 v[248:251], v[32:35], a[172:175], v[248:251]
    v_mfma_f32_16x16x32_bf16 v[228:231], v[36:39], a[160:163], v[228:231]
    s_barrier
    v_mfma_f32_16x16x32_bf16 v[236:239], v[36:39], a[164:167], v[236:239]
    ds_read_b64_tr_b16 v[32:33], v18 offset:32768
    ds_read_b64_tr_b16 v[34:35], v18 offset:33280
    v_mfma_f32_16x16x32_bf16 v[244:247], v[36:39], a[168:171], v[244:247]
    v_mfma_f32_16x16x32_bf16 v[252:255], v[36:39], a[172:175], v[252:255]
    s_waitcnt lgkmcnt(2)
    v_mfma_f32_16x16x32_bf16 v[224:227], v[40:43], a[176:179], v[224:227]
    ds_read_b64_tr_b16 v[36:37], v19 offset:32768
    ds_read_b64_tr_b16 v[38:39], v19 offset:33280
    v_mfma_f32_16x16x32_bf16 v[232:235], v[40:43], a[180:183], v[232:235]
    v_mfma_f32_16x16x32_bf16 v[240:243], v[40:43], a[184:187], v[240:243]
    v_mfma_f32_16x16x32_bf16 v[248:251], v[40:43], a[188:191], v[248:251]
    v_mfma_f32_16x16x32_bf16 v[228:231], v[44:47], a[176:179], v[228:231]
    ds_read_b64_tr_b16 v[40:41], v18 offset:40960
    ds_read_b64_tr_b16 v[42:43], v18 offset:41472
    v_mfma_f32_16x16x32_bf16 v[236:239], v[44:47], a[180:183], v[236:239]
    v_mfma_f32_16x16x32_bf16 v[244:247], v[44:47], a[184:187], v[244:247]
    v_mfma_f32_16x16x32_bf16 v[252:255], v[44:47], a[188:191], v[252:255]
    s_waitcnt lgkmcnt(2)
    v_mfma_f32_16x16x32_bf16 v[224:227], v[32:35], a[192:195], v[224:227]
    ds_read_b64_tr_b16 v[44:45], v19 offset:40960
    ds_read_b64_tr_b16 v[46:47], v19 offset:41472
    v_mfma_f32_16x16x32_bf16 v[232:235], v[32:35], a[196:199], v[232:235]
    v_mfma_f32_16x16x32_bf16 v[240:243], v[32:35], a[200:203], v[240:243]
    v_mfma_f32_16x16x32_bf16 v[248:251], v[32:35], a[204:207], v[248:251]
    v_mfma_f32_16x16x32_bf16 v[228:231], v[36:39], a[192:195], v[228:231]
    ds_read_b64_tr_b16 v[32:33], v18 offset:34816
    ds_read_b64_tr_b16 v[34:35], v18 offset:35328
    v_mfma_f32_16x16x32_bf16 v[236:239], v[36:39], a[196:199], v[236:239]
    v_mfma_f32_16x16x32_bf16 v[244:247], v[36:39], a[200:203], v[244:247]
    v_mfma_f32_16x16x32_bf16 v[252:255], v[36:39], a[204:207], v[252:255]
    s_waitcnt lgkmcnt(2)
    v_mfma_f32_16x16x32_bf16 v[224:227], v[40:43], a[208:211], v[224:227]
    ds_read_b64_tr_b16 v[36:37], v19 offset:34816
    ds_read_b64_tr_b16 v[38:39], v19 offset:35328
    v_mfma_f32_16x16x32_bf16 v[232:235], v[40:43], a[212:215], v[232:235]
    v_mfma_f32_16x16x32_bf16 v[240:243], v[40:43], a[216:219], v[240:243]
    v_mfma_f32_16x16x32_bf16 v[248:251], v[40:43], a[220:223], v[248:251]
    v_mfma_f32_16x16x32_bf16 v[228:231], v[44:47], a[208:211], v[228:231]
    ds_read_b64_tr_b16 v[40:41], v18 offset:43008
    ds_read_b64_tr_b16 v[42:43], v18 offset:43520
    v_mfma_f32_16x16x32_bf16 v[236:239], v[44:47], a[212:215], v[236:239]
    v_mfma_f32_16x16x32_bf16 v[244:247], v[44:47], a[216:219], v[244:247]
    v_mfma_f32_16x16x32_bf16 v[252:255], v[44:47], a[220:223], v[252:255]
    s_waitcnt lgkmcnt(2)
    v_mfma_f32_16x16x32_bf16 v[224:227], v[32:35], a[224:227], v[224:227]
    ds_read_b64_tr_b16 v[44:45], v19 offset:43008
    ds_read_b64_tr_b16 v[46:47], v19 offset:43520
    v_mfma_f32_16x16x32_bf16 v[232:235], v[32:35], a[228:231], v[232:235]
    v_mfma_f32_16x16x32_bf16 v[240:243], v[32:35], a[232:235], v[240:243]
    v_mfma_f32_16x16x32_bf16 v[248:251], v[32:35], a[236:239], v[248:251]
    v_mfma_f32_16x16x32_bf16 v[228:231], v[36:39], a[224:227], v[228:231]
    ds_read_b64_tr_b16 v[32:33], v18 offset:49152
    ds_read_b64_tr_b16 v[34:35], v18 offset:49664
    v_mfma_f32_16x16x32_bf16 v[236:239], v[36:39], a[228:231], v[236:239]
    v_mfma_f32_16x16x32_bf16 v[244:247], v[36:39], a[232:235], v[244:247]
    v_mfma_f32_16x16x32_bf16 v[252:255], v[36:39], a[236:239], v[252:255]
    s_waitcnt lgkmcnt(2)
    v_mfma_f32_16x16x32_bf16 v[224:227], v[40:43], a[240:243], v[224:227]
    ds_read_b64_tr_b16 v[36:37], v19 offset:49152
    ds_read_b64_tr_b16 v[38:39], v19 offset:49664
    v_mfma_f32_16x16x32_bf16 v[232:235], v[40:43], a[244:247], v[232:235]
    v_mfma_f32_16x16x32_bf16 v[240:243], v[40:43], a[248:251], v[240:243]
    v_mfma_f32_16x16x32_bf16 v[248:251], v[40:43], a[252:255], v[248:251]
    v_mfma_f32_16x16x32_bf16 v[228:231], v[44:47], a[240:243], v[228:231]
    ds_read_b64_tr_b16 v[40:41], v18 offset:57344
    ds_read_b64_tr_b16 v[42:43], v18 offset:57856
    v_mfma_f32_16x16x32_bf16 v[236:239], v[44:47], a[244:247], v[236:239]
    v_mfma_f32_16x16x32_bf16 v[244:247], v[44:47], a[248:251], v[244:247]
    v_mfma_f32_16x16x32_bf16 v[252:255], v[44:47], a[252:255], v[252:255]
    s_waitcnt lgkmcnt(2)
    v_mfma_f32_16x16x32_bf16 v[224:227], v[32:35], v[64:67], v[224:227]
    ds_read_b64_tr_b16 v[44:45], v19 offset:57344
    ds_read_b64_tr_b16 v[46:47], v19 offset:57856
    v_mfma_f32_16x16x32_bf16 v[232:235], v[32:35], v[68:71], v[232:235]
    v_mfma_f32_16x16x32_bf16 v[240:243], v[32:35], v[72:75], v[240:243]
    v_mfma_f32_16x16x32_bf16 v[248:251], v[32:35], v[76:79], v[248:251]
    v_mfma_f32_16x16x32_bf16 v[228:231], v[36:39], v[64:67], v[228:231]
    ds_read_b64_tr_b16 v[32:33], v18 offset:51200
    ds_read_b64_tr_b16 v[34:35], v18 offset:51712
    v_mfma_f32_16x16x32_bf16 v[236:239], v[36:39], v[68:71], v[236:239]
    v_mfma_f32_16x16x32_bf16 v[244:247], v[36:39], v[72:75], v[244:247]
    v_mfma_f32_16x16x32_bf16 v[252:255], v[36:39], v[76:79], v[252:255]
    s_waitcnt lgkmcnt(2)
    v_mfma_f32_16x16x32_bf16 v[224:227], v[40:43], v[80:83], v[224:227]
    ds_read_b64_tr_b16 v[36:37], v19 offset:51200
    ds_read_b64_tr_b16 v[38:39], v19 offset:51712
    v_mfma_f32_16x16x32_bf16 v[232:235], v[40:43], v[84:87], v[232:235]
    v_mfma_f32_16x16x32_bf16 v[240:243], v[40:43], v[88:91], v[240:243]
    v_mfma_f32_16x16x32_bf16 v[248:251], v[40:43], v[92:95], v[248:251]
    v_mfma_f32_16x16x32_bf16 v[228:231], v[44:47], v[80:83], v[228:231]
    ds_read_b64_tr_b16 v[40:41], v18 offset:59392
    ds_read_b64_tr_b16 v[42:43], v18 offset:59904
    v_mfma_f32_16x16x32_bf16 v[236:239], v[44:47], v[84:87], v[236:239]
    v_mfma_f32_16x16x32_bf16 v[244:247], v[44:47], v[88:91], v[244:247]
    v_mfma_f32_16x16x32_bf16 v[252:255], v[44:47], v[92:95], v[252:255]
    s_waitcnt lgkmcnt(2)
    v_mfma_f32_16x16x32_bf16 v[224:227], v[32:35], v[96:99], v[224:227]
    ds_read_b64_tr_b16 v[44:45], v19 offset:59392
    ds_read_b64_tr_b16 v[46:47], v19 offset:59904
    v_mfma_f32_16x16x32_bf16 v[232:235], v[32:35], v[100:103], v[232:235]
    v_mfma_f32_16x16x32_bf16 v[240:243], v[32:35], v[104:107], v[240:243]
    v_mfma_f32_16x16x32_bf16 v[248:251], v[32:35], v[108:111], v[248:251]
    v_mfma_f32_16x16x32_bf16 v[228:231], v[36:39], v[96:99], v[228:231]
    v_mfma_f32_16x16x32_bf16 v[236:239], v[36:39], v[100:103], v[236:239]
    v_mfma_f32_16x16x32_bf16 v[244:247], v[36:39], v[104:107], v[244:247]
    v_mfma_f32_16x16x32_bf16 v[252:255], v[36:39], v[108:111], v[252:255]
    s_waitcnt lgkmcnt(0)
    v_mfma_f32_16x16x32_bf16 v[224:227], v[40:43], v[112:115], v[224:227]
    v_mfma_f32_16x16x32_bf16 v[232:235], v[40:43], v[116:119], v[232:235]
    v_mfma_f32_16x16x32_bf16 v[240:243], v[40:43], v[120:123], v[240:243]
    v_mfma_f32_16x16x32_bf16 v[248:251], v[40:43], v[124:127], v[248:251]
    v_mfma_f32_16x16x32_bf16 v[228:231], v[44:47], v[112:115], v[228:231]
    v_mfma_f32_16x16x32_bf16 v[236:239], v[44:47], v[116:119], v[236:239]
    v_mfma_f32_16x16x32_bf16 v[244:247], v[44:47], v[120:123], v[244:247]
    v_mfma_f32_16x16x32_bf16 v[252:255], v[44:47], v[124:127], v[252:255]
    s_nop 1
    s_nop 0
    s_add_u32 s58, s56, 73728
    s_add_u32 s59, s57, 73728
    v_mul_f32_e64 v224, v224, |v224|
    v_mul_f32_e64 v225, v225, |v225|
    v_mul_f32_e64 v226, v226, |v226|
    v_mul_f32_e64 v227, v227, |v227|
    v_mul_f32_e64 v228, v228, |v228|
    v_mul_f32_e64 v229, v229, |v229|
    v_mul_f32_e64 v230, v230, |v230|
    v_mul_f32_e64 v231, v231, |v231|
    v_cvt_pk_bf16_f32 v48, v224, v225
    v_cvt_pk_bf16_f32 v49, v226, v227
    v_cvt_pk_bf16_f32 v50, v228, v229
    v_cvt_pk_bf16_f32 v51, v230, v231
    v_pk_max_i16 v48, v48, 0
    v_pk_max_i16 v49, v49, 0
    v_pk_max_i16 v50, v50, 0
    v_pk_max_i16 v51, v51, 0
    buffer_store_dwordx4 v[48:51], v23, s[52:55], s58 offen offset:0 sc1
    v_mul_f32_e64 v232, v232, |v232|
    v_mul_f32_e64 v233, v233, |v233|
    v_mul_f32_e64 v234, v234, |v234|
    v_mul_f32_e64 v235, v235, |v235|
    v_mul_f32_e64 v236, v236, |v236|
    v_mul_f32_e64 v237, v237, |v237|
    v_mul_f32_e64 v238, v238, |v238|
    v_mul_f32_e64 v239, v239, |v239|
    v_cvt_pk_bf16_f32 v52, v232, v233
    v_cvt_pk_bf16_f32 v53, v234, v235
    v_cvt_pk_bf16_f32 v54, v236, v237
    v_cvt_pk_bf16_f32 v55, v238, v239
    v_pk_max_i16 v52, v52, 0
    v_pk_max_i16 v53, v53, 0
L_ptA3:
    s_cbranch_execz L_ptdA
    s_nop 0
    v_pk_max_i16 v54, v54, 0
    v_pk_max_i16 v55, v55, 0
    buffer_store_dwordx4 v[52:55], v23, s[52:55], s58 offen offset:1024 sc1
    v_mul_f32_e64 v240, v240, |v240|
    v_mul_f32_e64 v241, v241, |v241|
    v_mul_f32_e64 v242, v242, |v242|
    v_mul_f32_e64 v243, v243, |v243|
    v_mul_f32_e64 v244, v244, |v244|
    v_mul_f32_e64 v245, v245, |v245|
    v_mul_f32_e64 v246, v246, |v246|
    v_mul_f32_e64 v247, v247, |v247|
    v_cvt_pk_bf16_f32 v56, v240, v241
    v_cvt_pk_bf16_f32 v57, v242, v243
    v_cvt_pk_bf16_f32 v58, v244, v245
    v_cvt_pk_bf16_f32 v59, v246, v247
    v_pk_max_i16 v56, v56, 0
    v_pk_max_i16 v57, v57, 0
    v_pk_max_i16 v58, v58, 0
    v_pk_max_i16 v59, v59, 0
    buffer_store_dwordx4 v[56:59], v23, s[52:55], s59 offen offset:0 sc1
    v_mul_f32_e64 v248, v248, |v248|
    v_mul_f32_e64 v249, v249, |v249|
    v_mul_f32_e64 v250, v250, |v250|
    v_mul_f32_e64 v251, v251, |v251|
    v_mul_f32_e64 v252, v252, |v252|
    v_mul_f32_e64 v253, v253, |v253|
    v_mul_f32_e64 v254, v254, |v254|
    v_mul_f32_e64 v255, v255, |v255|
    v_cvt_pk_bf16_f32 v60, v248, v249
    v_cvt_pk_bf16_f32 v61, v250, v251
    v_cvt_pk_bf16_f32 v62, v252, v253
    v_cvt_pk_bf16_f32 v63, v254, v255
    v_pk_max_i16 v60, v60, 0
    v_pk_max_i16 v61, v61, 0
    v_pk_max_i16 v62, v62, 0
    v_pk_max_i16 v63, v63, 0
    buffer_store_dwordx4 v[60:63], v23, s[52:55], s59 offen offset:1024 sc1
    s_waitcnt vmcnt(0)
    buffer_atomic_swap v28, v29, s[52:55], s43 offen offset:768 sc1
    s_or_b32 s66, s2, s40
    s_cmp_lg_u32 s66, 0
    s_cbranch_scc1 L_a_done
    v_and_b32 v3, 15, v1
    v_lshrrev_b32 v4, 4, v1
    v_lshlrev_b32_e64 v2, 8, v4
    v_lshl_add_u32 v2, v3, 2, v2
    v_add_u32 v2, 12713984, v2
    v_lshlrev_b32_e64 v3, 12, v3
    v_lshl_add_u32 v3, v4, 3, v3
    v_add_u32 v3, 12648448, v3
L_ep:
    s_add_u32 s100, s100, 1
    s_cmp_gt_u32 s100, 2000000
    s_cbranch_scc1 L_exit
    v_mov_b32 v32, 0
    v_mov_b32 v33, 0
    v_mov_b32 v34, 0
    v_mov_b32 v35, 0
    v_mov_b32_e64 v36, 0
    buffer_atomic_or v32, v2, s[52:55], 0 offen offset:0 sc0 sc1
    buffer_atomic_or v33, v2, s[52:55], 0 offen offset:1024 sc0 sc1
    buffer_atomic_or v34, v2, s[52:55], 0 offen offset:1536 sc0 sc1
    buffer_atomic_or v35, v3, s[52:55], 0 offen offset:0 sc0 sc1
    buffer_atomic_or v36, v3, s[52:55], 0 offen offset:16 sc0 sc1
    s_waitcnt vmcnt(0)
    v_mov_b32 v4, 0
    v_xor_b32 v32, v32, v28
    v_or_b32 v4, v4, v32
    v_xor_b32 v33, v33, v28
    v_or_b32 v4, v4, v33
    v_xor_b32 v34, v34, v28
    v_or_b32 v4, v4, v34
    v_xor_b32 v35, v35, v28
    v_or_b32 v4, v4, v35
    v_xor_b32 v36, v36, v28
    v_or_b32 v4, v4, v36
    v_cmp_ne_u32 vcc, 0, v4
    s_cbranch_vccnz L_ep
    global_store_dword v22, v28, s[38:39] sc1
L_a_done:
    s_endpgm
L_code_end:
    s_endpgm
.p2align 7
.type L_tab,@object
L_tab:
.long 0x4e90,0x4eb0,0x4ed0,0x4ef0,0x52b0,0x5290,0x52f0,0x52d0
.long 0x56d0,0x56f0,0x5690,0x56b0,0x5af0,0x5ad0,0x5ab0,0x5a90
.long 0x4e10,0x4e30,0x4e50,0x4e70,0x5230,0x5210,0x5270,0x5250
.long 0x5650,0x5670,0x5610,0x5630,0x5a70,0x5a50,0x5a30,0x5a10
.long 0x4d80,0x4da0,0x4dc0,0x4de0,0x51a0,0x5180,0x51e0,0x51c0
.long 0x55c0,0x55e0,0x5580,0x55a0,0x59e0,0x59c0,0x59a0,0x5980
.long 0x4d00,0x4d20,0x4d40,0x4d60,0x5120,0x5100,0x5160,0x5140
.long 0x5540,0x5560,0x5500,0x5520,0x5960,0x5940,0x5920,0x5900
.long 0x4e98,0x4eb8,0x4ed8,0x4ef8,0x52b8,0x5298,0x52f8,0x52d8
.long 0x56d8,0x56f8,0x5698,0x56b8,0x5af8,0x5ad8,0x5ab8,0x5a98
.long 0x4e18,0x4e38,0x4e58,0x4e78,0x5238,0x5218,0x5278,0x5258
.long 0x5658,0x5678,0x5618,0x5638,0x5a78,0x5a58,0x5a38,0x5a18
.long 0x4d88,0x4da8,0x4dc8,0x4de8,0x51a8,0x5188,0x51e8,0x51c8
.long 0x55c8,0x55e8,0x5588,0x55a8,0x59e8,0x59c8,0x59a8,0x5988
.long 0x4d08,0x4d28,0x4d48,0x4d68,0x5128,0x5108,0x5168,0x5148
.long 0x5548,0x5568,0x5508,0x5528,0x5968,0x5948,0x5928,0x5908
.long 0x4e80,0x4ea0,0x4ec0,0x4ee0,0x52a0,0x5280,0x52e0,0x52c0
.long 0x56c0,0x56e0,0x5680,0x56a0,0x5ae0,0x5ac0,0x5aa0,0x5a80
.long 0x4e00,0x4e20,0x4e40,0x4e60,0x5220,0x5200,0x5260,0x5240
.long 0x5640,0x5660,0x5600,0x5620,0x5a60,0x5a40,0x5a20,0x5a00
.long 0x4d90,0x4db0,0x4dd0,0x4df0,0x51b0,0x5190,0x51f0,0x51d0
.long 0x55d0,0x55f0,0x5590,0x55b0,0x59f0,0x59d0,0x59b0,0x5990
.long 0x4d10,0x4d30,0x4d50,0x4d70,0x5130,0x5110,0x5170,0x5150
.long 0x5550,0x5570,0x5510,0x5530,0x5970,0x5950,0x5930,0x5910
.long 0x4e88,0x4ea8,0x4ec8,0x4ee8,0x52a8,0x5288,0x52e8,0x52c8
.long 0x56c8,0x56e8,0x5688,0x56a8,0x5ae8,0x5ac8,0x5aa8,0x5a88
.long 0x4e08,0x4e28,0x4e48,0x4e68,0x5228,0x5208,0x5268,0x5248
.long 0x5648,0x5668,0x5608,0x5628,0x5a68,0x5a48,0x5a28,0x5a08
.long 0x4d98,0x4db8,0x4dd8,0x4df8,0x51b8,0x5198,0x51f8,0x51d8
.long 0x55d8,0x55f8,0x5598,0x55b8,0x59f8,0x59d8,0x59b8,0x5998
.long 0x4d18,0x4d38,0x4d58,0x4d78,0x5138,0x5118,0x5178,0x5158
.long 0x5558,0x5578,0x5518,0x5538,0x5978,0x5958,0x5938,0x5918
.long 0x2200,0x0,0xf0,0x0,0x2310,0x110,0xe0,0x7ffff000
.long 0x2420,0x220,0xd0,0x7ffff000,0x2530,0x330,0xc0,0x7ffff000
.long 0x2a80,0x440,0xb0,0x7ffff000,0x2a80,0x550,0xa0,0x7ffff000
.long 0x2b90,0x660,0x90,0x7ffff000,0x2ca0,0x770,0x80,0x7ffff000
.long 0x2640,0x880,0x70,0x7ffff000,0x2750,0x990,0x60,0x7ffff000
.long 0x2860,0xaa0,0x50,0x7ffff000,0x2970,0xbb0,0x40,0x7ffff000
.long 0x2ca0,0xcc0,0x30,0x7ffff000,0x2ca0,0xdd0,0x20,0x7ffff000
.long 0x2db0,0xee0,0x10,0x7ffff000,0x2db0,0xff0,0x0,0x7ffff000
.long 0x2ec0,0x1100,0x40f0,0x7ffff000,0x2fd0,0x1210,0x40e0,0x7ffff000
.long 0x3300,0x1320,0x40d0,0x7ffff000,0x3520,0x1430,0x40c0,0x7ffff000
.long 0x30e0,0x1540,0x40b0,0x7ffff000,0x31f0,0x1650,0x40a0,0x7ffff000
.long 0x3410,0x1760,0x4090,0x7ffff000,0x3630,0x1870,0x4080,0x7ffff000
.long 0x3740,0x1980,0x4070,0x7ffff000,0x3740,0x1a90,0x4060,0x7ffff000
.long 0x3740,0x1ba0,0x4050,0x7ffff000,0x3740,0x1cb0,0x4040,0x7ffff000
.long 0x3630,0x1dc0,0x4030,0x7ffff000,0x3630,0x1ed0,0x4020,0x7ffff000
.long 0x3630,0x1fe0,0x4010,0x7ffff000,0x3630,0x20f0,0x4000,0x7ffff000
.long 0x2210,0x10,0x80f0,0x7ffff000,0x2320,0x120,0x80e0,0x7ffff000
.long 0x2430,0x230,0x80d0,0x7ffff000,0x2540,0x340,0x80c0,0x7ffff000
.long 0x2a90,0x450,0x80b0,0x7ffff000,0x2a90,0x560,0x80a0,0x7ffff000
.long 0x2ba0,0x670,0x8090,0x7ffff000,0x2cb0,0x780,0x8080,0x7ffff000
.long 0x2650,0x890,0x8070,0x7ffff000,0x2760,0x9a0,0x8060,0x7ffff000
.long 0x2870,0xab0,0x8050,0x7ffff000,0x2980,0xbc0,0x8040,0x7ffff000
.long 0x2cb0,0xcd0,0x8030,0x7ffff000,0x2cb0,0xde0,0x8020,0x7ffff000
.long 0x2dc0,0xef0,0x8010,0x7ffff000,0x2dc0,0x1000,0x8000,0x7ffff000
.long 0x2ed0,0x1110,0xc0f0,0x7ffff000,0x2fe0,0x1220,0xc0e0,0x7ffff000
.long 0x3310,0x1330,0xc0d0,0x7ffff000,0x3530,0x1440,0xc0c0,0x7ffff000
.long 0x30f0,0x1550,0xc0b0,0x7ffff000,0x3200,0x1660,0xc0a0,0x7ffff000
.long 0x3420,0x1770,0xc090,0x7ffff000,0x3640,0x1880,0xc080,0x7ffff000
.long 0x3750,0x1990,0xc070,0x7ffff000,0x3750,0x1aa0,0xc060,0x7ffff000
.long 0x3750,0x1bb0,0xc050,0x7ffff000,0x3750,0x1cc0,0xc040,0x7ffff000
.long 0x3640,0x1dd0,0xc030,0x7ffff000,0x3640,0x1ee0,0xc020,0x7ffff000
.long 0x3640,0x1ff0,0xc010,0x7ffff000,0x3640,0x2100,0xc000,0x7ffff000
.long 0x0,0x0,0x100,0x0,0x10,0x4,0x180,0x500
.long 0x20,0x8,0x300,0xa00,0x30,0xc,0x380,0xf00
.long 0x40,0x10,0x500,0x1400,0x50,0x14,0x580,0x1900
.long 0x60,0x18,0x500,0x1e00,0x70,0x1c,0x580,0x2300
.long 0x80,0x20,0xd00,0x2800,0x90,0x24,0xd80,0x2d00
.long 0xa0,0x28,0xf00,0x3200,0xb0,0x2c,0xf80,0x3700
.long 0xc0,0x30,0x1100,0x3c00,0xd0,0x34,0x1180,0x4100
.long 0xe0,0x38,0x1100,0x4600,0xf0,0x3c,0x1180,0x4b00
.long 0x100,0x7ffff000,0x100,0x5000,0x110,0x7ffff000,0x180,0x5500
.long 0x120,0x7ffff000,0x300,0x5a00,0x130,0x7ffff000,0x380,0x5f00
.long 0x140,0x7ffff000,0x500,0x6400,0x150,0x7ffff000,0x580,0x6900
.long 0x160,0x7ffff000,0x500,0x6e00,0x170,0x7ffff000,0x580,0x7300
.long 0x180,0x7ffff000,0xd00,0x7300,0x190,0x7ffff000,0xd80,0x7300
.long 0x1a0,0x7ffff000,0xf00,0x7300,0x1b0,0x7ffff000,0xf80,0x7300
.long 0x1c0,0x7ffff000,0x1100,0x7300,0x1d0,0x7ffff000,0x1180,0x7300
.long 0x1e0,0x7ffff000,0x1100,0x7300,0x1f0,0x7ffff000,0x1180,0x7300
.long 0x200,0x7ffff000,0x100,0x7300,0x210,0x7ffff000,0x180,0x7300
.long 0x220,0x7ffff000,0x300,0x7300,0x230,0x7ffff000,0x380,0x7300
.long 0x240,0x7ffff000,0x500,0x7300,0x250,0x7ffff000,0x580,0x7300
.long 0x260,0x7ffff000,0x500,0x7300,0x270,0x7ffff000,0x580,0x7300
.long 0x280,0x7ffff000,0xd00,0x7300,0x290,0x7ffff000,0xd80,0x7300
.long 0x2a0,0x7ffff000,0xf00,0x7300,0x2b0,0x7ffff000,0xf80,0x7300
.long 0x2c0,0x7ffff000,0x1100,0x7300,0x2d0,0x7ffff000,0x1180,0x7300
.long 0x2e0,0x7ffff000,0x1100,0x7300,0x2f0,0x7ffff000,0x1180,0x7300
.long 0x300,0x7ffff000,0x100,0x7300,0x310,0x7ffff000,0x180,0x7300
.long 0x320,0x7ffff000,0x300,0x7300,0x330,0x7ffff000,0x380,0x7300
.long 0x340,0x7ffff000,0x500,0x7300,0x350,0x7ffff000,0x580,0x7300
.long 0x360,0x7ffff000,0x500,0x7300,0x370,0x7ffff000,0x580,0x7300
.long 0x380,0x7ffff000,0xd00,0x7300,0x390,0x7ffff000,0xd80,0x7300
.long 0x3a0,0x7ffff000,0xf00,0x7300,0x3b0,0x7ffff000,0xf80,0x7300
.long 0x3c0,0x7ffff000,0x1100,0x7300,0x3d0,0x7ffff000,0x1180,0x7300
.long 0x3e0,0x7ffff000,0x1100,0x7300,0x3f0,0x7ffff000,0x1180,0x7300
.long 0x1154,0x1160,0x820,0xffffffff,0x1158,0x1160,0x824,0xffffffff
.long 0x115c,0x1164,0x828,0xffff,0x1160,0x1164,0x82c,0x0
.long 0x1164,0x1168,0x830,0x0,0x1168,0x1168,0x834,0x0
.long 0x116c,0x116c,0x838,0x0,0x1170,0x116c,0x83c,0x0
.long 0x1174,0x1170,0x840,0x0,0x1178,0x1170,0x844,0x0
.long 0x117c,0x1174,0x848,0x0,0x1180,0x1174,0x84c,0x0
.long 0x1184,0x1178,0x850,0x0,0x1188,0x1178,0x854,0x0
.long 0x118c,0x117c,0x858,0x0,0x1190,0x117c,0x85c,0x0
.long 0x1144,0x1180,0x10e0,0xffffffff,0x1148,0x1180,0x10e4,0xffffffff
.long 0x114c,0x1184,0x10e8,0x0,0x1150,0x1184,0x10ec,0x0
.long 0x1154,0x1188,0x10f0,0x0,0x1158,0x1188,0x10f4,0x0
.long 0x115c,0x118c,0x10f8,0x0,0x1160,0x118c,0x10fc,0x0
.long 0x1164,0x1190,0x1100,0x0,0x1168,0x1190,0x1104,0x0
.long 0x116c,0x1194,0x1108,0x0,0x1170,0x1194,0x110c,0x0
.long 0x1174,0x1198,0x1110,0x0,0x1178,0x1198,0x1114,0x0
.long 0x117c,0x119c,0x1118,0x0,0x1180,0x119c,0x111c,0x0
.long 0x1134,0x11a0,0x1120,0x0,0x1138,0x11a0,0x1124,0x0
.long 0x113c,0x11a4,0x1128,0x0,0x1140,0x11a4,0x112c,0x0
.long 0x1144,0x11a8,0x1130,0x0,0x1148,0x11a8,0x1134,0x0
.long 0x114c,0x11ac,0x1138,0x0,0x1150,0x11ac,0x113c,0x0
.long 0x1154,0x11b0,0x1140,0x0,0x1158,0x11b0,0x1144,0x0
.long 0x115c,0x11b4,0x1148,0x0,0x1160,0x11b4,0x114c,0x0
.long 0x1164,0x11b8,0x1150,0x0,0x1168,0x11b8,0x1154,0x0
.long 0x116c,0x11bc,0x1158,0x0,0x1170,0x11bc,0x115c,0x0
.long 0x1124,0x11c0,0x1120,0x0,0x1128,0x11c0,0x1124,0x0
.long 0x112c,0x11c4,0x1128,0x0,0x1130,0x11c4,0x112c,0x0
.long 0x1134,0x11c8,0x1130,0x0,0x1138,0x11c8,0x1134,0x0
.long 0x113c,0x11cc,0x1138,0x0,0x1140,0x11cc,0x113c,0x0
.long 0x1144,0x11d0,0x1140,0x0,0x1148,0x11d0,0x1144,0x0
.long 0x114c,0x11d4,0x1148,0x0,0x1150,0x11d4,0x114c,0x0
.long 0x1154,0x11d8,0x1150,0x0,0x1158,0x11d8,0x1154,0x0
.long 0x115c,0x11dc,0x1158,0x0,0x1160,0x11dc,0x115c,0x0
.long 0x0,0x1c,0x0,0x0,0x10,0x18,0x810,0x8
.long 0x20,0x14,0x20,0x10,0x30,0x10,0x830,0x18
.long 0x40,0xc,0x40,0x1340,0x50,0x8,0x850,0x1348
.long 0x60,0x4,0x60,0x1350,0x70,0x0,0x870,0x1358
.long 0x80,0x0,0x80,0x2680,0x90,0x0,0x890,0x2688
.long 0xa0,0x0,0xa0,0x2690,0xb0,0x0,0x8b0,0x2698
.long 0xc0,0x0,0xc0,0x39c0,0xd0,0x0,0x8d0,0x39c8
.long 0xe0,0x0,0xe0,0x39d0,0xf0,0x0,0x8f0,0x39d8
.long 0x100,0x0,0x8,0x20,0x110,0x0,0x818,0x28
.long 0x120,0x0,0x28,0x30,0x130,0x0,0x838,0x38
.long 0x140,0x0,0x48,0x1360,0x150,0x0,0x858,0x1368
.long 0x160,0x0,0x68,0x1370,0x170,0x0,0x878,0x1378
.long 0x180,0x0,0x88,0x26a0,0x190,0x0,0x898,0x26a8
.long 0x1a0,0x0,0xa8,0x26b0,0x1b0,0x0,0x8b8,0x26b8
.long 0x1c0,0x0,0xc8,0x39e0,0x1d0,0x0,0x8d8,0x39e8
.long 0x1e0,0x0,0xe8,0x39f0,0x1f0,0x0,0x8f8,0x39f8
.long 0x200,0x0,0x10,0x40,0x210,0x0,0x820,0x48
.long 0x220,0x0,0x30,0x50,0x230,0x0,0x840,0x58
.long 0x240,0x0,0x50,0x1380,0x250,0x0,0x860,0x1388
.long 0x260,0x0,0x70,0x1390,0x270,0x0,0x880,0x1398
.long 0x280,0x0,0x90,0x26c0,0x290,0x0,0x8a0,0x26c8
.long 0x2a0,0x0,0xb0,0x26d0,0x2b0,0x0,0x8c0,0x26d8
.long 0x2c0,0x0,0xd0,0x3a00,0x2d0,0x0,0x8e0,0x3a08
.long 0x2e0,0x0,0xf0,0x3a10,0x2f0,0x0,0x900,0x3a18
.long 0x300,0x0,0x18,0x60,0x310,0x0,0x828,0x68
.long 0x320,0x0,0x38,0x70,0x330,0x0,0x848,0x78
.long 0x340,0x0,0x58,0x13a0,0x350,0x0,0x868,0x13a8
.long 0x360,0x0,0x78,0x13b0,0x370,0x0,0x888,0x13b8
.long 0x380,0x0,0x98,0x26e0,0x390,0x0,0x8a8,0x26e8
.long 0x3a0,0x0,0xb8,0x26f0,0x3b0,0x0,0x8c8,0x26f8
.long 0x3c0,0x0,0xd8,0x3a20,0x3d0,0x0,0x8e8,0x3a28
.long 0x3e0,0x0,0xf8,0x3a30,0x3f0,0x0,0x908,0x3a38
.long 0x8c0,0xcc0,0x10c0,0x7f0,0x4,0x404,0x804,0x770
.long 0x8c4,0xcc4,0x10c4,0x6e0,0x8,0x408,0x808,0x660
.long 0x8c8,0xcc8,0x10c8,0x5d0,0xc,0x40c,0x80c,0x550
.long 0x8cc,0xccc,0x10cc,0x4c0,0x10,0x410,0x810,0x440
.long 0x8d0,0xcd0,0x10d0,0x3f0,0x14,0x414,0x814,0x370
.long 0x8d4,0xcd4,0x10d4,0x2e0,0x18,0x418,0x818,0x260
.long 0x8d8,0xcd8,0x10d8,0x1d0,0x1c,0x41c,0x81c,0x150
.long 0x8dc,0xcdc,0x10dc,0xc0,0x20,0x420,0x820,0x40
.long 0x8d0,0xcd0,0x10d0,0x800,0x14,0x414,0x814,0x7b0
.long 0x8d4,0xcd4,0x10d4,0x730,0x18,0x418,0x818,0x6a0
.long 0x8d8,0xcd8,0x10d8,0x620,0x1c,0x41c,0x81c,0x590
.long 0x8dc,0xcdc,0x10dc,0x510,0x20,0x420,0x820,0x480
.long 0x8e0,0xce0,0x10e0,0x400,0x24,0x424,0x824,0x3b0
.long 0x8e4,0xce4,0x10e4,0x330,0x28,0x428,0x828,0x2a0
.long 0x8e8,0xce8,0x10e8,0x220,0x2c,0x42c,0x82c,0x190
.long 0x8ec,0xcec,0x10ec,0x110,0x30,0x430,0x830,0x80
.long 0x8e0,0xce0,0x10e0,0x840,0x24,0x424,0x824,0x7f0
.long 0x8e4,0xce4,0x10e4,0x770,0x28,0x428,0x828,0x6e0
.long 0x8e8,0xce8,0x10e8,0x660,0x2c,0x42c,0x82c,0x5d0
.long 0x8ec,0xcec,0x10ec,0x550,0x30,0x430,0x830,0x4c0
.long 0x8f0,0xcf0,0x10f0,0x440,0x34,0x434,0x834,0x3f0
.long 0x8f4,0xcf4,0x10f4,0x370,0x38,0x438,0x838,0x2e0
.long 0x8f8,0xcf8,0x10f8,0x260,0x3c,0x43c,0x83c,0x1d0
.long 0x8fc,0xcfc,0x10fc,0x150,0x40,0x440,0x840,0xc0
.long 0x8f0,0xcf0,0x10f0,0x880,0x34,0x434,0x834,0x800
.long 0x8f4,0xcf4,0x10f4,0x7b0,0x38,0x438,0x838,0x730
.long 0x8f8,0xcf8,0x10f8,0x6a0,0x3c,0x43c,0x83c,0x620
.long 0x8fc,0xcfc,0x10fc,0x590,0x40,0x440,0x840,0x510
.long 0x900,0xd00,0x1100,0x480,0x44,0x444,0x844,0x400
.long 0x904,0xd04,0x1104,0x3b0,0x48,0x448,0x848,0x330
.long 0x908,0xd08,0x1108,0x2a0,0x4c,0x44c,0x84c,0x220
.long 0x90c,0xd0c,0x110c,0x190,0x50,0x450,0x850,0x110
.long 0x7b0,0x880,0x990,0xaa0,0x730,0x800,0x910,0xa20
.long 0x6a0,0x7b0,0x880,0x990,0x620,0x730,0x800,0x910
.long 0x590,0x6a0,0x7b0,0x880,0x510,0x620,0x730,0x800
.long 0x480,0x590,0x6a0,0x7b0,0x400,0x510,0x620,0x730
.long 0x3b0,0x480,0x590,0x6a0,0x330,0x400,0x510,0x620
.long 0x2a0,0x3b0,0x480,0x590,0x220,0x330,0x400,0x510
.long 0x190,0x2a0,0x3b0,0x480,0x110,0x220,0x330,0x400
.long 0x80,0x190,0x2a0,0x3b0,0x0,0x110,0x220,0x330
.long 0x7f0,0x8c0,0x9d0,0xae0,0x770,0x840,0x950,0xa60
.long 0x6e0,0x7f0,0x8c0,0x9d0,0x660,0x770,0x840,0x950
.long 0x5d0,0x6e0,0x7f0,0x8c0,0x550,0x660,0x770,0x840
.long 0x4c0,0x5d0,0x6e0,0x7f0,0x440,0x550,0x660,0x770
.long 0x3f0,0x4c0,0x5d0,0x6e0,0x370,0x440,0x550,0x660
.long 0x2e0,0x3f0,0x4c0,0x5d0,0x260,0x370,0x440,0x550
.long 0x1d0,0x2e0,0x3f0,0x4c0,0x150,0x260,0x370,0x440
.long 0xc0,0x1d0,0x2e0,0x3f0,0x40,0x150,0x260,0x370
.long 0x800,0x910,0xa20,0xb30,0x7b0,0x880,0x990,0xaa0
.long 0x730,0x800,0x910,0xa20,0x6a0,0x7b0,0x880,0x990
.long 0x620,0x730,0x800,0x910,0x590,0x6a0,0x7b0,0x880
.long 0x510,0x620,0x730,0x800,0x480,0x590,0x6a0,0x7b0
.long 0x400,0x510,0x620,0x730,0x3b0,0x480,0x590,0x6a0
.long 0x330,0x400,0x510,0x620,0x2a0,0x3b0,0x480,0x590
.long 0x220,0x330,0x400,0x510,0x190,0x2a0,0x3b0,0x480
.long 0x110,0x220,0x330,0x400,0x80,0x190,0x2a0,0x3b0
.long 0x840,0x950,0xa60,0xb70,0x7f0,0x8c0,0x9d0,0xae0
.long 0x770,0x840,0x950,0xa60,0x6e0,0x7f0,0x8c0,0x9d0
.long 0x660,0x770,0x840,0x950,0x5d0,0x6e0,0x7f0,0x8c0
.long 0x550,0x660,0x770,0x840,0x4c0,0x5d0,0x6e0,0x7f0
.long 0x440,0x550,0x660,0x770,0x3f0,0x4c0,0x5d0,0x6e0
.long 0x370,0x440,0x550,0x660,0x2e0,0x3f0,0x4c0,0x5d0
.long 0x260,0x370,0x440,0x550,0x1d0,0x2e0,0x3f0,0x4c0
.long 0x150,0x260,0x370,0x440,0xc0,0x1d0,0x2e0,0x3f0
.long 0x0,0x0,0x0,0x2400,0x4,0x0,0x10,0x2410
.long 0x8,0x0,0x20,0x2420,0xc,0x0,0x30,0x2430
.long 0x10,0x0,0x40,0x2440,0x14,0x0,0x50,0x2450
.long 0x18,0x0,0x60,0x2460,0x1c,0x0,0x70,0x2470
.long 0x20,0x0,0x500,0x2900,0x24,0x0,0x510,0x2910
.long 0x28,0x0,0x520,0x2920,0x2c,0x0,0x530,0x2930
.long 0x7ffff000,0x0,0x540,0x2940,0x7ffff000,0x0,0x550,0x2950
.long 0x7ffff000,0x0,0x560,0x2960,0x7ffff000,0x0,0x570,0x2970
.long 0x7ffff000,0x8,0xa20,0x2e20,0x7ffff000,0x8,0xa30,0x2e30
.long 0x7ffff000,0x8,0xa00,0x2e00,0x7ffff000,0x8,0xa10,0x2e10
.long 0x7ffff000,0x8,0xa60,0x2e60,0x7ffff000,0x8,0xa70,0x2e70
.long 0x7ffff000,0x8,0xa40,0x2e40,0x7ffff000,0x8,0xa50,0x2e50
.long 0x7ffff000,0x8,0xf20,0x3320,0x7ffff000,0x8,0xf30,0x3330
.long 0x7ffff000,0x8,0xf00,0x3300,0x7ffff000,0x8,0xf10,0x3310
.long 0x7ffff000,0x8,0xf60,0x3360,0x7ffff000,0x8,0xf70,0x3370
.long 0x7ffff000,0x8,0xf40,0x3340,0x7ffff000,0x8,0xf50,0x3350
.long 0x7ffff000,0x10,0x1440,0x3840,0x7ffff000,0x10,0x1450,0x3850
.long 0x7ffff000,0x10,0x1460,0x3860,0x7ffff000,0x10,0x1470,0x3870
.long 0x7ffff000,0x10,0x1400,0x3800,0x7ffff000,0x10,0x1410,0x3810
.long 0x7ffff000,0x10,0x1420,0x3820,0x7ffff000,0x10,0x1430,0x3830
.long 0x7ffff000,0x10,0x1940,0x3d40,0x7ffff000,0x10,0x1950,0x3d50
.long 0x7ffff000,0x10,0x1960,0x3d60,0x7ffff000,0x10,0x1970,0x3d70
.long 0x7ffff000,0x10,0x1900,0x3d00,0x7ffff000,0x10,0x1910,0x3d10
.long 0x7ffff000,0x10,0x1920,0x3d20,0x7ffff000,0x10,0x1930,0x3d30
.long 0x7ffff000,0x18,0x1e60,0x4260,0x7ffff000,0x18,0x1e70,0x4270
.long 0x7ffff000,0x18,0x1e40,0x4240,0x7ffff000,0x18,0x1e50,0x4250
.long 0x7ffff000,0x18,0x1e20,0x4220,0x7ffff000,0x18,0x1e30,0x4230
.long 0x7ffff000,0x18,0x1e00,0x4200,0x7ffff000,0x18,0x1e10,0x4210
.long 0x7ffff000,0x18,0x2360,0x4760,0x7ffff000,0x18,0x2370,0x4770
.long 0x7ffff000,0x18,0x2340,0x4740,0x7ffff000,0x18,0x2350,0x4750
.long 0x7ffff000,0x18,0x2320,0x4720,0x7ffff000,0x18,0x2330,0x4730
.long 0x7ffff000,0x18,0x2300,0x4700,0x7ffff000,0x18,0x2310,0x4710
.long 0x0,0x0,0x0,0x0,0x0,0x0,0x0,0x0
.long 0x0,0x0,0x0,0x0,0x0,0x0,0x0,0x0
.long 0x0,0x0,0x0,0x0,0x0,0x0,0x0,0x0
.long 0x0,0x0,0x0,0x0,0x0,0x0,0x0,0x0
.long 0x0,0x0,0x0,0x0,0x0,0x0,0x0,0x0
.long 0x0,0x0,0x0,0x0,0x0,0x0,0x0,0x0
.long 0x0,0x0,0x0,0x0,0x0,0x0,0x0,0x3f800000
.long 0x0,0x0,0x0,0x3f803f80,0x0,0x0,0x3f800000,0x3f803f80
.long 0x0,0x0,0x0,0x0,0x0,0x0,0x0,0x0
.long 0x0,0x0,0x0,0x0,0x0,0x0,0x0,0x0
.long 0x0,0x0,0x0,0x0,0x0,0x0,0x0,0x3f800000
.long 0x0,0x0,0x0,0x3f803f80,0x0,0x0,0x3f800000,0x3f803f80
.long 0x0,0x0,0x3f803f80,0x3f803f80,0x0,0x3f800000,0x3f803f80,0x3f803f80
.long 0x0,0x3f803f80,0x3f803f80,0x3f803f80,0x3f800000,0x3f803f80,0x3f803f80,0x3f803f80
.long 0x3f803f80,0x3f803f80,0x3f803f80,0x3f80,0x3f803f80,0x3f803f80,0x3f803f80,0x0
.long 0x3f803f80,0x3f803f80,0x3f80,0x0,0x3f803f80,0x3f803f80,0x0,0x0
.long 0x0,0x0,0x3f803f80,0x3f803f80,0x0,0x3f800000,0x3f803f80,0x3f803f80
.long 0x0,0x3f803f80,0x3f803f80,0x3f803f80,0x3f800000,0x3f803f80,0x3f803f80,0x3f803f80
.long 0x3f803f80,0x3f803f80,0x3f803f80,0x3f80,0x3f803f80,0x3f803f80,0x3f803f80,0x0
.long 0x3f803f80,0x3f803f80,0x3f80,0x0,0x3f803f80,0x3f803f80,0x0,0x0
.long 0x3f803f80,0x3f80,0x0,0x0,0x3f803f80,0x0,0x0,0x0
.long 0x3f80,0x0,0x0,0x0,0x0,0x0,0x0,0x0
.long 0x0,0x0,0x0,0x0,0x0,0x0,0x0,0x0
.long 0x0,0x0,0x0,0x0,0x0,0x0,0x0,0x0
.long 0x3f803f80,0x3f80,0x0,0x0,0x3f803f80,0x0,0x0,0x0
.long 0x3f80,0x0,0x0,0x0,0x0,0x0,0x0,0x0
.long 0x0,0x0,0x0,0x0,0x0,0x0,0x0,0x0
.long 0x0,0x0,0x0,0x0,0x0,0x0,0x0,0x0
.long 0x0,0x0,0x0,0x0,0x0,0x0,0x0,0x0
.long 0x0,0x0,0x0,0x0,0x0,0x0,0x0,0x0
.long 0x0,0x0,0x0,0x0,0x0,0x0,0x0,0x0
.long 0x0,0x0,0x0,0x0,0x0,0x0,0x0,0x0
.long 0x0,0x0,0x0,0x0,0x0,0x0,0x0,0x0
.long 0x0,0x0,0x0,0x0,0x0,0x0,0x0,0x0
.long 0x0,0x0,0x0,0x0,0x0,0x0,0x0,0x0
.long 0x0,0x0,0x0,0x0,0x0,0x0,0x0,0x0
.long 0x0,0x0,0x0,0x0,0x0,0x0,0x0,0x0
.long 0x0,0x0,0x0,0x0,0x0,0x0,0x0,0x0
.long 0x0,0x0,0x0,0x3f800000,0x0,0x0,0x0,0x3f803f80
.long 0x0,0x0,0x3f800000,0x3f803f80,0x0,0x0,0x3f803f80,0x3f803f80
.long 0x0,0x0,0x0,0x0,0x0,0x0,0x0,0x0
.long 0x0,0x0,0x0,0x0,0x0,0x0,0x0,0x0
.long 0x0,0x0,0x0,0x3f800000,0x0,0x0,0x0,0x3f803f80
.long 0x0,0x0,0x3f800000,0x3f803f80,0x0,0x0,0x3f803f80,0x3f803f80
.long 0x0,0x3f800000,0x3f803f80,0x3f803f80,0x0,0x3f803f80,0x3f803f80,0x3f803f80
.long 0x3f800000,0x3f803f80,0x3f803f80,0x3f803f80,0x3f803f80,0x3f803f80,0x3f803f80,0x3f803f80
.long 0x3f803f80,0x3f803f80,0x3f803f80,0x3f803f80,0x3f803f80,0x3f803f80,0x3f803f80,0x3f80
.long 0x3f803f80,0x3f803f80,0x3f803f80,0x0,0x3f803f80,0x3f803f80,0x3f80,0x0
.long 0x0,0x3f800000,0x3f803f80,0x3f803f80,0x0,0x3f803f80,0x3f803f80,0x3f803f80
.long 0x3f800000,0x3f803f80,0x3f803f80,0x3f803f80,0x3f803f80,0x3f803f80,0x3f803f80,0x3f803f80
.long 0x3f803f80,0x3f803f80,0x3f803f80,0x3f803f80,0x3f803f80,0x3f803f80,0x3f803f80,0x3f80
.long 0x3f803f80,0x3f803f80,0x3f803f80,0x0,0x3f803f80,0x3f803f80,0x3f80,0x0
.long 0x3f803f80,0x3f803f80,0x0,0x0,0x3f803f80,0x3f80,0x0,0x0
.long 0x3f803f80,0x0,0x0,0x0,0x3f80,0x0,0x0,0x0
.long 0x0,0x0,0x0,0x0,0x0,0x0,0x0,0x0
.long 0x0,0x0,0x0,0x0,0x0,0x0,0x0,0x0
.long 0x3f803f80,0x3f803f80,0x0,0x0,0x3f803f80,0x3f80,0x0,0x0
.long 0x3f803f80,0x0,0x0,0x0,0x3f80,0x0,0x0,0x0
.long 0x0,0x0,0x0,0x0,0x0,0x0,0x0,0x0
.long 0x0,0x0,0x0,0x0,0x0,0x0,0x0,0x0
.long 0x0,0x0,0x0,0x0,0x0,0x0,0x0,0x0
.long 0x0,0x0,0x0,0x0,0x0,0x0,0x0,0x0
.long 0x0,0x0,0x0,0x0,0x0,0x0,0x0,0x0
.long 0x0,0x0,0x0,0x0,0x0,0x0,0x0,0x0
.long 0x0,0x20,0x40,0x60,0x8,0x28,0x48,0x68
.long 0x10,0x30,0x50,0x70,0x18,0x38,0x58,0x78
.long 0x80,0xa0,0xc0,0xe0,0x88,0xa8,0xc8,0xe8
.long 0x90,0xb0,0xd0,0xf0,0x98,0xb8,0xd8,0xf8
.long 0x120,0x100,0x160,0x140,0x128,0x108,0x168,0x148
.long 0x130,0x110,0x170,0x150,0x138,0x118,0x178,0x158
.long 0x1a0,0x180,0x1e0,0x1c0,0x1a8,0x188,0x1e8,0x1c8
.long 0x1b0,0x190,0x1f0,0x1d0,0x1b8,0x198,0x1f8,0x1d8
.long 0x240,0x260,0x200,0x220,0x248,0x268,0x208,0x228
.long 0x250,0x270,0x210,0x230,0x258,0x278,0x218,0x238
.long 0x2c0,0x2e0,0x280,0x2a0,0x2c8,0x2e8,0x288,0x2a8
.long 0x2d0,0x2f0,0x290,0x2b0,0x2d8,0x2f8,0x298,0x2b8
.long 0x360,0x340,0x320,0x300,0x368,0x348,0x328,0x308
.long 0x370,0x350,0x330,0x310,0x378,0x358,0x338,0x318
.long 0x3e0,0x3c0,0x3a0,0x380,0x3e8,0x3c8,0x3a8,0x388
.long 0x3f0,0x3d0,0x3b0,0x390,0x3f8,0x3d8,0x3b8,0x398
.long 0x400,0x420,0x440,0x460,0x408,0x428,0x448,0x468
.long 0x410,0x430,0x450,0x470,0x418,0x438,0x458,0x478
.long 0x480,0x4a0,0x4c0,0x4e0,0x488,0x4a8,0x4c8,0x4e8
.long 0x490,0x4b0,0x4d0,0x4f0,0x498,0x4b8,0x4d8,0x4f8
.long 0x520,0x500,0x560,0x540,0x528,0x508,0x568,0x548
.long 0x530,0x510,0x570,0x550,0x538,0x518,0x578,0x558
.long 0x5a0,0x580,0x5e0,0x5c0,0x5a8,0x588,0x5e8,0x5c8
.long 0x5b0,0x590,0x5f0,0x5d0,0x5b8,0x598,0x5f8,0x5d8
.long 0x640,0x660,0x600,0x620,0x648,0x668,0x608,0x628
.long 0x650,0x670,0x610,0x630,0x658,0x678,0x618,0x638
.long 0x6c0,0x6e0,0x680,0x6a0,0x6c8,0x6e8,0x688,0x6a8
.long 0x6d0,0x6f0,0x690,0x6b0,0x6d8,0x6f8,0x698,0x6b8
.long 0x760,0x740,0x720,0x700,0x768,0x748,0x728,0x708
.long 0x770,0x750,0x730,0x710,0x778,0x758,0x738,0x718
.long 0x7e0,0x7c0,0x7a0,0x780,0x7e8,0x7c8,0x7a8,0x788
.long 0x7f0,0x7d0,0x7b0,0x790,0x7f8,0x7d8,0x7b8,0x798
.long 0x20000,0x20020,0x0,0x10000,0x20040,0x20060,0x10,0x10010
.long 0x20008,0x20028,0x20,0x10020,0x20048,0x20068,0x30,0x10030
.long 0x20080,0x200a0,0x40,0x10040,0x200c0,0x200e0,0x50,0x10050
.long 0x20088,0x200a8,0x60,0x10060,0x200c8,0x200e8,0x70,0x10070
.long 0x20120,0x20100,0x80,0x10080,0x20160,0x20140,0x90,0x10090
.long 0x20128,0x20108,0xa0,0x100a0,0x20168,0x20148,0xb0,0x100b0
.long 0x201a0,0x20180,0xc0,0x100c0,0x201e0,0x201c0,0xd0,0x100d0
.long 0x201a8,0x20188,0xe0,0x100e0,0x201e8,0x201c8,0xf0,0x100f0
.long 0x20010,0x20030,0x100,0x10100,0x20050,0x20070,0x110,0x10110
.long 0x20018,0x20038,0x120,0x10120,0x20058,0x20078,0x130,0x10130
.long 0x20090,0x200b0,0x140,0x10140,0x200d0,0x200f0,0x150,0x10150
.long 0x20098,0x200b8,0x160,0x10160,0x200d8,0x200f8,0x170,0x10170
.long 0x20130,0x20110,0x180,0x10180,0x20170,0x20150,0x190,0x10190
.long 0x20138,0x20118,0x1a0,0x101a0,0x20178,0x20158,0x1b0,0x101b0
.long 0x201b0,0x20190,0x1c0,0x101c0,0x201f0,0x201d0,0x1d0,0x101d0
.long 0x201b8,0x20198,0x1e0,0x101e0,0x201f8,0x201d8,0x1f0,0x101f0
.long 0x20200,0x20220,0x200,0x10200,0x20240,0x20260,0x210,0x10210
.long 0x20208,0x20228,0x220,0x10220,0x20248,0x20268,0x230,0x10230
.long 0x20280,0x202a0,0x240,0x10240,0x202c0,0x202e0,0x250,0x10250
.long 0x20288,0x202a8,0x260,0x10260,0x202c8,0x202e8,0x270,0x10270
.long 0x20320,0x20300,0x280,0x10280,0x20360,0x20340,0x290,0x10290
.long 0x20328,0x20308,0x2a0,0x102a0,0x20368,0x20348,0x2b0,0x102b0
.long 0x203a0,0x20380,0x2c0,0x102c0,0x203e0,0x203c0,0x2d0,0x102d0
.long 0x203a8,0x20388,0x2e0,0x102e0,0x203e8,0x203c8,0x2f0,0x102f0
.long 0x20210,0x20230,0x300,0x10300,0x20250,0x20270,0x310,0x10310
.long 0x20218,0x20238,0x320,0x10320,0x20258,0x20278,0x330,0x10330
.long 0x20290,0x202b0,0x340,0x10340,0x202d0,0x202f0,0x350,0x10350
.long 0x20298,0x202b8,0x360,0x10360,0x202d8,0x202f8,0x370,0x10370
.long 0x20330,0x20310,0x380,0x10380,0x20370,0x20350,0x390,0x10390
.long 0x20338,0x20318,0x3a0,0x103a0,0x20378,0x20358,0x3b0,0x103b0
.long 0x203b0,0x20390,0x3c0,0x103c0,0x203f0,0x203d0,0x3d0,0x103d0
.long 0x203b8,0x20398,0x3e0,0x103e0,0x203f8,0x203d8,0x3f0,0x103f0
.long 0x1a000,0x0,0x0,0x0,0x1a010,0x10,0x10,0x4
.long 0x1a020,0x20,0x20,0x8,0x1a030,0x30,0x30,0xc
.long 0x1a040,0x40,0x40,0x10,0x1a050,0x50,0x50,0x14
.long 0x1a060,0x60,0x60,0x18,0x1a070,0x70,0x70,0x1c
.long 0x1a090,0x500,0x80,0x20,0x1a080,0x510,0x90,0x24
.long 0x1a0b0,0x520,0xa0,0x28,0x1a0a0,0x530,0xb0,0x2c
.long 0x1a0d0,0x540,0xc0,0x30,0x1a0c0,0x550,0xd0,0x34
.long 0x1a0f0,0x560,0xe0,0x38,0x1a0e0,0x570,0xf0,0x3c
.long 0x1a120,0xa00,0x4000,0x40,0x1a130,0xa10,0x4010,0x44
.long 0x1a100,0xa20,0x4020,0x48,0x1a110,0xa30,0x4030,0x4c
.long 0x1a160,0xa40,0x4040,0x50,0x1a170,0xa50,0x4050,0x54
.long 0x1a140,0xa60,0x4060,0x58,0x1a150,0xa70,0x4070,0x5c
.long 0x1a1b0,0xf00,0x4080,0x60,0x1a1a0,0xf10,0x4090,0x64
.long 0x1a190,0xf20,0x40a0,0x68,0x1a180,0xf30,0x40b0,0x6c
.long 0x1a1f0,0xf40,0x40c0,0x70,0x1a1e0,0xf50,0x40d0,0x74
.long 0x1a1d0,0xf60,0x40e0,0x78,0x1a1c0,0xf70,0x40f0,0x7c
.long 0x1a240,0x1400,0x8000,0x80,0x1a250,0x1410,0x8010,0x84
.long 0x1a260,0x1420,0x8020,0x88,0x1a270,0x1430,0x8030,0x8c
.long 0x1a200,0x1440,0x8040,0x90,0x1a210,0x1450,0x8050,0x94
.long 0x1a220,0x1460,0x8060,0x98,0x1a230,0x1470,0x8070,0x9c
.long 0x1a2d0,0x1900,0x8080,0xa0,0x1a2c0,0x1910,0x8090,0xa4
.long 0x1a2f0,0x1920,0x80a0,0xa8,0x1a2e0,0x1930,0x80b0,0xac
.long 0x1a290,0x1940,0x80c0,0xb0,0x1a280,0x1950,0x80d0,0xb4
.long 0x1a2b0,0x1960,0x80e0,0xb8,0x1a2a0,0x1970,0x80f0,0xbc
.long 0x1a360,0x1e00,0xc000,0xc0,0x1a370,0x1e10,0xc010,0xc4
.long 0x1a340,0x1e20,0xc020,0xc8,0x1a350,0x1e30,0xc030,0xcc
.long 0x1a320,0x1e40,0xc040,0xd0,0x1a330,0x1e50,0xc050,0xd4
.long 0x1a300,0x1e60,0xc060,0xd8,0x1a310,0x1e70,0xc070,0xdc
.long 0x1a3f0,0x2300,0xc080,0xe0,0x1a3e0,0x2310,0xc090,0xe4
.long 0x1a3d0,0x2320,0xc0a0,0xe8,0x1a3c0,0x2330,0xc0b0,0xec
.long 0x1a3b0,0x2340,0xc0c0,0xf0,0x1a3a0,0x2350,0xc0d0,0xf4
.long 0x1a390,0x2360,0xc0e0,0xf8,0x1a380,0x2370,0xc0f0,0xfc
.long 0x1a000,0x1a020,0x1a040,0x1a060,0x1a090,0x1a0b0,0x1a0d0,0x1a0f0
.long 0x1a120,0x1a100,0x1a160,0x1a140,0x1a1b0,0x1a190,0x1a1f0,0x1a1d0
.long 0x1a240,0x1a260,0x1a200,0x1a220,0x1a2d0,0x1a2f0,0x1a290,0x1a2b0
.long 0x1a360,0x1a340,0x1a320,0x1a300,0x1a3f0,0x1a3d0,0x1a3b0,0x1a390
.long 0x1a400,0x1a420,0x1a440,0x1a460,0x1a490,0x1a4b0,0x1a4d0,0x1a4f0
.long 0x1a520,0x1a500,0x1a560,0x1a540,0x1a5b0,0x1a590,0x1a5f0,0x1a5d0
.long 0x1a640,0x1a660,0x1a600,0x1a620,0x1a6d0,0x1a6f0,0x1a690,0x1a6b0
.long 0x1a760,0x1a740,0x1a720,0x1a700,0x1a7f0,0x1a7d0,0x1a7b0,0x1a790
.long 0x1a008,0x1a028,0x1a048,0x1a068,0x1a098,0x1a0b8,0x1a0d8,0x1a0f8
.long 0x1a128,0x1a108,0x1a168,0x1a148,0x1a1b8,0x1a198,0x1a1f8,0x1a1d8
.long 0x1a248,0x1a268,0x1a208,0x1a228,0x1a2d8,0x1a2f8,0x1a298,0x1a2b8
.long 0x1a368,0x1a348,0x1a328,0x1a308,0x1a3f8,0x1a3d8,0x1a3b8,0x1a398
.long 0x1a408,0x1a428,0x1a448,0x1a468,0x1a498,0x1a4b8,0x1a4d8,0x1a4f8
.long 0x1a528,0x1a508,0x1a568,0x1a548,0x1a5b8,0x1a598,0x1a5f8,0x1a5d8
.long 0x1a648,0x1a668,0x1a608,0x1a628,0x1a6d8,0x1a6f8,0x1a698,0x1a6b8
.long 0x1a768,0x1a748,0x1a728,0x1a708,0x1a7f8,0x1a7d8,0x1a7b8,0x1a798
.long 0x1a010,0x1a030,0x1a050,0x1a070,0x1a080,0x1a0a0,0x1a0c0,0x1a0e0
.long 0x1a130,0x1a110,0x1a170,0x1a150,0x1a1a0,0x1a180,0x1a1e0,0x1a1c0
.long 0x1a250,0x1a270,0x1a210,0x1a230,0x1a2c0,0x1a2e0,0x1a280,0x1a2a0
.long 0x1a370,0x1a350,0x1a330,0x1a310,0x1a3e0,0x1a3c0,0x1a3a0,0x1a380
.long 0x1a410,0x1a430,0x1a450,0x1a470,0x1a480,0x1a4a0,0x1a4c0,0x1a4e0
.long 0x1a530,0x1a510,0x1a570,0x1a550,0x1a5a0,0x1a580,0x1a5e0,0x1a5c0
.long 0x1a650,0x1a670,0x1a610,0x1a630,0x1a6c0,0x1a6e0,0x1a680,0x1a6a0
.long 0x1a770,0x1a750,0x1a730,0x1a710,0x1a7e0,0x1a7c0,0x1a7a0,0x1a780
.long 0x1a018,0x1a038,0x1a058,0x1a078,0x1a088,0x1a0a8,0x1a0c8,0x1a0e8
.long 0x1a138,0x1a118,0x1a178,0x1a158,0x1a1a8,0x1a188,0x1a1e8,0x1a1c8
.long 0x1a258,0x1a278,0x1a218,0x1a238,0x1a2c8,0x1a2e8,0x1a288,0x1a2a8
.long 0x1a378,0x1a358,0x1a338,0x1a318,0x1a3e8,0x1a3c8,0x1a3a8,0x1a388
.long 0x1a418,0x1a438,0x1a458,0x1a478,0x1a488,0x1a4a8,0x1a4c8,0x1a4e8
.long 0x1a538,0x1a518,0x1a578,0x1a558,0x1a5a8,0x1a588,0x1a5e8,0x1a5c8
.long 0x1a658,0x1a678,0x1a618,0x1a638,0x1a6c8,0x1a6e8,0x1a688,0x1a6a8
.long 0x1a778,0x1a758,0x1a738,0x1a718,0x1a7e8,0x1a7c8,0x1a7a8,0x1a788
.long 0x1260,0x1260,0x1,0x2,0x1264,0x1264,0x1,0x2
.long 0x1268,0x1268,0x1,0x2,0x126c,0x126c,0x1,0x2
.long 0x1270,0x1270,0x1,0x2,0x1274,0x1274,0x1,0x2
.long 0x1278,0x1278,0x1,0x2,0x127c,0x127c,0x1,0x2
.long 0x1260,0x1280,0x1,0x2,0x1264,0x1284,0x1,0x2
.long 0x1268,0x1288,0x1,0x2,0x126c,0x128c,0x1,0x2
.long 0x1270,0x1290,0x1,0x2,0x1274,0x1294,0x1,0x2
.long 0x1278,0x1298,0x1,0x2,0x127c,0x129c,0x1,0x2
.long 0x1260,0x12a0,0x1,0x2,0x1264,0x12a4,0x1,0x2
.long 0x1268,0x12a8,0x1,0x2,0x126c,0x12ac,0x1,0x2
.long 0x1270,0x12b0,0x1,0x2,0x1274,0x12b4,0x1,0x2
.long 0x1278,0x12b8,0x1,0x2,0x127c,0x12bc,0x1,0x2
.long 0x1260,0x12c0,0x1,0x2,0x1264,0x12c4,0x1,0x2
.long 0x1268,0x12c8,0x1,0x2,0x126c,0x12cc,0x1,0x2
.long 0x1270,0x12d0,0x1,0x2,0x1274,0x12d4,0x1,0x2
.long 0x1278,0x12d8,0x1,0x2,0x127c,0x12dc,0x1,0x2
.long 0x1260,0x1260,0x1,0x2,0x1264,0x1264,0x1,0x2
.long 0x1268,0x1268,0x1,0x2,0x126c,0x126c,0x1,0x2
.long 0x1270,0x1270,0x1,0x2,0x1274,0x1274,0x1,0x2
.long 0x1278,0x1278,0x1,0x2,0x127c,0x127c,0x1,0x2
.long 0x1260,0x1280,0x1,0x2,0x1264,0x1284,0x1,0x2
.long 0x1268,0x1288,0x1,0x2,0x126c,0x128c,0x1,0x2
.long 0x1270,0x1290,0x1,0x2,0x1274,0x1294,0x1,0x2
.long 0x1278,0x1298,0x1,0x2,0x127c,0x129c,0x1,0x2
.long 0x1260,0x12a0,0x1,0x2,0x1264,0x12a4,0x1,0x2
.long 0x1268,0x12a8,0x1,0x2,0x126c,0x12ac,0x1,0x2
.long 0x1270,0x12b0,0x1,0x2,0x1274,0x12b4,0x1,0x2
.long 0x1278,0x12b8,0x1,0x2,0x127c,0x12bc,0x1,0x2
.long 0x1260,0x12c0,0x1,0x2,0x1264,0x12c4,0x1,0x2
.long 0x1268,0x12c8,0x1,0x2,0x126c,0x12cc,0x1,0x2
.long 0x1270,0x12d0,0x1,0x2,0x1274,0x12d4,0x1,0x2
.long 0x1278,0x12d8,0x1,0x2,0x127c,0x12dc,0x1,0x2
.long 0x5e90,0x5eb0,0x5ed0,0x5ef0,0x62b0,0x6290,0x62f0,0x62d0
.long 0x66d0,0x66f0,0x6690,0x66b0,0x6af0,0x6ad0,0x6ab0,0x6a90
.long 0x5e10,0x5e30,0x5e50,0x5e70,0x6230,0x6210,0x6270,0x6250
.long 0x6650,0x6670,0x6610,0x6630,0x6a70,0x6a50,0x6a30,0x6a10
.long 0x5d80,0x5da0,0x5dc0,0x5de0,0x61a0,0x6180,0x61e0,0x61c0
.long 0x65c0,0x65e0,0x6580,0x65a0,0x69e0,0x69c0,0x69a0,0x6980
.long 0x5d00,0x5d20,0x5d40,0x5d60,0x6120,0x6100,0x6160,0x6140
.long 0x6540,0x6560,0x6500,0x6520,0x6960,0x6940,0x6920,0x6900
.long 0x5e98,0x5eb8,0x5ed8,0x5ef8,0x62b8,0x6298,0x62f8,0x62d8
.long 0x66d8,0x66f8,0x6698,0x66b8,0x6af8,0x6ad8,0x6ab8,0x6a98
.long 0x5e18,0x5e38,0x5e58,0x5e78,0x6238,0x6218,0x6278,0x6258
.long 0x6658,0x6678,0x6618,0x6638,0x6a78,0x6a58,0x6a38,0x6a18
.long 0x5d88,0x5da8,0x5dc8,0x5de8,0x61a8,0x6188,0x61e8,0x61c8
.long 0x65c8,0x65e8,0x6588,0x65a8,0x69e8,0x69c8,0x69a8,0x6988
.long 0x5d08,0x5d28,0x5d48,0x5d68,0x6128,0x6108,0x6168,0x6148
.long 0x6548,0x6568,0x6508,0x6528,0x6968,0x6948,0x6928,0x6908
.long 0x5e80,0x5ea0,0x5ec0,0x5ee0,0x62a0,0x6280,0x62e0,0x62c0
.long 0x66c0,0x66e0,0x6680,0x66a0,0x6ae0,0x6ac0,0x6aa0,0x6a80
.long 0x5e00,0x5e20,0x5e40,0x5e60,0x6220,0x6200,0x6260,0x6240
.long 0x6640,0x6660,0x6600,0x6620,0x6a60,0x6a40,0x6a20,0x6a00
.long 0x5d90,0x5db0,0x5dd0,0x5df0,0x61b0,0x6190,0x61f0,0x61d0
.long 0x65d0,0x65f0,0x6590,0x65b0,0x69f0,0x69d0,0x69b0,0x6990
.long 0x5d10,0x5d30,0x5d50,0x5d70,0x6130,0x6110,0x6170,0x6150
.long 0x6550,0x6570,0x6510,0x6530,0x6970,0x6950,0x6930,0x6910
.long 0x5e88,0x5ea8,0x5ec8,0x5ee8,0x62a8,0x6288,0x62e8,0x62c8
.long 0x66c8,0x66e8,0x6688,0x66a8,0x6ae8,0x6ac8,0x6aa8,0x6a88
.long 0x5e08,0x5e28,0x5e48,0x5e68,0x6228,0x6208,0x6268,0x6248
.long 0x6648,0x6668,0x6608,0x6628,0x6a68,0x6a48,0x6a28,0x6a08
.long 0x5d98,0x5db8,0x5dd8,0x5df8,0x61b8,0x6198,0x61f8,0x61d8
.long 0x65d8,0x65f8,0x6598,0x65b8,0x69f8,0x69d8,0x69b8,0x6998
.long 0x5d18,0x5d38,0x5d58,0x5d78,0x6138,0x6118,0x6178,0x6158
.long 0x6558,0x6578,0x6518,0x6538,0x6978,0x6958,0x6938,0x6918
.long 0x5a50,0x3850,0xe0,0x0,0x5b60,0x3960,0xf0,0x7ffff000
.long 0x5c70,0x3a70,0xc0,0x7ffff000,0x5d80,0x3b80,0xd0,0x7ffff000
.long 0x62d0,0x3c90,0xa0,0x7ffff000,0x62d0,0x3da0,0xb0,0x7ffff000
.long 0x63e0,0x3eb0,0x80,0x7ffff000,0x64f0,0x3fc0,0x90,0x7ffff000
.long 0x5e90,0x40d0,0x60,0x7ffff000,0x5fa0,0x41e0,0x70,0x7ffff000
.long 0x60b0,0x42f0,0x40,0x7ffff000,0x61c0,0x4400,0x50,0x7ffff000
.long 0x64f0,0x4510,0x20,0x7ffff000,0x64f0,0x4620,0x30,0x7ffff000
.long 0x6600,0x4730,0x0,0x7ffff000,0x6600,0x4840,0x10,0x7ffff000
.long 0x6710,0x4950,0x40e0,0x7ffff000,0x6820,0x4a60,0x40f0,0x7ffff000
.long 0x6b50,0x4b70,0x40c0,0x7ffff000,0x6d70,0x4c80,0x40d0,0x7ffff000
.long 0x6930,0x4d90,0x40a0,0x7ffff000,0x6a40,0x4ea0,0x40b0,0x7ffff000
.long 0x6c60,0x4fb0,0x4080,0x7ffff000,0x6e80,0x50c0,0x4090,0x7ffff000
.long 0x6f90,0x51d0,0x4060,0x7ffff000,0x6f90,0x52e0,0x4070,0x7ffff000
.long 0x6f90,0x53f0,0x4040,0x7ffff000,0x6f90,0x5500,0x4050,0x7ffff000
.long 0x6e80,0x5610,0x4020,0x7ffff000,0x6e80,0x5720,0x4030,0x7ffff000
.long 0x6e80,0x5830,0x4000,0x7ffff000,0x6e80,0x5940,0x4010,0x7ffff000
.long 0x5a60,0x3860,0x80e0,0x7ffff000,0x5b70,0x3970,0x80f0,0x7ffff000
.long 0x5c80,0x3a80,0x80c0,0x7ffff000,0x5d90,0x3b90,0x80d0,0x7ffff000
.long 0x62e0,0x3ca0,0x80a0,0x7ffff000,0x62e0,0x3db0,0x80b0,0x7ffff000
.long 0x63f0,0x3ec0,0x8080,0x7ffff000,0x6500,0x3fd0,0x8090,0x7ffff000
.long 0x5ea0,0x40e0,0x8060,0x7ffff000,0x5fb0,0x41f0,0x8070,0x7ffff000
.long 0x60c0,0x4300,0x8040,0x7ffff000,0x61d0,0x4410,0x8050,0x7ffff000
.long 0x6500,0x4520,0x8020,0x7ffff000,0x6500,0x4630,0x8030,0x7ffff000
.long 0x6610,0x4740,0x8000,0x7ffff000,0x6610,0x4850,0x8010,0x7ffff000
.long 0x6720,0x4960,0xc0e0,0x7ffff000,0x6830,0x4a70,0xc0f0,0x7ffff000
.long 0x6b60,0x4b80,0xc0c0,0x7ffff000,0x6d80,0x4c90,0xc0d0,0x7ffff000
.long 0x6940,0x4da0,0xc0a0,0x7ffff000,0x6a50,0x4eb0,0xc0b0,0x7ffff000
.long 0x6c70,0x4fc0,0xc080,0x7ffff000,0x6e90,0x50d0,0xc090,0x7ffff000
.long 0x6fa0,0x51e0,0xc060,0x7ffff000,0x6fa0,0x52f0,0xc070,0x7ffff000
.long 0x6fa0,0x5400,0xc040,0x7ffff000,0x6fa0,0x5510,0xc050,0x7ffff000
.long 0x6e90,0x5620,0xc020,0x7ffff000,0x6e90,0x5730,0xc030,0x7ffff000
.long 0x6e90,0x5840,0xc000,0x7ffff000,0x6e90,0x5950,0xc010,0x7ffff000
.long 0x0,0x0,0x1900,0x7800,0x10,0x4,0x1980,0x7d00
.long 0x20,0x8,0x1b00,0x8200,0x30,0xc,0x1b80,0x8700
.long 0x40,0x10,0x1d00,0x8c00,0x50,0x14,0x1d80,0x9100
.long 0x60,0x18,0x1d00,0x9600,0x70,0x1c,0x1d80,0x9b00
.long 0x80,0x20,0x2500,0xa000,0x90,0x24,0x2580,0xa500
.long 0xa0,0x28,0x2700,0xaa00,0xb0,0x2c,0x2780,0xaf00
.long 0xc0,0x30,0x2900,0xb400,0xd0,0x34,0x2980,0xb900
.long 0xe0,0x38,0x2900,0xbe00,0xf0,0x3c,0x2980,0xc300
.long 0x100,0x7ffff000,0x1900,0xc800,0x110,0x7ffff000,0x1980,0xcd00
.long 0x120,0x7ffff000,0x1b00,0xd200,0x130,0x7ffff000,0x1b80,0xd700
.long 0x140,0x7ffff000,0x1d00,0xdc00,0x150,0x7ffff000,0x1d80,0xe100
.long 0x160,0x7ffff000,0x1d00,0xe600,0x170,0x7ffff000,0x1d80,0xeb00
.long 0x180,0x7ffff000,0x2500,0xeb00,0x190,0x7ffff000,0x2580,0xeb00
.long 0x1a0,0x7ffff000,0x2700,0xeb00,0x1b0,0x7ffff000,0x2780,0xeb00
.long 0x1c0,0x7ffff000,0x2900,0xeb00,0x1d0,0x7ffff000,0x2980,0xeb00
.long 0x1e0,0x7ffff000,0x2900,0xeb00,0x1f0,0x7ffff000,0x2980,0xeb00
.long 0x200,0x7ffff000,0x1900,0xeb00,0x210,0x7ffff000,0x1980,0xeb00
.long 0x220,0x7ffff000,0x1b00,0xeb00,0x230,0x7ffff000,0x1b80,0xeb00
.long 0x240,0x7ffff000,0x1d00,0xeb00,0x250,0x7ffff000,0x1d80,0xeb00
.long 0x260,0x7ffff000,0x1d00,0xeb00,0x270,0x7ffff000,0x1d80,0xeb00
.long 0x280,0x7ffff000,0x2500,0xeb00,0x290,0x7ffff000,0x2580,0xeb00
.long 0x2a0,0x7ffff000,0x2700,0xeb00,0x2b0,0x7ffff000,0x2780,0xeb00
.long 0x2c0,0x7ffff000,0x2900,0xeb00,0x2d0,0x7ffff000,0x2980,0xeb00
.long 0x2e0,0x7ffff000,0x2900,0xeb00,0x2f0,0x7ffff000,0x2980,0xeb00
.long 0x300,0x7ffff000,0x1900,0xeb00,0x310,0x7ffff000,0x1980,0xeb00
.long 0x320,0x7ffff000,0x1b00,0xeb00,0x330,0x7ffff000,0x1b80,0xeb00
.long 0x340,0x7ffff000,0x1d00,0xeb00,0x350,0x7ffff000,0x1d80,0xeb00
.long 0x360,0x7ffff000,0x1d00,0xeb00,0x370,0x7ffff000,0x1d80,0xeb00
.long 0x380,0x7ffff000,0x2500,0xeb00,0x390,0x7ffff000,0x2580,0xeb00
.long 0x3a0,0x7ffff000,0x2700,0xeb00,0x3b0,0x7ffff000,0x2780,0xeb00
.long 0x3c0,0x7ffff000,0x2900,0xeb00,0x3d0,0x7ffff000,0x2980,0xeb00
.long 0x3e0,0x7ffff000,0x2900,0xeb00,0x3f0,0x7ffff000,0x2980,0xeb00
.long 0x2494,0x24a0,0x1b60,0xffffffff,0x2498,0x24a0,0x1b64,0xffffffff
.long 0x249c,0x24a4,0x1b68,0xffff,0x24a0,0x24a4,0x1b6c,0x0
.long 0x24a4,0x24a8,0x1b70,0x0,0x24a8,0x24a8,0x1b74,0x0
.long 0x24ac,0x24ac,0x1b78,0x0,0x24b0,0x24ac,0x1b7c,0x0
.long 0x24b4,0x24b0,0x1b80,0x0,0x24b8,0x24b0,0x1b84,0x0
.long 0x24bc,0x24b4,0x1b88,0x0,0x24c0,0x24b4,0x1b8c,0x0
.long 0x24c4,0x24b8,0x1b90,0x0,0x24c8,0x24b8,0x1b94,0x0
.long 0x24cc,0x24bc,0x1b98,0x0,0x24d0,0x24bc,0x1b9c,0x0
.long 0x2484,0x24c0,0x2420,0xffffffff,0x2488,0x24c0,0x2424,0xffffffff
.long 0x248c,0x24c4,0x2428,0x0,0x2490,0x24c4,0x242c,0x0
.long 0x2494,0x24c8,0x2430,0x0,0x2498,0x24c8,0x2434,0x0
.long 0x249c,0x24cc,0x2438,0x0,0x24a0,0x24cc,0x243c,0x0
.long 0x24a4,0x24d0,0x2440,0x0,0x24a8,0x24d0,0x2444,0x0
.long 0x24ac,0x24d4,0x2448,0x0,0x24b0,0x24d4,0x244c,0x0
.long 0x24b4,0x24d8,0x2450,0x0,0x24b8,0x24d8,0x2454,0x0
.long 0x24bc,0x24dc,0x2458,0x0,0x24c0,0x24dc,0x245c,0x0
.long 0x2474,0x24e0,0x2460,0x0,0x2478,0x24e0,0x2464,0x0
.long 0x247c,0x24e4,0x2468,0x0,0x2480,0x24e4,0x246c,0x0
.long 0x2484,0x24e8,0x2470,0x0,0x2488,0x24e8,0x2474,0x0
.long 0x248c,0x24ec,0x2478,0x0,0x2490,0x24ec,0x247c,0x0
.long 0x2494,0x24f0,0x2480,0x0,0x2498,0x24f0,0x2484,0x0
.long 0x249c,0x24f4,0x2488,0x0,0x24a0,0x24f4,0x248c,0x0
.long 0x24a4,0x24f8,0x2490,0x0,0x24a8,0x24f8,0x2494,0x0
.long 0x24ac,0x24fc,0x2498,0x0,0x24b0,0x24fc,0x249c,0x0
.long 0x2464,0x2500,0x2460,0x0,0x2468,0x2500,0x2464,0x0
.long 0x246c,0x2504,0x2468,0x0,0x2470,0x2504,0x246c,0x0
.long 0x2474,0x2508,0x2470,0x0,0x2478,0x2508,0x2474,0x0
.long 0x247c,0x250c,0x2478,0x0,0x2480,0x250c,0x247c,0x0
.long 0x2484,0x2510,0x2480,0x0,0x2488,0x2510,0x2484,0x0
.long 0x248c,0x2514,0x2488,0x0,0x2490,0x2514,0x248c,0x0
.long 0x2494,0x2518,0x2490,0x0,0x2498,0x2518,0x2494,0x0
.long 0x249c,0x251c,0x2498,0x0,0x24a0,0x251c,0x249c,0x0
.long 0x1340,0x135c,0x1340,0x200,0x1350,0x1358,0x1b50,0x208
.long 0x1360,0x1354,0x1360,0x210,0x1370,0x1350,0x1b70,0x218
.long 0x1380,0x134c,0x1380,0x1540,0x1390,0x1348,0x1b90,0x1548
.long 0x13a0,0x1344,0x13a0,0x1550,0x13b0,0x1340,0x1bb0,0x1558
.long 0x13c0,0x1340,0x13c0,0x2880,0x13d0,0x1340,0x1bd0,0x2888
.long 0x13e0,0x1340,0x13e0,0x2890,0x13f0,0x1340,0x1bf0,0x2898
.long 0x1400,0x1340,0x1400,0x3bc0,0x1410,0x1340,0x1c10,0x3bc8
.long 0x1420,0x1340,0x1420,0x3bd0,0x1430,0x1340,0x1c30,0x3bd8
.long 0x1440,0x1340,0x1348,0x220,0x1450,0x1340,0x1b58,0x228
.long 0x1460,0x1340,0x1368,0x230,0x1470,0x1340,0x1b78,0x238
.long 0x1480,0x1340,0x1388,0x1560,0x1490,0x1340,0x1b98,0x1568
.long 0x14a0,0x1340,0x13a8,0x1570,0x14b0,0x1340,0x1bb8,0x1578
.long 0x14c0,0x1340,0x13c8,0x28a0,0x14d0,0x1340,0x1bd8,0x28a8
.long 0x14e0,0x1340,0x13e8,0x28b0,0x14f0,0x1340,0x1bf8,0x28b8
.long 0x1500,0x1340,0x1408,0x3be0,0x1510,0x1340,0x1c18,0x3be8
.long 0x1520,0x1340,0x1428,0x3bf0,0x1530,0x1340,0x1c38,0x3bf8
.long 0x1540,0x1340,0x1350,0x240,0x1550,0x1340,0x1b60,0x248
.long 0x1560,0x1340,0x1370,0x250,0x1570,0x1340,0x1b80,0x258
.long 0x1580,0x1340,0x1390,0x1580,0x1590,0x1340,0x1ba0,0x1588
.long 0x15a0,0x1340,0x13b0,0x1590,0x15b0,0x1340,0x1bc0,0x1598
.long 0x15c0,0x1340,0x13d0,0x28c0,0x15d0,0x1340,0x1be0,0x28c8
.long 0x15e0,0x1340,0x13f0,0x28d0,0x15f0,0x1340,0x1c00,0x28d8
.long 0x1600,0x1340,0x1410,0x3c00,0x1610,0x1340,0x1c20,0x3c08
.long 0x1620,0x1340,0x1430,0x3c10,0x1630,0x1340,0x1c40,0x3c18
.long 0x1640,0x1340,0x1358,0x260,0x1650,0x1340,0x1b68,0x268
.long 0x1660,0x1340,0x1378,0x270,0x1670,0x1340,0x1b88,0x278
.long 0x1680,0x1340,0x1398,0x15a0,0x1690,0x1340,0x1ba8,0x15a8
.long 0x16a0,0x1340,0x13b8,0x15b0,0x16b0,0x1340,0x1bc8,0x15b8
.long 0x16c0,0x1340,0x13d8,0x28e0,0x16d0,0x1340,0x1be8,0x28e8
.long 0x16e0,0x1340,0x13f8,0x28f0,0x16f0,0x1340,0x1c08,0x28f8
.long 0x1700,0x1340,0x1418,0x3c20,0x1710,0x1340,0x1c28,0x3c28
.long 0x1720,0x1340,0x1438,0x3c30,0x1730,0x1340,0x1c48,0x3c38
.long 0x1c00,0x2000,0x2400,0x7e0,0x1344,0x1744,0x1b44,0x760
.long 0x1c04,0x2004,0x2404,0x6f0,0x1348,0x1748,0x1b48,0x670
.long 0x1c08,0x2008,0x2408,0x5c0,0x134c,0x174c,0x1b4c,0x540
.long 0x1c0c,0x200c,0x240c,0x4d0,0x1350,0x1750,0x1b50,0x450
.long 0x1c10,0x2010,0x2410,0x3e0,0x1354,0x1754,0x1b54,0x360
.long 0x1c14,0x2014,0x2414,0x2f0,0x1358,0x1758,0x1b58,0x270
.long 0x1c18,0x2018,0x2418,0x1c0,0x135c,0x175c,0x1b5c,0x140
.long 0x1c1c,0x201c,0x241c,0xd0,0x1360,0x1760,0x1b60,0x50
.long 0x1c10,0x2010,0x2410,0x810,0x1354,0x1754,0x1b54,0x7a0
.long 0x1c14,0x2014,0x2414,0x720,0x1358,0x1758,0x1b58,0x6b0
.long 0x1c18,0x2018,0x2418,0x630,0x135c,0x175c,0x1b5c,0x580
.long 0x1c1c,0x201c,0x241c,0x500,0x1360,0x1760,0x1b60,0x490
.long 0x1c20,0x2020,0x2420,0x410,0x1364,0x1764,0x1b64,0x3a0
.long 0x1c24,0x2024,0x2424,0x320,0x1368,0x1768,0x1b68,0x2b0
.long 0x1c28,0x2028,0x2428,0x230,0x136c,0x176c,0x1b6c,0x180
.long 0x1c2c,0x202c,0x242c,0x100,0x1370,0x1770,0x1b70,0x90
.long 0x1c20,0x2020,0x2420,0x850,0x1364,0x1764,0x1b64,0x7e0
.long 0x1c24,0x2024,0x2424,0x760,0x1368,0x1768,0x1b68,0x6f0
.long 0x1c28,0x2028,0x2428,0x670,0x136c,0x176c,0x1b6c,0x5c0
.long 0x1c2c,0x202c,0x242c,0x540,0x1370,0x1770,0x1b70,0x4d0
.long 0x1c30,0x2030,0x2430,0x450,0x1374,0x1774,0x1b74,0x3e0
.long 0x1c34,0x2034,0x2434,0x360,0x1378,0x1778,0x1b78,0x2f0
.long 0x1c38,0x2038,0x2438,0x270,0x137c,0x177c,0x1b7c,0x1c0
.long 0x1c3c,0x203c,0x243c,0x140,0x1380,0x1780,0x1b80,0xd0
.long 0x1c30,0x2030,0x2430,0x890,0x1374,0x1774,0x1b74,0x810
.long 0x1c34,0x2034,0x2434,0x7a0,0x1378,0x1778,0x1b78,0x720
.long 0x1c38,0x2038,0x2438,0x6b0,0x137c,0x177c,0x1b7c,0x630
.long 0x1c3c,0x203c,0x243c,0x580,0x1380,0x1780,0x1b80,0x500
.long 0x1c40,0x2040,0x2440,0x490,0x1384,0x1784,0x1b84,0x410
.long 0x1c44,0x2044,0x2444,0x3a0,0x1388,0x1788,0x1b88,0x320
.long 0x1c48,0x2048,0x2448,0x2b0,0x138c,0x178c,0x1b8c,0x230
.long 0x1c4c,0x204c,0x244c,0x180,0x1390,0x1790,0x1b90,0x100
.long 0x7a0,0x890,0x980,0xab0,0x720,0x810,0x900,0xa30
.long 0x6b0,0x7a0,0x890,0x980,0x630,0x720,0x810,0x900
.long 0x580,0x6b0,0x7a0,0x890,0x500,0x630,0x720,0x810
.long 0x490,0x580,0x6b0,0x7a0,0x410,0x500,0x630,0x720
.long 0x3a0,0x490,0x580,0x6b0,0x320,0x410,0x500,0x630
.long 0x2b0,0x3a0,0x490,0x580,0x230,0x320,0x410,0x500
.long 0x180,0x2b0,0x3a0,0x490,0x100,0x230,0x320,0x410
.long 0x90,0x180,0x2b0,0x3a0,0x10,0x100,0x230,0x320
.long 0x7e0,0x8d0,0x9c0,0xaf0,0x760,0x850,0x940,0xa70
.long 0x6f0,0x7e0,0x8d0,0x9c0,0x670,0x760,0x850,0x940
.long 0x5c0,0x6f0,0x7e0,0x8d0,0x540,0x670,0x760,0x850
.long 0x4d0,0x5c0,0x6f0,0x7e0,0x450,0x540,0x670,0x760
.long 0x3e0,0x4d0,0x5c0,0x6f0,0x360,0x450,0x540,0x670
.long 0x2f0,0x3e0,0x4d0,0x5c0,0x270,0x360,0x450,0x540
.long 0x1c0,0x2f0,0x3e0,0x4d0,0x140,0x270,0x360,0x450
.long 0xd0,0x1c0,0x2f0,0x3e0,0x50,0x140,0x270,0x360
.long 0x810,0x900,0xa30,0xb20,0x7a0,0x890,0x980,0xab0
.long 0x720,0x810,0x900,0xa30,0x6b0,0x7a0,0x890,0x980
.long 0x630,0x720,0x810,0x900,0x580,0x6b0,0x7a0,0x890
.long 0x500,0x630,0x720,0x810,0x490,0x580,0x6b0,0x7a0
.long 0x410,0x500,0x630,0x720,0x3a0,0x490,0x580,0x6b0
.long 0x320,0x410,0x500,0x630,0x2b0,0x3a0,0x490,0x580
.long 0x230,0x320,0x410,0x500,0x180,0x2b0,0x3a0,0x490
.long 0x100,0x230,0x320,0x410,0x90,0x180,0x2b0,0x3a0
.long 0x850,0x940,0xa70,0xb60,0x7e0,0x8d0,0x9c0,0xaf0
.long 0x760,0x850,0x940,0xa70,0x6f0,0x7e0,0x8d0,0x9c0
.long 0x670,0x760,0x850,0x940,0x5c0,0x6f0,0x7e0,0x8d0
.long 0x540,0x670,0x760,0x850,0x4d0,0x5c0,0x6f0,0x7e0
.long 0x450,0x540,0x670,0x760,0x3e0,0x4d0,0x5c0,0x6f0
.long 0x360,0x450,0x540,0x670,0x2f0,0x3e0,0x4d0,0x5c0
.long 0x270,0x360,0x450,0x540,0x1c0,0x2f0,0x3e0,0x4d0
.long 0x140,0x270,0x360,0x450,0xd0,0x1c0,0x2f0,0x3e0
.long 0x0,0x0,0x5000,0x7400,0x4,0x0,0x5010,0x7410
.long 0x8,0x0,0x5020,0x7420,0xc,0x0,0x5030,0x7430
.long 0x10,0x0,0x5040,0x7440,0x14,0x0,0x5050,0x7450
.long 0x18,0x0,0x5060,0x7460,0x1c,0x0,0x5070,0x7470
.long 0x20,0x0,0x5500,0x7900,0x24,0x0,0x5510,0x7910
.long 0x28,0x0,0x5520,0x7920,0x2c,0x0,0x5530,0x7930
.long 0x7ffff000,0x0,0x5540,0x7940,0x7ffff000,0x0,0x5550,0x7950
.long 0x7ffff000,0x0,0x5560,0x7960,0x7ffff000,0x0,0x5570,0x7970
.long 0x7ffff000,0x8,0x5a20,0x7e20,0x7ffff000,0x8,0x5a30,0x7e30
.long 0x7ffff000,0x8,0x5a00,0x7e00,0x7ffff000,0x8,0x5a10,0x7e10
.long 0x7ffff000,0x8,0x5a60,0x7e60,0x7ffff000,0x8,0x5a70,0x7e70
.long 0x7ffff000,0x8,0x5a40,0x7e40,0x7ffff000,0x8,0x5a50,0x7e50
.long 0x7ffff000,0x8,0x5f20,0x8320,0x7ffff000,0x8,0x5f30,0x8330
.long 0x7ffff000,0x8,0x5f00,0x8300,0x7ffff000,0x8,0x5f10,0x8310
.long 0x7ffff000,0x8,0x5f60,0x8360,0x7ffff000,0x8,0x5f70,0x8370
.long 0x7ffff000,0x8,0x5f40,0x8340,0x7ffff000,0x8,0x5f50,0x8350
.long 0x7ffff000,0x10,0x6440,0x8840,0x7ffff000,0x10,0x6450,0x8850
.long 0x7ffff000,0x10,0x6460,0x8860,0x7ffff000,0x10,0x6470,0x8870
.long 0x7ffff000,0x10,0x6400,0x8800,0x7ffff000,0x10,0x6410,0x8810
.long 0x7ffff000,0x10,0x6420,0x8820,0x7ffff000,0x10,0x6430,0x8830
.long 0x7ffff000,0x10,0x6940,0x8d40,0x7ffff000,0x10,0x6950,0x8d50
.long 0x7ffff000,0x10,0x6960,0x8d60,0x7ffff000,0x10,0x6970,0x8d70
.long 0x7ffff000,0x10,0x6900,0x8d00,0x7ffff000,0x10,0x6910,0x8d10
.long 0x7ffff000,0x10,0x6920,0x8d20,0x7ffff000,0x10,0x6930,0x8d30
.long 0x7ffff000,0x18,0x6e60,0x9260,0x7ffff000,0x18,0x6e70,0x9270
.long 0x7ffff000,0x18,0x6e40,0x9240,0x7ffff000,0x18,0x6e50,0x9250
.long 0x7ffff000,0x18,0x6e20,0x9220,0x7ffff000,0x18,0x6e30,0x9230
.long 0x7ffff000,0x18,0x6e00,0x9200,0x7ffff000,0x18,0x6e10,0x9210
.long 0x7ffff000,0x18,0x7360,0x9760,0x7ffff000,0x18,0x7370,0x9770
.long 0x7ffff000,0x18,0x7340,0x9740,0x7ffff000,0x18,0x7350,0x9750
.long 0x7ffff000,0x18,0x7320,0x9720,0x7ffff000,0x18,0x7330,0x9730
.long 0x7ffff000,0x18,0x7300,0x9700,0x7ffff000,0x18,0x7310,0x9710
.long 0x0,0x0,0x0,0x0,0x0,0x0,0x0,0x0
.long 0x0,0x0,0x0,0x0,0x0,0x0,0x0,0x0
.long 0x0,0x0,0x0,0x0,0x0,0x0,0x0,0x0
.long 0x0,0x0,0x0,0x0,0x0,0x0,0x0,0x0
.long 0x0,0x0,0x0,0x0,0x0,0x0,0x0,0x0
.long 0x0,0x0,0x0,0x0,0x0,0x0,0x0,0x0
.long 0x0,0x0,0x0,0x0,0x0,0x0,0x0,0x3f800000
.long 0x0,0x0,0x0,0x3f803f80,0x0,0x0,0x3f800000,0x3f803f80
.long 0x0,0x0,0x0,0x0,0x0,0x0,0x0,0x0
.long 0x0,0x0,0x0,0x0,0x0,0x0,0x0,0x0
.long 0x0,0x0,0x0,0x0,0x0,0x0,0x0,0x3f800000
.long 0x0,0x0,0x0,0x3f803f80,0x0,0x0,0x3f800000,0x3f803f80
.long 0x0,0x0,0x3f803f80,0x3f803f80,0x0,0x3f800000,0x3f803f80,0x3f803f80
.long 0x0,0x3f803f80,0x3f803f80,0x3f803f80,0x3f800000,0x3f803f80,0x3f803f80,0x3f803f80
.long 0x3f803f80,0x3f803f80,0x3f803f80,0x3f80,0x3f803f80,0x3f803f80,0x3f803f80,0x0
.long 0x3f803f80,0x3f803f80,0x3f80,0x0,0x3f803f80,0x3f803f80,0x0,0x0
.long 0x0,0x0,0x3f803f80,0x3f803f80,0x0,0x3f800000,0x3f803f80,0x3f803f80
.long 0x0,0x3f803f80,0x3f803f80,0x3f803f80,0x3f800000,0x3f803f80,0x3f803f80,0x3f803f80
.long 0x3f803f80,0x3f803f80,0x3f803f80,0x3f80,0x3f803f80,0x3f803f80,0x3f803f80,0x0
.long 0x3f803f80,0x3f803f80,0x3f80,0x0,0x3f803f80,0x3f803f80,0x0,0x0
.long 0x3f803f80,0x3f80,0x0,0x0,0x3f803f80,0x0,0x0,0x0
.long 0x3f80,0x0,0x0,0x0,0x0,0x0,0x0,0x0
.long 0x0,0x0,0x0,0x0,0x0,0x0,0x0,0x0
.long 0x0,0x0,0x0,0x0,0x0,0x0,0x0,0x0
.long 0x3f803f80,0x3f80,0x0,0x0,0x3f803f80,0x0,0x0,0x0
.long 0x3f80,0x0,0x0,0x0,0x0,0x0,0x0,0x0
.long 0x0,0x0,0x0,0x0,0x0,0x0,0x0,0x0
.long 0x0,0x0,0x0,0x0,0x0,0x0,0x0,0x0
.long 0x0,0x0,0x0,0x0,0x0,0x0,0x0,0x0
.long 0x0,0x0,0x0,0x0,0x0,0x0,0x0,0x0
.long 0x0,0x0,0x0,0x0,0x0,0x0,0x0,0x0
.long 0x0,0x0,0x0,0x0,0x0,0x0,0x0,0x0
.long 0x0,0x0,0x0,0x0,0x0,0x0,0x0,0x0
.long 0x0,0x0,0x0,0x0,0x0,0x0,0x0,0x0
.long 0x0,0x0,0x0,0x0,0x0,0x0,0x0,0x0
.long 0x0,0x0,0x0,0x0,0x0,0x0,0x0,0x0
.long 0x0,0x0,0x0,0x0,0x0,0x0,0x0,0x0
.long 0x0,0x0,0x0,0x0,0x0,0x0,0x0,0x0
.long 0x0,0x0,0x0,0x3f800000,0x0,0x0,0x0,0x3f803f80
.long 0x0,0x0,0x3f800000,0x3f803f80,0x0,0x0,0x3f803f80,0x3f803f80
.long 0x0,0x0,0x0,0x0,0x0,0x0,0x0,0x0
.long 0x0,0x0,0x0,0x0,0x0,0x0,0x0,0x0
.long 0x0,0x0,0x0,0x3f800000,0x0,0x0,0x0,0x3f803f80
.long 0x0,0x0,0x3f800000,0x3f803f80,0x0,0x0,0x3f803f80,0x3f803f80
.long 0x0,0x3f800000,0x3f803f80,0x3f803f80,0x0,0x3f803f80,0x3f803f80,0x3f803f80
.long 0x3f800000,0x3f803f80,0x3f803f80,0x3f803f80,0x3f803f80,0x3f803f80,0x3f803f80,0x3f803f80
.long 0x3f803f80,0x3f803f80,0x3f803f80,0x3f803f80,0x3f803f80,0x3f803f80,0x3f803f80,0x3f80
.long 0x3f803f80,0x3f803f80,0x3f803f80,0x0,0x3f803f80,0x3f803f80,0x3f80,0x0
.long 0x0,0x3f800000,0x3f803f80,0x3f803f80,0x0,0x3f803f80,0x3f803f80,0x3f803f80
.long 0x3f800000,0x3f803f80,0x3f803f80,0x3f803f80,0x3f803f80,0x3f803f80,0x3f803f80,0x3f803f80
.long 0x3f803f80,0x3f803f80,0x3f803f80,0x3f803f80,0x3f803f80,0x3f803f80,0x3f803f80,0x3f80
.long 0x3f803f80,0x3f803f80,0x3f803f80,0x0,0x3f803f80,0x3f803f80,0x3f80,0x0
.long 0x3f803f80,0x3f803f80,0x0,0x0,0x3f803f80,0x3f80,0x0,0x0
.long 0x3f803f80,0x0,0x0,0x0,0x3f80,0x0,0x0,0x0
.long 0x0,0x0,0x0,0x0,0x0,0x0,0x0,0x0
.long 0x0,0x0,0x0,0x0,0x0,0x0,0x0,0x0
.long 0x3f803f80,0x3f803f80,0x0,0x0,0x3f803f80,0x3f80,0x0,0x0
.long 0x3f803f80,0x0,0x0,0x0,0x3f80,0x0,0x0,0x0
.long 0x0,0x0,0x0,0x0,0x0,0x0,0x0,0x0
.long 0x0,0x0,0x0,0x0,0x0,0x0,0x0,0x0
.long 0x0,0x0,0x0,0x0,0x0,0x0,0x0,0x0
.long 0x0,0x0,0x0,0x0,0x0,0x0,0x0,0x0
.long 0x0,0x0,0x0,0x0,0x0,0x0,0x0,0x0
.long 0x0,0x0,0x0,0x0,0x0,0x0,0x0,0x0
.long 0x0,0x20,0x40,0x60,0x8,0x28,0x48,0x68
.long 0x10,0x30,0x50,0x70,0x18,0x38,0x58,0x78
.long 0x80,0xa0,0xc0,0xe0,0x88,0xa8,0xc8,0xe8
.long 0x90,0xb0,0xd0,0xf0,0x98,0xb8,0xd8,0xf8
.long 0x120,0x100,0x160,0x140,0x128,0x108,0x168,0x148
.long 0x130,0x110,0x170,0x150,0x138,0x118,0x178,0x158
.long 0x1a0,0x180,0x1e0,0x1c0,0x1a8,0x188,0x1e8,0x1c8
.long 0x1b0,0x190,0x1f0,0x1d0,0x1b8,0x198,0x1f8,0x1d8
.long 0x240,0x260,0x200,0x220,0x248,0x268,0x208,0x228
.long 0x250,0x270,0x210,0x230,0x258,0x278,0x218,0x238
.long 0x2c0,0x2e0,0x280,0x2a0,0x2c8,0x2e8,0x288,0x2a8
.long 0x2d0,0x2f0,0x290,0x2b0,0x2d8,0x2f8,0x298,0x2b8
.long 0x360,0x340,0x320,0x300,0x368,0x348,0x328,0x308
.long 0x370,0x350,0x330,0x310,0x378,0x358,0x338,0x318
.long 0x3e0,0x3c0,0x3a0,0x380,0x3e8,0x3c8,0x3a8,0x388
.long 0x3f0,0x3d0,0x3b0,0x390,0x3f8,0x3d8,0x3b8,0x398
.long 0x400,0x420,0x440,0x460,0x408,0x428,0x448,0x468
.long 0x410,0x430,0x450,0x470,0x418,0x438,0x458,0x478
.long 0x480,0x4a0,0x4c0,0x4e0,0x488,0x4a8,0x4c8,0x4e8
.long 0x490,0x4b0,0x4d0,0x4f0,0x498,0x4b8,0x4d8,0x4f8
.long 0x520,0x500,0x560,0x540,0x528,0x508,0x568,0x548
.long 0x530,0x510,0x570,0x550,0x538,0x518,0x578,0x558
.long 0x5a0,0x580,0x5e0,0x5c0,0x5a8,0x588,0x5e8,0x5c8
.long 0x5b0,0x590,0x5f0,0x5d0,0x5b8,0x598,0x5f8,0x5d8
.long 0x640,0x660,0x600,0x620,0x648,0x668,0x608,0x628
.long 0x650,0x670,0x610,0x630,0x658,0x678,0x618,0x638
.long 0x6c0,0x6e0,0x680,0x6a0,0x6c8,0x6e8,0x688,0x6a8
.long 0x6d0,0x6f0,0x690,0x6b0,0x6d8,0x6f8,0x698,0x6b8
.long 0x760,0x740,0x720,0x700,0x768,0x748,0x728,0x708
.long 0x770,0x750,0x730,0x710,0x778,0x758,0x738,0x718
.long 0x7e0,0x7c0,0x7a0,0x780,0x7e8,0x7c8,0x7a8,0x788
.long 0x7f0,0x7d0,0x7b0,0x790,0x7f8,0x7d8,0x7b8,0x798
.long 0x20000,0x20020,0x800,0x10800,0x20040,0x20060,0x810,0x10810
.long 0x20008,0x20028,0x820,0x10820,0x20048,0x20068,0x830,0x10830
.long 0x20080,0x200a0,0x840,0x10840,0x200c0,0x200e0,0x850,0x10850
.long 0x20088,0x200a8,0x860,0x10860,0x200c8,0x200e8,0x870,0x10870
.long 0x20120,0x20100,0x880,0x10880,0x20160,0x20140,0x890,0x10890
.long 0x20128,0x20108,0x8a0,0x108a0,0x20168,0x20148,0x8b0,0x108b0
.long 0x201a0,0x20180,0x8c0,0x108c0,0x201e0,0x201c0,0x8d0,0x108d0
.long 0x201a8,0x20188,0x8e0,0x108e0,0x201e8,0x201c8,0x8f0,0x108f0
.long 0x20010,0x20030,0x900,0x10900,0x20050,0x20070,0x910,0x10910
.long 0x20018,0x20038,0x920,0x10920,0x20058,0x20078,0x930,0x10930
.long 0x20090,0x200b0,0x940,0x10940,0x200d0,0x200f0,0x950,0x10950
.long 0x20098,0x200b8,0x960,0x10960,0x200d8,0x200f8,0x970,0x10970
.long 0x20130,0x20110,0x980,0x10980,0x20170,0x20150,0x990,0x10990
.long 0x20138,0x20118,0x9a0,0x109a0,0x20178,0x20158,0x9b0,0x109b0
.long 0x201b0,0x20190,0x9c0,0x109c0,0x201f0,0x201d0,0x9d0,0x109d0
.long 0x201b8,0x20198,0x9e0,0x109e0,0x201f8,0x201d8,0x9f0,0x109f0
.long 0x20200,0x20220,0xa00,0x10a00,0x20240,0x20260,0xa10,0x10a10
.long 0x20208,0x20228,0xa20,0x10a20,0x20248,0x20268,0xa30,0x10a30
.long 0x20280,0x202a0,0xa40,0x10a40,0x202c0,0x202e0,0xa50,0x10a50
.long 0x20288,0x202a8,0xa60,0x10a60,0x202c8,0x202e8,0xa70,0x10a70
.long 0x20320,0x20300,0xa80,0x10a80,0x20360,0x20340,0xa90,0x10a90
.long 0x20328,0x20308,0xaa0,0x10aa0,0x20368,0x20348,0xab0,0x10ab0
.long 0x203a0,0x20380,0xac0,0x10ac0,0x203e0,0x203c0,0xad0,0x10ad0
.long 0x203a8,0x20388,0xae0,0x10ae0,0x203e8,0x203c8,0xaf0,0x10af0
.long 0x20210,0x20230,0xb00,0x10b00,0x20250,0x20270,0xb10,0x10b10
.long 0x20218,0x20238,0xb20,0x10b20,0x20258,0x20278,0xb30,0x10b30
.long 0x20290,0x202b0,0xb40,0x10b40,0x202d0,0x202f0,0xb50,0x10b50
.long 0x20298,0x202b8,0xb60,0x10b60,0x202d8,0x202f8,0xb70,0x10b70
.long 0x20330,0x20310,0xb80,0x10b80,0x20370,0x20350,0xb90,0x10b90
.long 0x20338,0x20318,0xba0,0x10ba0,0x20378,0x20358,0xbb0,0x10bb0
.long 0x203b0,0x20390,0xbc0,0x10bc0,0x203f0,0x203d0,0xbd0,0x10bd0
.long 0x203b8,0x20398,0xbe0,0x10be0,0x203f8,0x203d8,0xbf0,0x10bf0
.long 0x1b000,0xa000,0x100,0x400,0x1b010,0xa010,0x110,0x404
.long 0x1b020,0xa020,0x120,0x408,0x1b030,0xa030,0x130,0x40c
.long 0x1b040,0xa040,0x140,0x410,0x1b050,0xa050,0x150,0x414
.long 0x1b060,0xa060,0x160,0x418,0x1b070,0xa070,0x170,0x41c
.long 0x1b090,0xa500,0x180,0x420,0x1b080,0xa510,0x190,0x424
.long 0x1b0b0,0xa520,0x1a0,0x428,0x1b0a0,0xa530,0x1b0,0x42c
.long 0x1b0d0,0xa540,0x1c0,0x430,0x1b0c0,0xa550,0x1d0,0x434
.long 0x1b0f0,0xa560,0x1e0,0x438,0x1b0e0,0xa570,0x1f0,0x43c
.long 0x1b120,0xaa00,0x4100,0x440,0x1b130,0xaa10,0x4110,0x444
.long 0x1b100,0xaa20,0x4120,0x448,0x1b110,0xaa30,0x4130,0x44c
.long 0x1b160,0xaa40,0x4140,0x450,0x1b170,0xaa50,0x4150,0x454
.long 0x1b140,0xaa60,0x4160,0x458,0x1b150,0xaa70,0x4170,0x45c
.long 0x1b1b0,0xaf00,0x4180,0x460,0x1b1a0,0xaf10,0x4190,0x464
.long 0x1b190,0xaf20,0x41a0,0x468,0x1b180,0xaf30,0x41b0,0x46c
.long 0x1b1f0,0xaf40,0x41c0,0x470,0x1b1e0,0xaf50,0x41d0,0x474
.long 0x1b1d0,0xaf60,0x41e0,0x478,0x1b1c0,0xaf70,0x41f0,0x47c
.long 0x1b240,0xb400,0x8100,0x480,0x1b250,0xb410,0x8110,0x484
.long 0x1b260,0xb420,0x8120,0x488,0x1b270,0xb430,0x8130,0x48c
.long 0x1b200,0xb440,0x8140,0x490,0x1b210,0xb450,0x8150,0x494
.long 0x1b220,0xb460,0x8160,0x498,0x1b230,0xb470,0x8170,0x49c
.long 0x1b2d0,0xb900,0x8180,0x4a0,0x1b2c0,0xb910,0x8190,0x4a4
.long 0x1b2f0,0xb920,0x81a0,0x4a8,0x1b2e0,0xb930,0x81b0,0x4ac
.long 0x1b290,0xb940,0x81c0,0x4b0,0x1b280,0xb950,0x81d0,0x4b4
.long 0x1b2b0,0xb960,0x81e0,0x4b8,0x1b2a0,0xb970,0x81f0,0x4bc
.long 0x1b360,0xbe00,0xc100,0x4c0,0x1b370,0xbe10,0xc110,0x4c4
.long 0x1b340,0xbe20,0xc120,0x4c8,0x1b350,0xbe30,0xc130,0x4cc
.long 0x1b320,0xbe40,0xc140,0x4d0,0x1b330,0xbe50,0xc150,0x4d4
.long 0x1b300,0xbe60,0xc160,0x4d8,0x1b310,0xbe70,0xc170,0x4dc
.long 0x1b3f0,0xc300,0xc180,0x4e0,0x1b3e0,0xc310,0xc190,0x4e4
.long 0x1b3d0,0xc320,0xc1a0,0x4e8,0x1b3c0,0xc330,0xc1b0,0x4ec
.long 0x1b3b0,0xc340,0xc1c0,0x4f0,0x1b3a0,0xc350,0xc1d0,0x4f4
.long 0x1b390,0xc360,0xc1e0,0x4f8,0x1b380,0xc370,0xc1f0,0x4fc
.long 0x1b000,0x1b020,0x1b040,0x1b060,0x1b090,0x1b0b0,0x1b0d0,0x1b0f0
.long 0x1b120,0x1b100,0x1b160,0x1b140,0x1b1b0,0x1b190,0x1b1f0,0x1b1d0
.long 0x1b240,0x1b260,0x1b200,0x1b220,0x1b2d0,0x1b2f0,0x1b290,0x1b2b0
.long 0x1b360,0x1b340,0x1b320,0x1b300,0x1b3f0,0x1b3d0,0x1b3b0,0x1b390
.long 0x1b400,0x1b420,0x1b440,0x1b460,0x1b490,0x1b4b0,0x1b4d0,0x1b4f0
.long 0x1b520,0x1b500,0x1b560,0x1b540,0x1b5b0,0x1b590,0x1b5f0,0x1b5d0
.long 0x1b640,0x1b660,0x1b600,0x1b620,0x1b6d0,0x1b6f0,0x1b690,0x1b6b0
.long 0x1b760,0x1b740,0x1b720,0x1b700,0x1b7f0,0x1b7d0,0x1b7b0,0x1b790
.long 0x1b008,0x1b028,0x1b048,0x1b068,0x1b098,0x1b0b8,0x1b0d8,0x1b0f8
.long 0x1b128,0x1b108,0x1b168,0x1b148,0x1b1b8,0x1b198,0x1b1f8,0x1b1d8
.long 0x1b248,0x1b268,0x1b208,0x1b228,0x1b2d8,0x1b2f8,0x1b298,0x1b2b8
.long 0x1b368,0x1b348,0x1b328,0x1b308,0x1b3f8,0x1b3d8,0x1b3b8,0x1b398
.long 0x1b408,0x1b428,0x1b448,0x1b468,0x1b498,0x1b4b8,0x1b4d8,0x1b4f8
.long 0x1b528,0x1b508,0x1b568,0x1b548,0x1b5b8,0x1b598,0x1b5f8,0x1b5d8
.long 0x1b648,0x1b668,0x1b608,0x1b628,0x1b6d8,0x1b6f8,0x1b698,0x1b6b8
.long 0x1b768,0x1b748,0x1b728,0x1b708,0x1b7f8,0x1b7d8,0x1b7b8,0x1b798
.long 0x1b010,0x1b030,0x1b050,0x1b070,0x1b080,0x1b0a0,0x1b0c0,0x1b0e0
.long 0x1b130,0x1b110,0x1b170,0x1b150,0x1b1a0,0x1b180,0x1b1e0,0x1b1c0
.long 0x1b250,0x1b270,0x1b210,0x1b230,0x1b2c0,0x1b2e0,0x1b280,0x1b2a0
.long 0x1b370,0x1b350,0x1b330,0x1b310,0x1b3e0,0x1b3c0,0x1b3a0,0x1b380
.long 0x1b410,0x1b430,0x1b450,0x1b470,0x1b480,0x1b4a0,0x1b4c0,0x1b4e0
.long 0x1b530,0x1b510,0x1b570,0x1b550,0x1b5a0,0x1b580,0x1b5e0,0x1b5c0
.long 0x1b650,0x1b670,0x1b610,0x1b630,0x1b6c0,0x1b6e0,0x1b680,0x1b6a0
.long 0x1b770,0x1b750,0x1b730,0x1b710,0x1b7e0,0x1b7c0,0x1b7a0,0x1b780
.long 0x1b018,0x1b038,0x1b058,0x1b078,0x1b088,0x1b0a8,0x1b0c8,0x1b0e8
.long 0x1b138,0x1b118,0x1b178,0x1b158,0x1b1a8,0x1b188,0x1b1e8,0x1b1c8
.long 0x1b258,0x1b278,0x1b218,0x1b238,0x1b2c8,0x1b2e8,0x1b288,0x1b2a8
.long 0x1b378,0x1b358,0x1b338,0x1b318,0x1b3e8,0x1b3c8,0x1b3a8,0x1b388
.long 0x1b418,0x1b438,0x1b458,0x1b478,0x1b488,0x1b4a8,0x1b4c8,0x1b4e8
.long 0x1b538,0x1b518,0x1b578,0x1b558,0x1b5a8,0x1b588,0x1b5e8,0x1b5c8
.long 0x1b658,0x1b678,0x1b618,0x1b638,0x1b6c8,0x1b6e8,0x1b688,0x1b6a8
.long 0x1b778,0x1b758,0x1b738,0x1b718,0x1b7e8,0x1b7c8,0x1b7a8,0x1b788
.long 0x1280,0x1260,0x1,0x2,0x1284,0x1264,0x1,0x2
.long 0x1288,0x1268,0x1,0x2,0x128c,0x126c,0x1,0x2
.long 0x1290,0x1270,0x1,0x2,0x1294,0x1274,0x1,0x2
.long 0x1298,0x1278,0x1,0x2,0x129c,0x127c,0x1,0x2
.long 0x1280,0x1280,0x1,0x2,0x1284,0x1284,0x1,0x2
.long 0x1288,0x1288,0x1,0x2,0x128c,0x128c,0x1,0x2
.long 0x1290,0x1290,0x1,0x2,0x1294,0x1294,0x1,0x2
.long 0x1298,0x1298,0x1,0x2,0x129c,0x129c,0x1,0x2
.long 0x1280,0x12a0,0x1,0x2,0x1284,0x12a4,0x1,0x2
.long 0x1288,0x12a8,0x1,0x2,0x128c,0x12ac,0x1,0x2
.long 0x1290,0x12b0,0x1,0x2,0x1294,0x12b4,0x1,0x2
.long 0x1298,0x12b8,0x1,0x2,0x129c,0x12bc,0x1,0x2
.long 0x1280,0x12c0,0x1,0x2,0x1284,0x12c4,0x1,0x2
.long 0x1288,0x12c8,0x1,0x2,0x128c,0x12cc,0x1,0x2
.long 0x1290,0x12d0,0x1,0x2,0x1294,0x12d4,0x1,0x2
.long 0x1298,0x12d8,0x1,0x2,0x129c,0x12dc,0x1,0x2
.long 0x1280,0x1260,0x1,0x2,0x1284,0x1264,0x1,0x2
.long 0x1288,0x1268,0x1,0x2,0x128c,0x126c,0x1,0x2
.long 0x1290,0x1270,0x1,0x2,0x1294,0x1274,0x1,0x2
.long 0x1298,0x1278,0x1,0x2,0x129c,0x127c,0x1,0x2
.long 0x1280,0x1280,0x1,0x2,0x1284,0x1284,0x1,0x2
.long 0x1288,0x1288,0x1,0x2,0x128c,0x128c,0x1,0x2
.long 0x1290,0x1290,0x1,0x2,0x1294,0x1294,0x1,0x2
.long 0x1298,0x1298,0x1,0x2,0x129c,0x129c,0x1,0x2
.long 0x1280,0x12a0,0x1,0x2,0x1284,0x12a4,0x1,0x2
.long 0x1288,0x12a8,0x1,0x2,0x128c,0x12ac,0x1,0x2
.long 0x1290,0x12b0,0x1,0x2,0x1294,0x12b4,0x1,0x2
.long 0x1298,0x12b8,0x1,0x2,0x129c,0x12bc,0x1,0x2
.long 0x1280,0x12c0,0x1,0x2,0x1284,0x12c4,0x1,0x2
.long 0x1288,0x12c8,0x1,0x2,0x128c,0x12cc,0x1,0x2
.long 0x1290,0x12d0,0x1,0x2,0x1294,0x12d4,0x1,0x2
.long 0x1298,0x12d8,0x1,0x2,0x129c,0x12dc,0x1,0x2
.long 0x6e90,0x6eb0,0x6ed0,0x6ef0,0x72b0,0x7290,0x72f0,0x72d0
.long 0x76d0,0x76f0,0x7690,0x76b0,0x7af0,0x7ad0,0x7ab0,0x7a90
.long 0x6e10,0x6e30,0x6e50,0x6e70,0x7230,0x7210,0x7270,0x7250
.long 0x7650,0x7670,0x7610,0x7630,0x7a70,0x7a50,0x7a30,0x7a10
.long 0x6d80,0x6da0,0x6dc0,0x6de0,0x71a0,0x7180,0x71e0,0x71c0
.long 0x75c0,0x75e0,0x7580,0x75a0,0x79e0,0x79c0,0x79a0,0x7980
.long 0x6d00,0x6d20,0x6d40,0x6d60,0x7120,0x7100,0x7160,0x7140
.long 0x7540,0x7560,0x7500,0x7520,0x7960,0x7940,0x7920,0x7900
.long 0x6e98,0x6eb8,0x6ed8,0x6ef8,0x72b8,0x7298,0x72f8,0x72d8
.long 0x76d8,0x76f8,0x7698,0x76b8,0x7af8,0x7ad8,0x7ab8,0x7a98
.long 0x6e18,0x6e38,0x6e58,0x6e78,0x7238,0x7218,0x7278,0x7258
.long 0x7658,0x7678,0x7618,0x7638,0x7a78,0x7a58,0x7a38,0x7a18
.long 0x6d88,0x6da8,0x6dc8,0x6de8,0x71a8,0x7188,0x71e8,0x71c8
.long 0x75c8,0x75e8,0x7588,0x75a8,0x79e8,0x79c8,0x79a8,0x7988
.long 0x6d08,0x6d28,0x6d48,0x6d68,0x7128,0x7108,0x7168,0x7148
.long 0x7548,0x7568,0x7508,0x7528,0x7968,0x7948,0x7928,0x7908
.long 0x6e80,0x6ea0,0x6ec0,0x6ee0,0x72a0,0x7280,0x72e0,0x72c0
.long 0x76c0,0x76e0,0x7680,0x76a0,0x7ae0,0x7ac0,0x7aa0,0x7a80
.long 0x6e00,0x6e20,0x6e40,0x6e60,0x7220,0x7200,0x7260,0x7240
.long 0x7640,0x7660,0x7600,0x7620,0x7a60,0x7a40,0x7a20,0x7a00
.long 0x6d90,0x6db0,0x6dd0,0x6df0,0x71b0,0x7190,0x71f0,0x71d0
.long 0x75d0,0x75f0,0x7590,0x75b0,0x79f0,0x79d0,0x79b0,0x7990
.long 0x6d10,0x6d30,0x6d50,0x6d70,0x7130,0x7110,0x7170,0x7150
.long 0x7550,0x7570,0x7510,0x7530,0x7970,0x7950,0x7930,0x7910
.long 0x6e88,0x6ea8,0x6ec8,0x6ee8,0x72a8,0x7288,0x72e8,0x72c8
.long 0x76c8,0x76e8,0x7688,0x76a8,0x7ae8,0x7ac8,0x7aa8,0x7a88
.long 0x6e08,0x6e28,0x6e48,0x6e68,0x7228,0x7208,0x7268,0x7248
.long 0x7648,0x7668,0x7608,0x7628,0x7a68,0x7a48,0x7a28,0x7a08
.long 0x6d98,0x6db8,0x6dd8,0x6df8,0x71b8,0x7198,0x71f8,0x71d8
.long 0x75d8,0x75f8,0x7598,0x75b8,0x79f8,0x79d8,0x79b8,0x7998
.long 0x6d18,0x6d38,0x6d58,0x6d78,0x7138,0x7118,0x7178,0x7158
.long 0x7558,0x7578,0x7518,0x7538,0x7978,0x7958,0x7938,0x7918
.long 0x92a0,0x70a0,0xd0,0x0,0x93b0,0x71b0,0xc0,0x7ffff000
.long 0x94c0,0x72c0,0xf0,0x7ffff000,0x95d0,0x73d0,0xe0,0x7ffff000
.long 0x9b20,0x74e0,0x90,0x7ffff000,0x9b20,0x75f0,0x80,0x7ffff000
.long 0x9c30,0x7700,0xb0,0x7ffff000,0x9d40,0x7810,0xa0,0x7ffff000
.long 0x96e0,0x7920,0x50,0x7ffff000,0x97f0,0x7a30,0x40,0x7ffff000
.long 0x9900,0x7b40,0x70,0x7ffff000,0x9a10,0x7c50,0x60,0x7ffff000
.long 0x9d40,0x7d60,0x10,0x7ffff000,0x9d40,0x7e70,0x0,0x7ffff000
.long 0x9e50,0x7f80,0x30,0x7ffff000,0x9e50,0x8090,0x20,0x7ffff000
.long 0x9f60,0x81a0,0x40d0,0x7ffff000,0xa070,0x82b0,0x40c0,0x7ffff000
.long 0xa3a0,0x83c0,0x40f0,0x7ffff000,0xa5c0,0x84d0,0x40e0,0x7ffff000
.long 0xa180,0x85e0,0x4090,0x7ffff000,0xa290,0x86f0,0x4080,0x7ffff000
.long 0xa4b0,0x8800,0x40b0,0x7ffff000,0xa6d0,0x8910,0x40a0,0x7ffff000
.long 0xa7e0,0x8a20,0x4050,0x7ffff000,0xa7e0,0x8b30,0x4040,0x7ffff000
.long 0xa7e0,0x8c40,0x4070,0x7ffff000,0xa7e0,0x8d50,0x4060,0x7ffff000
.long 0xa6d0,0x8e60,0x4010,0x7ffff000,0xa6d0,0x8f70,0x4000,0x7ffff000
.long 0xa6d0,0x9080,0x4030,0x7ffff000,0xa6d0,0x9190,0x4020,0x7ffff000
.long 0x92b0,0x70b0,0x80d0,0x7ffff000,0x93c0,0x71c0,0x80c0,0x7ffff000
.long 0x94d0,0x72d0,0x80f0,0x7ffff000,0x95e0,0x73e0,0x80e0,0x7ffff000
.long 0x9b30,0x74f0,0x8090,0x7ffff000,0x9b30,0x7600,0x8080,0x7ffff000
.long 0x9c40,0x7710,0x80b0,0x7ffff000,0x9d50,0x7820,0x80a0,0x7ffff000
.long 0x96f0,0x7930,0x8050,0x7ffff000,0x9800,0x7a40,0x8040,0x7ffff000
.long 0x9910,0x7b50,0x8070,0x7ffff000,0x9a20,0x7c60,0x8060,0x7ffff000
.long 0x9d50,0x7d70,0x8010,0x7ffff000,0x9d50,0x7e80,0x8000,0x7ffff000
.long 0x9e60,0x7f90,0x8030,0x7ffff000,0x9e60,0x80a0,0x8020,0x7ffff000
.long 0x9f70,0x81b0,0xc0d0,0x7ffff000,0xa080,0x82c0,0xc0c0,0x7ffff000
.long 0xa3b0,0x83d0,0xc0f0,0x7ffff000,0xa5d0,0x84e0,0xc0e0,0x7ffff000
.long 0xa190,0x85f0,0xc090,0x7ffff000,0xa2a0,0x8700,0xc080,0x7ffff000
.long 0xa4c0,0x8810,0xc0b0,0x7ffff000,0xa6e0,0x8920,0xc0a0,0x7ffff000
.long 0xa7f0,0x8a30,0xc050,0x7ffff000,0xa7f0,0x8b40,0xc040,0x7ffff000
.long 0xa7f0,0x8c50,0xc070,0x7ffff000,0xa7f0,0x8d60,0xc060,0x7ffff000
.long 0xa6e0,0x8e70,0xc010,0x7ffff000,0xa6e0,0x8f80,0xc000,0x7ffff000
.long 0xa6e0,0x9090,0xc030,0x7ffff000,0xa6e0,0x91a0,0xc020,0x7ffff000
.long 0x0,0x0,0x3100,0xf000,0x10,0x4,0x3180,0xf500
.long 0x20,0x8,0x3300,0xfa00,0x30,0xc,0x3380,0xff00
.long 0x40,0x10,0x3500,0x10400,0x50,0x14,0x3580,0x10900
.long 0x60,0x18,0x3500,0x10e00,0x70,0x1c,0x3580,0x11300
.long 0x80,0x20,0x3d00,0x11800,0x90,0x24,0x3d80,0x11d00
.long 0xa0,0x28,0x3f00,0x12200,0xb0,0x2c,0x3f80,0x12700
.long 0xc0,0x30,0x4100,0x12c00,0xd0,0x34,0x4180,0x13100
.long 0xe0,0x38,0x4100,0x13600,0xf0,0x3c,0x4180,0x13b00
.long 0x100,0x7ffff000,0x3100,0x14000,0x110,0x7ffff000,0x3180,0x14500
.long 0x120,0x7ffff000,0x3300,0x14a00,0x130,0x7ffff000,0x3380,0x14f00
.long 0x140,0x7ffff000,0x3500,0x15400,0x150,0x7ffff000,0x3580,0x15900
.long 0x160,0x7ffff000,0x3500,0x15e00,0x170,0x7ffff000,0x3580,0x16300
.long 0x180,0x7ffff000,0x3d00,0x16300,0x190,0x7ffff000,0x3d80,0x16300
.long 0x1a0,0x7ffff000,0x3f00,0x16300,0x1b0,0x7ffff000,0x3f80,0x16300
.long 0x1c0,0x7ffff000,0x4100,0x16300,0x1d0,0x7ffff000,0x4180,0x16300
.long 0x1e0,0x7ffff000,0x4100,0x16300,0x1f0,0x7ffff000,0x4180,0x16300
.long 0x200,0x7ffff000,0x3100,0x16300,0x210,0x7ffff000,0x3180,0x16300
.long 0x220,0x7ffff000,0x3300,0x16300,0x230,0x7ffff000,0x3380,0x16300
.long 0x240,0x7ffff000,0x3500,0x16300,0x250,0x7ffff000,0x3580,0x16300
.long 0x260,0x7ffff000,0x3500,0x16300,0x270,0x7ffff000,0x3580,0x16300
.long 0x280,0x7ffff000,0x3d00,0x16300,0x290,0x7ffff000,0x3d80,0x16300
.long 0x2a0,0x7ffff000,0x3f00,0x16300,0x2b0,0x7ffff000,0x3f80,0x16300
.long 0x2c0,0x7ffff000,0x4100,0x16300,0x2d0,0x7ffff000,0x4180,0x16300
.long 0x2e0,0x7ffff000,0x4100,0x16300,0x2f0,0x7ffff000,0x4180,0x16300
.long 0x300,0x7ffff000,0x3100,0x16300,0x310,0x7ffff000,0x3180,0x16300
.long 0x320,0x7ffff000,0x3300,0x16300,0x330,0x7ffff000,0x3380,0x16300
.long 0x340,0x7ffff000,0x3500,0x16300,0x350,0x7ffff000,0x3580,0x16300
.long 0x360,0x7ffff000,0x3500,0x16300,0x370,0x7ffff000,0x3580,0x16300
.long 0x380,0x7ffff000,0x3d00,0x16300,0x390,0x7ffff000,0x3d80,0x16300
.long 0x3a0,0x7ffff000,0x3f00,0x16300,0x3b0,0x7ffff000,0x3f80,0x16300
.long 0x3c0,0x7ffff000,0x4100,0x16300,0x3d0,0x7ffff000,0x4180,0x16300
.long 0x3e0,0x7ffff000,0x4100,0x16300,0x3f0,0x7ffff000,0x4180,0x16300
.long 0x37d4,0x37e0,0x2ea0,0xffffffff,0x37d8,0x37e0,0x2ea4,0xffffffff
.long 0x37dc,0x37e4,0x2ea8,0xffff,0x37e0,0x37e4,0x2eac,0x0
.long 0x37e4,0x37e8,0x2eb0,0x0,0x37e8,0x37e8,0x2eb4,0x0
.long 0x37ec,0x37ec,0x2eb8,0x0,0x37f0,0x37ec,0x2ebc,0x0
.long 0x37f4,0x37f0,0x2ec0,0x0,0x37f8,0x37f0,0x2ec4,0x0
.long 0x37fc,0x37f4,0x2ec8,0x0,0x3800,0x37f4,0x2ecc,0x0
.long 0x3804,0x37f8,0x2ed0,0x0,0x3808,0x37f8,0x2ed4,0x0
.long 0x380c,0x37fc,0x2ed8,0x0,0x3810,0x37fc,0x2edc,0x0
.long 0x37c4,0x3800,0x3760,0xffffffff,0x37c8,0x3800,0x3764,0xffffffff
.long 0x37cc,0x3804,0x3768,0x0,0x37d0,0x3804,0x376c,0x0
.long 0x37d4,0x3808,0x3770,0x0,0x37d8,0x3808,0x3774,0x0
.long 0x37dc,0x380c,0x3778,0x0,0x37e0,0x380c,0x377c,0x0
.long 0x37e4,0x3810,0x3780,0x0,0x37e8,0x3810,0x3784,0x0
.long 0x37ec,0x3814,0x3788,0x0,0x37f0,0x3814,0x378c,0x0
.long 0x37f4,0x3818,0x3790,0x0,0x37f8,0x3818,0x3794,0x0
.long 0x37fc,0x381c,0x3798,0x0,0x3800,0x381c,0x379c,0x0
.long 0x37b4,0x3820,0x37a0,0x0,0x37b8,0x3820,0x37a4,0x0
.long 0x37bc,0x3824,0x37a8,0x0,0x37c0,0x3824,0x37ac,0x0
.long 0x37c4,0x3828,0x37b0,0x0,0x37c8,0x3828,0x37b4,0x0
.long 0x37cc,0x382c,0x37b8,0x0,0x37d0,0x382c,0x37bc,0x0
.long 0x37d4,0x3830,0x37c0,0x0,0x37d8,0x3830,0x37c4,0x0
.long 0x37dc,0x3834,0x37c8,0x0,0x37e0,0x3834,0x37cc,0x0
.long 0x37e4,0x3838,0x37d0,0x0,0x37e8,0x3838,0x37d4,0x0
.long 0x37ec,0x383c,0x37d8,0x0,0x37f0,0x383c,0x37dc,0x0
.long 0x37a4,0x3840,0x37a0,0x0,0x37a8,0x3840,0x37a4,0x0
.long 0x37ac,0x3844,0x37a8,0x0,0x37b0,0x3844,0x37ac,0x0
.long 0x37b4,0x3848,0x37b0,0x0,0x37b8,0x3848,0x37b4,0x0
.long 0x37bc,0x384c,0x37b8,0x0,0x37c0,0x384c,0x37bc,0x0
.long 0x37c4,0x3850,0x37c0,0x0,0x37c8,0x3850,0x37c4,0x0
.long 0x37cc,0x3854,0x37c8,0x0,0x37d0,0x3854,0x37cc,0x0
.long 0x37d4,0x3858,0x37d0,0x0,0x37d8,0x3858,0x37d4,0x0
.long 0x37dc,0x385c,0x37d8,0x0,0x37e0,0x385c,0x37dc,0x0
.long 0x2680,0x269c,0x2680,0x400,0x2690,0x2698,0x2e90,0x408
.long 0x26a0,0x2694,0x26a0,0x410,0x26b0,0x2690,0x2eb0,0x418
.long 0x26c0,0x268c,0x26c0,0x1740,0x26d0,0x2688,0x2ed0,0x1748
.long 0x26e0,0x2684,0x26e0,0x1750,0x26f0,0x2680,0x2ef0,0x1758
.long 0x2700,0x2680,0x2700,0x2a80,0x2710,0x2680,0x2f10,0x2a88
.long 0x2720,0x2680,0x2720,0x2a90,0x2730,0x2680,0x2f30,0x2a98
.long 0x2740,0x2680,0x2740,0x3dc0,0x2750,0x2680,0x2f50,0x3dc8
.long 0x2760,0x2680,0x2760,0x3dd0,0x2770,0x2680,0x2f70,0x3dd8
.long 0x2780,0x2680,0x2688,0x420,0x2790,0x2680,0x2e98,0x428
.long 0x27a0,0x2680,0x26a8,0x430,0x27b0,0x2680,0x2eb8,0x438
.long 0x27c0,0x2680,0x26c8,0x1760,0x27d0,0x2680,0x2ed8,0x1768
.long 0x27e0,0x2680,0x26e8,0x1770,0x27f0,0x2680,0x2ef8,0x1778
.long 0x2800,0x2680,0x2708,0x2aa0,0x2810,0x2680,0x2f18,0x2aa8
.long 0x2820,0x2680,0x2728,0x2ab0,0x2830,0x2680,0x2f38,0x2ab8
.long 0x2840,0x2680,0x2748,0x3de0,0x2850,0x2680,0x2f58,0x3de8
.long 0x2860,0x2680,0x2768,0x3df0,0x2870,0x2680,0x2f78,0x3df8
.long 0x2880,0x2680,0x2690,0x440,0x2890,0x2680,0x2ea0,0x448
.long 0x28a0,0x2680,0x26b0,0x450,0x28b0,0x2680,0x2ec0,0x458
.long 0x28c0,0x2680,0x26d0,0x1780,0x28d0,0x2680,0x2ee0,0x1788
.long 0x28e0,0x2680,0x26f0,0x1790,0x28f0,0x2680,0x2f00,0x1798
.long 0x2900,0x2680,0x2710,0x2ac0,0x2910,0x2680,0x2f20,0x2ac8
.long 0x2920,0x2680,0x2730,0x2ad0,0x2930,0x2680,0x2f40,0x2ad8
.long 0x2940,0x2680,0x2750,0x3e00,0x2950,0x2680,0x2f60,0x3e08
.long 0x2960,0x2680,0x2770,0x3e10,0x2970,0x2680,0x2f80,0x3e18
.long 0x2980,0x2680,0x2698,0x460,0x2990,0x2680,0x2ea8,0x468
.long 0x29a0,0x2680,0x26b8,0x470,0x29b0,0x2680,0x2ec8,0x478
.long 0x29c0,0x2680,0x26d8,0x17a0,0x29d0,0x2680,0x2ee8,0x17a8
.long 0x29e0,0x2680,0x26f8,0x17b0,0x29f0,0x2680,0x2f08,0x17b8
.long 0x2a00,0x2680,0x2718,0x2ae0,0x2a10,0x2680,0x2f28,0x2ae8
.long 0x2a20,0x2680,0x2738,0x2af0,0x2a30,0x2680,0x2f48,0x2af8
.long 0x2a40,0x2680,0x2758,0x3e20,0x2a50,0x2680,0x2f68,0x3e28
.long 0x2a60,0x2680,0x2778,0x3e30,0x2a70,0x2680,0x2f88,0x3e38
.long 0x2f40,0x3340,0x3740,0x7d0,0x2684,0x2a84,0x2e84,0x750
.long 0x2f44,0x3344,0x3744,0x6c0,0x2688,0x2a88,0x2e88,0x640
.long 0x2f48,0x3348,0x3748,0x5f0,0x268c,0x2a8c,0x2e8c,0x570
.long 0x2f4c,0x334c,0x374c,0x4e0,0x2690,0x2a90,0x2e90,0x460
.long 0x2f50,0x3350,0x3750,0x3d0,0x2694,0x2a94,0x2e94,0x350
.long 0x2f54,0x3354,0x3754,0x2c0,0x2698,0x2a98,0x2e98,0x240
.long 0x2f58,0x3358,0x3758,0x1f0,0x269c,0x2a9c,0x2e9c,0x170
.long 0x2f5c,0x335c,0x375c,0xe0,0x26a0,0x2aa0,0x2ea0,0x60
.long 0x2f50,0x3350,0x3750,0x820,0x2694,0x2a94,0x2e94,0x790
.long 0x2f54,0x3354,0x3754,0x710,0x2698,0x2a98,0x2e98,0x680
.long 0x2f58,0x3358,0x3758,0x600,0x269c,0x2a9c,0x2e9c,0x5b0
.long 0x2f5c,0x335c,0x375c,0x530,0x26a0,0x2aa0,0x2ea0,0x4a0
.long 0x2f60,0x3360,0x3760,0x420,0x26a4,0x2aa4,0x2ea4,0x390
.long 0x2f64,0x3364,0x3764,0x310,0x26a8,0x2aa8,0x2ea8,0x280
.long 0x2f68,0x3368,0x3768,0x200,0x26ac,0x2aac,0x2eac,0x1b0
.long 0x2f6c,0x336c,0x376c,0x130,0x26b0,0x2ab0,0x2eb0,0xa0
.long 0x2f60,0x3360,0x3760,0x860,0x26a4,0x2aa4,0x2ea4,0x7d0
.long 0x2f64,0x3364,0x3764,0x750,0x26a8,0x2aa8,0x2ea8,0x6c0
.long 0x2f68,0x3368,0x3768,0x640,0x26ac,0x2aac,0x2eac,0x5f0
.long 0x2f6c,0x336c,0x376c,0x570,0x26b0,0x2ab0,0x2eb0,0x4e0
.long 0x2f70,0x3370,0x3770,0x460,0x26b4,0x2ab4,0x2eb4,0x3d0
.long 0x2f74,0x3374,0x3774,0x350,0x26b8,0x2ab8,0x2eb8,0x2c0
.long 0x2f78,0x3378,0x3778,0x240,0x26bc,0x2abc,0x2ebc,0x1f0
.long 0x2f7c,0x337c,0x377c,0x170,0x26c0,0x2ac0,0x2ec0,0xe0
.long 0x2f70,0x3370,0x3770,0x8a0,0x26b4,0x2ab4,0x2eb4,0x820
.long 0x2f74,0x3374,0x3774,0x790,0x26b8,0x2ab8,0x2eb8,0x710
.long 0x2f78,0x3378,0x3778,0x680,0x26bc,0x2abc,0x2ebc,0x600
.long 0x2f7c,0x337c,0x377c,0x5b0,0x26c0,0x2ac0,0x2ec0,0x530
.long 0x2f80,0x3380,0x3780,0x4a0,0x26c4,0x2ac4,0x2ec4,0x420
.long 0x2f84,0x3384,0x3784,0x390,0x26c8,0x2ac8,0x2ec8,0x310
.long 0x2f88,0x3388,0x3788,0x280,0x26cc,0x2acc,0x2ecc,0x200
.long 0x2f8c,0x338c,0x378c,0x1b0,0x26d0,0x2ad0,0x2ed0,0x130
.long 0x790,0x8a0,0x9b0,0xa80,0x710,0x820,0x930,0xa00
.long 0x680,0x790,0x8a0,0x9b0,0x600,0x710,0x820,0x930
.long 0x5b0,0x680,0x790,0x8a0,0x530,0x600,0x710,0x820
.long 0x4a0,0x5b0,0x680,0x790,0x420,0x530,0x600,0x710
.long 0x390,0x4a0,0x5b0,0x680,0x310,0x420,0x530,0x600
.long 0x280,0x390,0x4a0,0x5b0,0x200,0x310,0x420,0x530
.long 0x1b0,0x280,0x390,0x4a0,0x130,0x200,0x310,0x420
.long 0xa0,0x1b0,0x280,0x390,0x20,0x130,0x200,0x310
.long 0x7d0,0x8e0,0x9f0,0xac0,0x750,0x860,0x970,0xa40
.long 0x6c0,0x7d0,0x8e0,0x9f0,0x640,0x750,0x860,0x970
.long 0x5f0,0x6c0,0x7d0,0x8e0,0x570,0x640,0x750,0x860
.long 0x4e0,0x5f0,0x6c0,0x7d0,0x460,0x570,0x640,0x750
.long 0x3d0,0x4e0,0x5f0,0x6c0,0x350,0x460,0x570,0x640
.long 0x2c0,0x3d0,0x4e0,0x5f0,0x240,0x350,0x460,0x570
.long 0x1f0,0x2c0,0x3d0,0x4e0,0x170,0x240,0x350,0x460
.long 0xe0,0x1f0,0x2c0,0x3d0,0x60,0x170,0x240,0x350
.long 0x820,0x930,0xa00,0xb10,0x790,0x8a0,0x9b0,0xa80
.long 0x710,0x820,0x930,0xa00,0x680,0x790,0x8a0,0x9b0
.long 0x600,0x710,0x820,0x930,0x5b0,0x680,0x790,0x8a0
.long 0x530,0x600,0x710,0x820,0x4a0,0x5b0,0x680,0x790
.long 0x420,0x530,0x600,0x710,0x390,0x4a0,0x5b0,0x680
.long 0x310,0x420,0x530,0x600,0x280,0x390,0x4a0,0x5b0
.long 0x200,0x310,0x420,0x530,0x1b0,0x280,0x390,0x4a0
.long 0x130,0x200,0x310,0x420,0xa0,0x1b0,0x280,0x390
.long 0x860,0x970,0xa40,0xb50,0x7d0,0x8e0,0x9f0,0xac0
.long 0x750,0x860,0x970,0xa40,0x6c0,0x7d0,0x8e0,0x9f0
.long 0x640,0x750,0x860,0x970,0x5f0,0x6c0,0x7d0,0x8e0
.long 0x570,0x640,0x750,0x860,0x4e0,0x5f0,0x6c0,0x7d0
.long 0x460,0x570,0x640,0x750,0x3d0,0x4e0,0x5f0,0x6c0
.long 0x350,0x460,0x570,0x640,0x2c0,0x3d0,0x4e0,0x5f0
.long 0x240,0x350,0x460,0x570,0x1f0,0x2c0,0x3d0,0x4e0
.long 0x170,0x240,0x350,0x460,0xe0,0x1f0,0x2c0,0x3d0
.long 0x0,0x0,0xa000,0xc400,0x4,0x0,0xa010,0xc410
.long 0x8,0x0,0xa020,0xc420,0xc,0x0,0xa030,0xc430
.long 0x10,0x0,0xa040,0xc440,0x14,0x0,0xa050,0xc450
.long 0x18,0x0,0xa060,0xc460,0x1c,0x0,0xa070,0xc470
.long 0x20,0x0,0xa500,0xc900,0x24,0x0,0xa510,0xc910
.long 0x28,0x0,0xa520,0xc920,0x2c,0x0,0xa530,0xc930
.long 0x7ffff000,0x0,0xa540,0xc940,0x7ffff000,0x0,0xa550,0xc950
.long 0x7ffff000,0x0,0xa560,0xc960,0x7ffff000,0x0,0xa570,0xc970
.long 0x7ffff000,0x8,0xaa20,0xce20,0x7ffff000,0x8,0xaa30,0xce30
.long 0x7ffff000,0x8,0xaa00,0xce00,0x7ffff000,0x8,0xaa10,0xce10
.long 0x7ffff000,0x8,0xaa60,0xce60,0x7ffff000,0x8,0xaa70,0xce70
.long 0x7ffff000,0x8,0xaa40,0xce40,0x7ffff000,0x8,0xaa50,0xce50
.long 0x7ffff000,0x8,0xaf20,0xd320,0x7ffff000,0x8,0xaf30,0xd330
.long 0x7ffff000,0x8,0xaf00,0xd300,0x7ffff000,0x8,0xaf10,0xd310
.long 0x7ffff000,0x8,0xaf60,0xd360,0x7ffff000,0x8,0xaf70,0xd370
.long 0x7ffff000,0x8,0xaf40,0xd340,0x7ffff000,0x8,0xaf50,0xd350
.long 0x7ffff000,0x10,0xb440,0xd840,0x7ffff000,0x10,0xb450,0xd850
.long 0x7ffff000,0x10,0xb460,0xd860,0x7ffff000,0x10,0xb470,0xd870
.long 0x7ffff000,0x10,0xb400,0xd800,0x7ffff000,0x10,0xb410,0xd810
.long 0x7ffff000,0x10,0xb420,0xd820,0x7ffff000,0x10,0xb430,0xd830
.long 0x7ffff000,0x10,0xb940,0xdd40,0x7ffff000,0x10,0xb950,0xdd50
.long 0x7ffff000,0x10,0xb960,0xdd60,0x7ffff000,0x10,0xb970,0xdd70
.long 0x7ffff000,0x10,0xb900,0xdd00,0x7ffff000,0x10,0xb910,0xdd10
.long 0x7ffff000,0x10,0xb920,0xdd20,0x7ffff000,0x10,0xb930,0xdd30
.long 0x7ffff000,0x18,0xbe60,0xe260,0x7ffff000,0x18,0xbe70,0xe270
.long 0x7ffff000,0x18,0xbe40,0xe240,0x7ffff000,0x18,0xbe50,0xe250
.long 0x7ffff000,0x18,0xbe20,0xe220,0x7ffff000,0x18,0xbe30,0xe230
.long 0x7ffff000,0x18,0xbe00,0xe200,0x7ffff000,0x18,0xbe10,0xe210
.long 0x7ffff000,0x18,0xc360,0xe760,0x7ffff000,0x18,0xc370,0xe770
.long 0x7ffff000,0x18,0xc340,0xe740,0x7ffff000,0x18,0xc350,0xe750
.long 0x7ffff000,0x18,0xc320,0xe720,0x7ffff000,0x18,0xc330,0xe730
.long 0x7ffff000,0x18,0xc300,0xe700,0x7ffff000,0x18,0xc310,0xe710
.long 0x0,0x0,0x0,0x0,0x0,0x0,0x0,0x0
.long 0x0,0x0,0x0,0x0,0x0,0x0,0x0,0x0
.long 0x0,0x0,0x0,0x0,0x0,0x0,0x0,0x0
.long 0x0,0x0,0x0,0x0,0x0,0x0,0x0,0x0
.long 0x0,0x0,0x0,0x0,0x0,0x0,0x0,0x0
.long 0x0,0x0,0x0,0x0,0x0,0x0,0x0,0x0
.long 0x0,0x0,0x0,0x0,0x0,0x0,0x0,0x3f800000
.long 0x0,0x0,0x0,0x3f803f80,0x0,0x0,0x3f800000,0x3f803f80
.long 0x0,0x0,0x0,0x0,0x0,0x0,0x0,0x0
.long 0x0,0x0,0x0,0x0,0x0,0x0,0x0,0x0
.long 0x0,0x0,0x0,0x0,0x0,0x0,0x0,0x3f800000
.long 0x0,0x0,0x0,0x3f803f80,0x0,0x0,0x3f800000,0x3f803f80
.long 0x0,0x0,0x3f803f80,0x3f803f80,0x0,0x3f800000,0x3f803f80,0x3f803f80
.long 0x0,0x3f803f80,0x3f803f80,0x3f803f80,0x3f800000,0x3f803f80,0x3f803f80,0x3f803f80
.long 0x3f803f80,0x3f803f80,0x3f803f80,0x3f80,0x3f803f80,0x3f803f80,0x3f803f80,0x0
.long 0x3f803f80,0x3f803f80,0x3f80,0x0,0x3f803f80,0x3f803f80,0x0,0x0
.long 0x0,0x0,0x3f803f80,0x3f803f80,0x0,0x3f800000,0x3f803f80,0x3f803f80
.long 0x0,0x3f803f80,0x3f803f80,0x3f803f80,0x3f800000,0x3f803f80,0x3f803f80,0x3f803f80
.long 0x3f803f80,0x3f803f80,0x3f803f80,0x3f80,0x3f803f80,0x3f803f80,0x3f803f80,0x0
.long 0x3f803f80,0x3f803f80,0x3f80,0x0,0x3f803f80,0x3f803f80,0x0,0x0
.long 0x3f803f80,0x3f80,0x0,0x0,0x3f803f80,0x0,0x0,0x0
.long 0x3f80,0x0,0x0,0x0,0x0,0x0,0x0,0x0
.long 0x0,0x0,0x0,0x0,0x0,0x0,0x0,0x0
.long 0x0,0x0,0x0,0x0,0x0,0x0,0x0,0x0
.long 0x3f803f80,0x3f80,0x0,0x0,0x3f803f80,0x0,0x0,0x0
.long 0x3f80,0x0,0x0,0x0,0x0,0x0,0x0,0x0
.long 0x0,0x0,0x0,0x0,0x0,0x0,0x0,0x0
.long 0x0,0x0,0x0,0x0,0x0,0x0,0x0,0x0
.long 0x0,0x0,0x0,0x0,0x0,0x0,0x0,0x0
.long 0x0,0x0,0x0,0x0,0x0,0x0,0x0,0x0
.long 0x0,0x0,0x0,0x0,0x0,0x0,0x0,0x0
.long 0x0,0x0,0x0,0x0,0x0,0x0,0x0,0x0
.long 0x0,0x0,0x0,0x0,0x0,0x0,0x0,0x0
.long 0x0,0x0,0x0,0x0,0x0,0x0,0x0,0x0
.long 0x0,0x0,0x0,0x0,0x0,0x0,0x0,0x0
.long 0x0,0x0,0x0,0x0,0x0,0x0,0x0,0x0
.long 0x0,0x0,0x0,0x0,0x0,0x0,0x0,0x0
.long 0x0,0x0,0x0,0x0,0x0,0x0,0x0,0x0
.long 0x0,0x0,0x0,0x3f800000,0x0,0x0,0x0,0x3f803f80
.long 0x0,0x0,0x3f800000,0x3f803f80,0x0,0x0,0x3f803f80,0x3f803f80
.long 0x0,0x0,0x0,0x0,0x0,0x0,0x0,0x0
.long 0x0,0x0,0x0,0x0,0x0,0x0,0x0,0x0
.long 0x0,0x0,0x0,0x3f800000,0x0,0x0,0x0,0x3f803f80
.long 0x0,0x0,0x3f800000,0x3f803f80,0x0,0x0,0x3f803f80,0x3f803f80
.long 0x0,0x3f800000,0x3f803f80,0x3f803f80,0x0,0x3f803f80,0x3f803f80,0x3f803f80
.long 0x3f800000,0x3f803f80,0x3f803f80,0x3f803f80,0x3f803f80,0x3f803f80,0x3f803f80,0x3f803f80
.long 0x3f803f80,0x3f803f80,0x3f803f80,0x3f803f80,0x3f803f80,0x3f803f80,0x3f803f80,0x3f80
.long 0x3f803f80,0x3f803f80,0x3f803f80,0x0,0x3f803f80,0x3f803f80,0x3f80,0x0
.long 0x0,0x3f800000,0x3f803f80,0x3f803f80,0x0,0x3f803f80,0x3f803f80,0x3f803f80
.long 0x3f800000,0x3f803f80,0x3f803f80,0x3f803f80,0x3f803f80,0x3f803f80,0x3f803f80,0x3f803f80
.long 0x3f803f80,0x3f803f80,0x3f803f80,0x3f803f80,0x3f803f80,0x3f803f80,0x3f803f80,0x3f80
.long 0x3f803f80,0x3f803f80,0x3f803f80,0x0,0x3f803f80,0x3f803f80,0x3f80,0x0
.long 0x3f803f80,0x3f803f80,0x0,0x0,0x3f803f80,0x3f80,0x0,0x0
.long 0x3f803f80,0x0,0x0,0x0,0x3f80,0x0,0x0,0x0
.long 0x0,0x0,0x0,0x0,0x0,0x0,0x0,0x0
.long 0x0,0x0,0x0,0x0,0x0,0x0,0x0,0x0
.long 0x3f803f80,0x3f803f80,0x0,0x0,0x3f803f80,0x3f80,0x0,0x0
.long 0x3f803f80,0x0,0x0,0x0,0x3f80,0x0,0x0,0x0
.long 0x0,0x0,0x0,0x0,0x0,0x0,0x0,0x0
.long 0x0,0x0,0x0,0x0,0x0,0x0,0x0,0x0
.long 0x0,0x0,0x0,0x0,0x0,0x0,0x0,0x0
.long 0x0,0x0,0x0,0x0,0x0,0x0,0x0,0x0
.long 0x0,0x0,0x0,0x0,0x0,0x0,0x0,0x0
.long 0x0,0x0,0x0,0x0,0x0,0x0,0x0,0x0
.long 0x0,0x20,0x40,0x60,0x8,0x28,0x48,0x68
.long 0x10,0x30,0x50,0x70,0x18,0x38,0x58,0x78
.long 0x80,0xa0,0xc0,0xe0,0x88,0xa8,0xc8,0xe8
.long 0x90,0xb0,0xd0,0xf0,0x98,0xb8,0xd8,0xf8
.long 0x120,0x100,0x160,0x140,0x128,0x108,0x168,0x148
.long 0x130,0x110,0x170,0x150,0x138,0x118,0x178,0x158
.long 0x1a0,0x180,0x1e0,0x1c0,0x1a8,0x188,0x1e8,0x1c8
.long 0x1b0,0x190,0x1f0,0x1d0,0x1b8,0x198,0x1f8,0x1d8
.long 0x240,0x260,0x200,0x220,0x248,0x268,0x208,0x228
.long 0x250,0x270,0x210,0x230,0x258,0x278,0x218,0x238
.long 0x2c0,0x2e0,0x280,0x2a0,0x2c8,0x2e8,0x288,0x2a8
.long 0x2d0,0x2f0,0x290,0x2b0,0x2d8,0x2f8,0x298,0x2b8
.long 0x360,0x340,0x320,0x300,0x368,0x348,0x328,0x308
.long 0x370,0x350,0x330,0x310,0x378,0x358,0x338,0x318
.long 0x3e0,0x3c0,0x3a0,0x380,0x3e8,0x3c8,0x3a8,0x388
.long 0x3f0,0x3d0,0x3b0,0x390,0x3f8,0x3d8,0x3b8,0x398
.long 0x400,0x420,0x440,0x460,0x408,0x428,0x448,0x468
.long 0x410,0x430,0x450,0x470,0x418,0x438,0x458,0x478
.long 0x480,0x4a0,0x4c0,0x4e0,0x488,0x4a8,0x4c8,0x4e8
.long 0x490,0x4b0,0x4d0,0x4f0,0x498,0x4b8,0x4d8,0x4f8
.long 0x520,0x500,0x560,0x540,0x528,0x508,0x568,0x548
.long 0x530,0x510,0x570,0x550,0x538,0x518,0x578,0x558
.long 0x5a0,0x580,0x5e0,0x5c0,0x5a8,0x588,0x5e8,0x5c8
.long 0x5b0,0x590,0x5f0,0x5d0,0x5b8,0x598,0x5f8,0x5d8
.long 0x640,0x660,0x600,0x620,0x648,0x668,0x608,0x628
.long 0x650,0x670,0x610,0x630,0x658,0x678,0x618,0x638
.long 0x6c0,0x6e0,0x680,0x6a0,0x6c8,0x6e8,0x688,0x6a8
.long 0x6d0,0x6f0,0x690,0x6b0,0x6d8,0x6f8,0x698,0x6b8
.long 0x760,0x740,0x720,0x700,0x768,0x748,0x728,0x708
.long 0x770,0x750,0x730,0x710,0x778,0x758,0x738,0x718
.long 0x7e0,0x7c0,0x7a0,0x780,0x7e8,0x7c8,0x7a8,0x788
.long 0x7f0,0x7d0,0x7b0,0x790,0x7f8,0x7d8,0x7b8,0x798
.long 0x20000,0x20020,0x1000,0x11000,0x20040,0x20060,0x1010,0x11010
.long 0x20008,0x20028,0x1020,0x11020,0x20048,0x20068,0x1030,0x11030
.long 0x20080,0x200a0,0x1040,0x11040,0x200c0,0x200e0,0x1050,0x11050
.long 0x20088,0x200a8,0x1060,0x11060,0x200c8,0x200e8,0x1070,0x11070
.long 0x20120,0x20100,0x1080,0x11080,0x20160,0x20140,0x1090,0x11090
.long 0x20128,0x20108,0x10a0,0x110a0,0x20168,0x20148,0x10b0,0x110b0
.long 0x201a0,0x20180,0x10c0,0x110c0,0x201e0,0x201c0,0x10d0,0x110d0
.long 0x201a8,0x20188,0x10e0,0x110e0,0x201e8,0x201c8,0x10f0,0x110f0
.long 0x20010,0x20030,0x1100,0x11100,0x20050,0x20070,0x1110,0x11110
.long 0x20018,0x20038,0x1120,0x11120,0x20058,0x20078,0x1130,0x11130
.long 0x20090,0x200b0,0x1140,0x11140,0x200d0,0x200f0,0x1150,0x11150
.long 0x20098,0x200b8,0x1160,0x11160,0x200d8,0x200f8,0x1170,0x11170
.long 0x20130,0x20110,0x1180,0x11180,0x20170,0x20150,0x1190,0x11190
.long 0x20138,0x20118,0x11a0,0x111a0,0x20178,0x20158,0x11b0,0x111b0
.long 0x201b0,0x20190,0x11c0,0x111c0,0x201f0,0x201d0,0x11d0,0x111d0
.long 0x201b8,0x20198,0x11e0,0x111e0,0x201f8,0x201d8,0x11f0,0x111f0
.long 0x20200,0x20220,0x1200,0x11200,0x20240,0x20260,0x1210,0x11210
.long 0x20208,0x20228,0x1220,0x11220,0x20248,0x20268,0x1230,0x11230
.long 0x20280,0x202a0,0x1240,0x11240,0x202c0,0x202e0,0x1250,0x11250
.long 0x20288,0x202a8,0x1260,0x11260,0x202c8,0x202e8,0x1270,0x11270
.long 0x20320,0x20300,0x1280,0x11280,0x20360,0x20340,0x1290,0x11290
.long 0x20328,0x20308,0x12a0,0x112a0,0x20368,0x20348,0x12b0,0x112b0
.long 0x203a0,0x20380,0x12c0,0x112c0,0x203e0,0x203c0,0x12d0,0x112d0
.long 0x203a8,0x20388,0x12e0,0x112e0,0x203e8,0x203c8,0x12f0,0x112f0
.long 0x20210,0x20230,0x1300,0x11300,0x20250,0x20270,0x1310,0x11310
.long 0x20218,0x20238,0x1320,0x11320,0x20258,0x20278,0x1330,0x11330
.long 0x20290,0x202b0,0x1340,0x11340,0x202d0,0x202f0,0x1350,0x11350
.long 0x20298,0x202b8,0x1360,0x11360,0x202d8,0x202f8,0x1370,0x11370
.long 0x20330,0x20310,0x1380,0x11380,0x20370,0x20350,0x1390,0x11390
.long 0x20338,0x20318,0x13a0,0x113a0,0x20378,0x20358,0x13b0,0x113b0
.long 0x203b0,0x20390,0x13c0,0x113c0,0x203f0,0x203d0,0x13d0,0x113d0
.long 0x203b8,0x20398,0x13e0,0x113e0,0x203f8,0x203d8,0x13f0,0x113f0
.long 0x1c000,0x14000,0x200,0x800,0x1c010,0x14010,0x210,0x804
.long 0x1c020,0x14020,0x220,0x808,0x1c030,0x14030,0x230,0x80c
.long 0x1c040,0x14040,0x240,0x810,0x1c050,0x14050,0x250,0x814
.long 0x1c060,0x14060,0x260,0x818,0x1c070,0x14070,0x270,0x81c
.long 0x1c090,0x14500,0x280,0x820,0x1c080,0x14510,0x290,0x824
.long 0x1c0b0,0x14520,0x2a0,0x828,0x1c0a0,0x14530,0x2b0,0x82c
.long 0x1c0d0,0x14540,0x2c0,0x830,0x1c0c0,0x14550,0x2d0,0x834
.long 0x1c0f0,0x14560,0x2e0,0x838,0x1c0e0,0x14570,0x2f0,0x83c
.long 0x1c120,0x14a00,0x4200,0x840,0x1c130,0x14a10,0x4210,0x844
.long 0x1c100,0x14a20,0x4220,0x848,0x1c110,0x14a30,0x4230,0x84c
.long 0x1c160,0x14a40,0x4240,0x850,0x1c170,0x14a50,0x4250,0x854
.long 0x1c140,0x14a60,0x4260,0x858,0x1c150,0x14a70,0x4270,0x85c
.long 0x1c1b0,0x14f00,0x4280,0x860,0x1c1a0,0x14f10,0x4290,0x864
.long 0x1c190,0x14f20,0x42a0,0x868,0x1c180,0x14f30,0x42b0,0x86c
.long 0x1c1f0,0x14f40,0x42c0,0x870,0x1c1e0,0x14f50,0x42d0,0x874
.long 0x1c1d0,0x14f60,0x42e0,0x878,0x1c1c0,0x14f70,0x42f0,0x87c
.long 0x1c240,0x15400,0x8200,0x880,0x1c250,0x15410,0x8210,0x884
.long 0x1c260,0x15420,0x8220,0x888,0x1c270,0x15430,0x8230,0x88c
.long 0x1c200,0x15440,0x8240,0x890,0x1c210,0x15450,0x8250,0x894
.long 0x1c220,0x15460,0x8260,0x898,0x1c230,0x15470,0x8270,0x89c
.long 0x1c2d0,0x15900,0x8280,0x8a0,0x1c2c0,0x15910,0x8290,0x8a4
.long 0x1c2f0,0x15920,0x82a0,0x8a8,0x1c2e0,0x15930,0x82b0,0x8ac
.long 0x1c290,0x15940,0x82c0,0x8b0,0x1c280,0x15950,0x82d0,0x8b4
.long 0x1c2b0,0x15960,0x82e0,0x8b8,0x1c2a0,0x15970,0x82f0,0x8bc
.long 0x1c360,0x15e00,0xc200,0x8c0,0x1c370,0x15e10,0xc210,0x8c4
.long 0x1c340,0x15e20,0xc220,0x8c8,0x1c350,0x15e30,0xc230,0x8cc
.long 0x1c320,0x15e40,0xc240,0x8d0,0x1c330,0x15e50,0xc250,0x8d4
.long 0x1c300,0x15e60,0xc260,0x8d8,0x1c310,0x15e70,0xc270,0x8dc
.long 0x1c3f0,0x16300,0xc280,0x8e0,0x1c3e0,0x16310,0xc290,0x8e4
.long 0x1c3d0,0x16320,0xc2a0,0x8e8,0x1c3c0,0x16330,0xc2b0,0x8ec
.long 0x1c3b0,0x16340,0xc2c0,0x8f0,0x1c3a0,0x16350,0xc2d0,0x8f4
.long 0x1c390,0x16360,0xc2e0,0x8f8,0x1c380,0x16370,0xc2f0,0x8fc
.long 0x1c000,0x1c020,0x1c040,0x1c060,0x1c090,0x1c0b0,0x1c0d0,0x1c0f0
.long 0x1c120,0x1c100,0x1c160,0x1c140,0x1c1b0,0x1c190,0x1c1f0,0x1c1d0
.long 0x1c240,0x1c260,0x1c200,0x1c220,0x1c2d0,0x1c2f0,0x1c290,0x1c2b0
.long 0x1c360,0x1c340,0x1c320,0x1c300,0x1c3f0,0x1c3d0,0x1c3b0,0x1c390
.long 0x1c400,0x1c420,0x1c440,0x1c460,0x1c490,0x1c4b0,0x1c4d0,0x1c4f0
.long 0x1c520,0x1c500,0x1c560,0x1c540,0x1c5b0,0x1c590,0x1c5f0,0x1c5d0
.long 0x1c640,0x1c660,0x1c600,0x1c620,0x1c6d0,0x1c6f0,0x1c690,0x1c6b0
.long 0x1c760,0x1c740,0x1c720,0x1c700,0x1c7f0,0x1c7d0,0x1c7b0,0x1c790
.long 0x1c008,0x1c028,0x1c048,0x1c068,0x1c098,0x1c0b8,0x1c0d8,0x1c0f8
.long 0x1c128,0x1c108,0x1c168,0x1c148,0x1c1b8,0x1c198,0x1c1f8,0x1c1d8
.long 0x1c248,0x1c268,0x1c208,0x1c228,0x1c2d8,0x1c2f8,0x1c298,0x1c2b8
.long 0x1c368,0x1c348,0x1c328,0x1c308,0x1c3f8,0x1c3d8,0x1c3b8,0x1c398
.long 0x1c408,0x1c428,0x1c448,0x1c468,0x1c498,0x1c4b8,0x1c4d8,0x1c4f8
.long 0x1c528,0x1c508,0x1c568,0x1c548,0x1c5b8,0x1c598,0x1c5f8,0x1c5d8
.long 0x1c648,0x1c668,0x1c608,0x1c628,0x1c6d8,0x1c6f8,0x1c698,0x1c6b8
.long 0x1c768,0x1c748,0x1c728,0x1c708,0x1c7f8,0x1c7d8,0x1c7b8,0x1c798
.long 0x1c010,0x1c030,0x1c050,0x1c070,0x1c080,0x1c0a0,0x1c0c0,0x1c0e0
.long 0x1c130,0x1c110,0x1c170,0x1c150,0x1c1a0,0x1c180,0x1c1e0,0x1c1c0
.long 0x1c250,0x1c270,0x1c210,0x1c230,0x1c2c0,0x1c2e0,0x1c280,0x1c2a0
.long 0x1c370,0x1c350,0x1c330,0x1c310,0x1c3e0,0x1c3c0,0x1c3a0,0x1c380
.long 0x1c410,0x1c430,0x1c450,0x1c470,0x1c480,0x1c4a0,0x1c4c0,0x1c4e0
.long 0x1c530,0x1c510,0x1c570,0x1c550,0x1c5a0,0x1c580,0x1c5e0,0x1c5c0
.long 0x1c650,0x1c670,0x1c610,0x1c630,0x1c6c0,0x1c6e0,0x1c680,0x1c6a0
.long 0x1c770,0x1c750,0x1c730,0x1c710,0x1c7e0,0x1c7c0,0x1c7a0,0x1c780
.long 0x1c018,0x1c038,0x1c058,0x1c078,0x1c088,0x1c0a8,0x1c0c8,0x1c0e8
.long 0x1c138,0x1c118,0x1c178,0x1c158,0x1c1a8,0x1c188,0x1c1e8,0x1c1c8
.long 0x1c258,0x1c278,0x1c218,0x1c238,0x1c2c8,0x1c2e8,0x1c288,0x1c2a8
.long 0x1c378,0x1c358,0x1c338,0x1c318,0x1c3e8,0x1c3c8,0x1c3a8,0x1c388
.long 0x1c418,0x1c438,0x1c458,0x1c478,0x1c488,0x1c4a8,0x1c4c8,0x1c4e8
.long 0x1c538,0x1c518,0x1c578,0x1c558,0x1c5a8,0x1c588,0x1c5e8,0x1c5c8
.long 0x1c658,0x1c678,0x1c618,0x1c638,0x1c6c8,0x1c6e8,0x1c688,0x1c6a8
.long 0x1c778,0x1c758,0x1c738,0x1c718,0x1c7e8,0x1c7c8,0x1c7a8,0x1c788
.long 0x12a0,0x1260,0x1,0x2,0x12a4,0x1264,0x1,0x2
.long 0x12a8,0x1268,0x1,0x2,0x12ac,0x126c,0x1,0x2
.long 0x12b0,0x1270,0x1,0x2,0x12b4,0x1274,0x1,0x2
.long 0x12b8,0x1278,0x1,0x2,0x12bc,0x127c,0x1,0x2
.long 0x12a0,0x1280,0x1,0x2,0x12a4,0x1284,0x1,0x2
.long 0x12a8,0x1288,0x1,0x2,0x12ac,0x128c,0x1,0x2
.long 0x12b0,0x1290,0x1,0x2,0x12b4,0x1294,0x1,0x2
.long 0x12b8,0x1298,0x1,0x2,0x12bc,0x129c,0x1,0x2
.long 0x12a0,0x12a0,0x1,0x2,0x12a4,0x12a4,0x1,0x2
.long 0x12a8,0x12a8,0x1,0x2,0x12ac,0x12ac,0x1,0x2
.long 0x12b0,0x12b0,0x1,0x2,0x12b4,0x12b4,0x1,0x2
.long 0x12b8,0x12b8,0x1,0x2,0x12bc,0x12bc,0x1,0x2
.long 0x12a0,0x12c0,0x1,0x2,0x12a4,0x12c4,0x1,0x2
.long 0x12a8,0x12c8,0x1,0x2,0x12ac,0x12cc,0x1,0x2
.long 0x12b0,0x12d0,0x1,0x2,0x12b4,0x12d4,0x1,0x2
.long 0x12b8,0x12d8,0x1,0x2,0x12bc,0x12dc,0x1,0x2
.long 0x12a0,0x1260,0x1,0x2,0x12a4,0x1264,0x1,0x2
.long 0x12a8,0x1268,0x1,0x2,0x12ac,0x126c,0x1,0x2
.long 0x12b0,0x1270,0x1,0x2,0x12b4,0x1274,0x1,0x2
.long 0x12b8,0x1278,0x1,0x2,0x12bc,0x127c,0x1,0x2
.long 0x12a0,0x1280,0x1,0x2,0x12a4,0x1284,0x1,0x2
.long 0x12a8,0x1288,0x1,0x2,0x12ac,0x128c,0x1,0x2
.long 0x12b0,0x1290,0x1,0x2,0x12b4,0x1294,0x1,0x2
.long 0x12b8,0x1298,0x1,0x2,0x12bc,0x129c,0x1,0x2
.long 0x12a0,0x12a0,0x1,0x2,0x12a4,0x12a4,0x1,0x2
.long 0x12a8,0x12a8,0x1,0x2,0x12ac,0x12ac,0x1,0x2
.long 0x12b0,0x12b0,0x1,0x2,0x12b4,0x12b4,0x1,0x2
.long 0x12b8,0x12b8,0x1,0x2,0x12bc,0x12bc,0x1,0x2
.long 0x12a0,0x12c0,0x1,0x2,0x12a4,0x12c4,0x1,0x2
.long 0x12a8,0x12c8,0x1,0x2,0x12ac,0x12cc,0x1,0x2
.long 0x12b0,0x12d0,0x1,0x2,0x12b4,0x12d4,0x1,0x2
.long 0x12b8,0x12d8,0x1,0x2,0x12bc,0x12dc,0x1,0x2
.long 0x7e90,0x7eb0,0x7ed0,0x7ef0,0x82b0,0x8290,0x82f0,0x82d0
.long 0x86d0,0x86f0,0x8690,0x86b0,0x8af0,0x8ad0,0x8ab0,0x8a90
.long 0x7e10,0x7e30,0x7e50,0x7e70,0x8230,0x8210,0x8270,0x8250
.long 0x8650,0x8670,0x8610,0x8630,0x8a70,0x8a50,0x8a30,0x8a10
.long 0x7d80,0x7da0,0x7dc0,0x7de0,0x81a0,0x8180,0x81e0,0x81c0
.long 0x85c0,0x85e0,0x8580,0x85a0,0x89e0,0x89c0,0x89a0,0x8980
.long 0x7d00,0x7d20,0x7d40,0x7d60,0x8120,0x8100,0x8160,0x8140
.long 0x8540,0x8560,0x8500,0x8520,0x8960,0x8940,0x8920,0x8900
.long 0x7e98,0x7eb8,0x7ed8,0x7ef8,0x82b8,0x8298,0x82f8,0x82d8
.long 0x86d8,0x86f8,0x8698,0x86b8,0x8af8,0x8ad8,0x8ab8,0x8a98
.long 0x7e18,0x7e38,0x7e58,0x7e78,0x8238,0x8218,0x8278,0x8258
.long 0x8658,0x8678,0x8618,0x8638,0x8a78,0x8a58,0x8a38,0x8a18
.long 0x7d88,0x7da8,0x7dc8,0x7de8,0x81a8,0x8188,0x81e8,0x81c8
.long 0x85c8,0x85e8,0x8588,0x85a8,0x89e8,0x89c8,0x89a8,0x8988
.long 0x7d08,0x7d28,0x7d48,0x7d68,0x8128,0x8108,0x8168,0x8148
.long 0x8548,0x8568,0x8508,0x8528,0x8968,0x8948,0x8928,0x8908
.long 0x7e80,0x7ea0,0x7ec0,0x7ee0,0x82a0,0x8280,0x82e0,0x82c0
.long 0x86c0,0x86e0,0x8680,0x86a0,0x8ae0,0x8ac0,0x8aa0,0x8a80
.long 0x7e00,0x7e20,0x7e40,0x7e60,0x8220,0x8200,0x8260,0x8240
.long 0x8640,0x8660,0x8600,0x8620,0x8a60,0x8a40,0x8a20,0x8a00
.long 0x7d90,0x7db0,0x7dd0,0x7df0,0x81b0,0x8190,0x81f0,0x81d0
.long 0x85d0,0x85f0,0x8590,0x85b0,0x89f0,0x89d0,0x89b0,0x8990
.long 0x7d10,0x7d30,0x7d50,0x7d70,0x8130,0x8110,0x8170,0x8150
.long 0x8550,0x8570,0x8510,0x8530,0x8970,0x8950,0x8930,0x8910
.long 0x7e88,0x7ea8,0x7ec8,0x7ee8,0x82a8,0x8288,0x82e8,0x82c8
.long 0x86c8,0x86e8,0x8688,0x86a8,0x8ae8,0x8ac8,0x8aa8,0x8a88
.long 0x7e08,0x7e28,0x7e48,0x7e68,0x8228,0x8208,0x8268,0x8248
.long 0x8648,0x8668,0x8608,0x8628,0x8a68,0x8a48,0x8a28,0x8a08
.long 0x7d98,0x7db8,0x7dd8,0x7df8,0x81b8,0x8198,0x81f8,0x81d8
.long 0x85d8,0x85f8,0x8598,0x85b8,0x89f8,0x89d8,0x89b8,0x8998
.long 0x7d18,0x7d38,0x7d58,0x7d78,0x8138,0x8118,0x8178,0x8158
.long 0x8558,0x8578,0x8518,0x8538,0x8978,0x8958,0x8938,0x8918
.long 0xcaf0,0xa8f0,0xc0,0x0,0xcc00,0xaa00,0xd0,0x7ffff000
.long 0xcd10,0xab10,0xe0,0x7ffff000,0xce20,0xac20,0xf0,0x7ffff000
.long 0xd370,0xad30,0x80,0x7ffff000,0xd370,0xae40,0x90,0x7ffff000
.long 0xd480,0xaf50,0xa0,0x7ffff000,0xd590,0xb060,0xb0,0x7ffff000
.long 0xcf30,0xb170,0x40,0x7ffff000,0xd040,0xb280,0x50,0x7ffff000
.long 0xd150,0xb390,0x60,0x7ffff000,0xd260,0xb4a0,0x70,0x7ffff000
.long 0xd590,0xb5b0,0x0,0x7ffff000,0xd590,0xb6c0,0x10,0x7ffff000
.long 0xd6a0,0xb7d0,0x20,0x7ffff000,0xd6a0,0xb8e0,0x30,0x7ffff000
.long 0xd7b0,0xb9f0,0x40c0,0x7ffff000,0xd8c0,0xbb00,0x40d0,0x7ffff000
.long 0xdbf0,0xbc10,0x40e0,0x7ffff000,0xde10,0xbd20,0x40f0,0x7ffff000
.long 0xd9d0,0xbe30,0x4080,0x7ffff000,0xdae0,0xbf40,0x4090,0x7ffff000
.long 0xdd00,0xc050,0x40a0,0x7ffff000,0xdf20,0xc160,0x40b0,0x7ffff000
.long 0xe030,0xc270,0x4040,0x7ffff000,0xe030,0xc380,0x4050,0x7ffff000
.long 0xe030,0xc490,0x4060,0x7ffff000,0xe030,0xc5a0,0x4070,0x7ffff000
.long 0xdf20,0xc6b0,0x4000,0x7ffff000,0xdf20,0xc7c0,0x4010,0x7ffff000
.long 0xdf20,0xc8d0,0x4020,0x7ffff000,0xdf20,0xc9e0,0x4030,0x7ffff000
.long 0xcb00,0xa900,0x80c0,0x7ffff000,0xcc10,0xaa10,0x80d0,0x7ffff000
.long 0xcd20,0xab20,0x80e0,0x7ffff000,0xce30,0xac30,0x80f0,0x7ffff000
.long 0xd380,0xad40,0x8080,0x7ffff000,0xd380,0xae50,0x8090,0x7ffff000
.long 0xd490,0xaf60,0x80a0,0x7ffff000,0xd5a0,0xb070,0x80b0,0x7ffff000
.long 0xcf40,0xb180,0x8040,0x7ffff000,0xd050,0xb290,0x8050,0x7ffff000
.long 0xd160,0xb3a0,0x8060,0x7ffff000,0xd270,0xb4b0,0x8070,0x7ffff000
.long 0xd5a0,0xb5c0,0x8000,0x7ffff000,0xd5a0,0xb6d0,0x8010,0x7ffff000
.long 0xd6b0,0xb7e0,0x8020,0x7ffff000,0xd6b0,0xb8f0,0x8030,0x7ffff000
.long 0xd7c0,0xba00,0xc0c0,0x7ffff000,0xd8d0,0xbb10,0xc0d0,0x7ffff000
.long 0xdc00,0xbc20,0xc0e0,0x7ffff000,0xde20,0xbd30,0xc0f0,0x7ffff000
.long 0xd9e0,0xbe40,0xc080,0x7ffff000,0xdaf0,0xbf50,0xc090,0x7ffff000
.long 0xdd10,0xc060,0xc0a0,0x7ffff000,0xdf30,0xc170,0xc0b0,0x7ffff000
.long 0xe040,0xc280,0xc040,0x7ffff000,0xe040,0xc390,0xc050,0x7ffff000
.long 0xe040,0xc4a0,0xc060,0x7ffff000,0xe040,0xc5b0,0xc070,0x7ffff000
.long 0xdf30,0xc6c0,0xc000,0x7ffff000,0xdf30,0xc7d0,0xc010,0x7ffff000
.long 0xdf30,0xc8e0,0xc020,0x7ffff000,0xdf30,0xc9f0,0xc030,0x7ffff000
.long 0x0,0x0,0x4900,0x16800,0x10,0x4,0x4980,0x16d00
.long 0x20,0x8,0x4b00,0x17200,0x30,0xc,0x4b80,0x17700
.long 0x40,0x10,0x4d00,0x17c00,0x50,0x14,0x4d80,0x18100
.long 0x60,0x18,0x4d00,0x18600,0x70,0x1c,0x4d80,0x18b00
.long 0x80,0x20,0x5500,0x19000,0x90,0x24,0x5580,0x19500
.long 0xa0,0x28,0x5700,0x19a00,0xb0,0x2c,0x5780,0x19f00
.long 0xc0,0x30,0x5900,0x1a400,0xd0,0x34,0x5980,0x1a900
.long 0xe0,0x38,0x5900,0x1ae00,0xf0,0x3c,0x5980,0x1b300
.long 0x100,0x7ffff000,0x4900,0x1b800,0x110,0x7ffff000,0x4980,0x1bd00
.long 0x120,0x7ffff000,0x4b00,0x1c200,0x130,0x7ffff000,0x4b80,0x1c700
.long 0x140,0x7ffff000,0x4d00,0x1cc00,0x150,0x7ffff000,0x4d80,0x1d100
.long 0x160,0x7ffff000,0x4d00,0x1d600,0x170,0x7ffff000,0x4d80,0x1db00
.long 0x180,0x7ffff000,0x5500,0x1db00,0x190,0x7ffff000,0x5580,0x1db00
.long 0x1a0,0x7ffff000,0x5700,0x1db00,0x1b0,0x7ffff000,0x5780,0x1db00
.long 0x1c0,0x7ffff000,0x5900,0x1db00,0x1d0,0x7ffff000,0x5980,0x1db00
.long 0x1e0,0x7ffff000,0x5900,0x1db00,0x1f0,0x7ffff000,0x5980,0x1db00
.long 0x200,0x7ffff000,0x4900,0x1db00,0x210,0x7ffff000,0x4980,0x1db00
.long 0x220,0x7ffff000,0x4b00,0x1db00,0x230,0x7ffff000,0x4b80,0x1db00
.long 0x240,0x7ffff000,0x4d00,0x1db00,0x250,0x7ffff000,0x4d80,0x1db00
.long 0x260,0x7ffff000,0x4d00,0x1db00,0x270,0x7ffff000,0x4d80,0x1db00
.long 0x280,0x7ffff000,0x5500,0x1db00,0x290,0x7ffff000,0x5580,0x1db00
.long 0x2a0,0x7ffff000,0x5700,0x1db00,0x2b0,0x7ffff000,0x5780,0x1db00
.long 0x2c0,0x7ffff000,0x5900,0x1db00,0x2d0,0x7ffff000,0x5980,0x1db00
.long 0x2e0,0x7ffff000,0x5900,0x1db00,0x2f0,0x7ffff000,0x5980,0x1db00
.long 0x300,0x7ffff000,0x4900,0x1db00,0x310,0x7ffff000,0x4980,0x1db00
.long 0x320,0x7ffff000,0x4b00,0x1db00,0x330,0x7ffff000,0x4b80,0x1db00
.long 0x340,0x7ffff000,0x4d00,0x1db00,0x350,0x7ffff000,0x4d80,0x1db00
.long 0x360,0x7ffff000,0x4d00,0x1db00,0x370,0x7ffff000,0x4d80,0x1db00
.long 0x380,0x7ffff000,0x5500,0x1db00,0x390,0x7ffff000,0x5580,0x1db00
.long 0x3a0,0x7ffff000,0x5700,0x1db00,0x3b0,0x7ffff000,0x5780,0x1db00
.long 0x3c0,0x7ffff000,0x5900,0x1db00,0x3d0,0x7ffff000,0x5980,0x1db00
.long 0x3e0,0x7ffff000,0x5900,0x1db00,0x3f0,0x7ffff000,0x5980,0x1db00
.long 0x4b14,0x4b20,0x41e0,0xffffffff,0x4b18,0x4b20,0x41e4,0xffffffff
.long 0x4b1c,0x4b24,0x41e8,0xffff,0x4b20,0x4b24,0x41ec,0x0
.long 0x4b24,0x4b28,0x41f0,0x0,0x4b28,0x4b28,0x41f4,0x0
.long 0x4b2c,0x4b2c,0x41f8,0x0,0x4b30,0x4b2c,0x41fc,0x0
.long 0x4b34,0x4b30,0x4200,0x0,0x4b38,0x4b30,0x4204,0x0
.long 0x4b3c,0x4b34,0x4208,0x0,0x4b40,0x4b34,0x420c,0x0
.long 0x4b44,0x4b38,0x4210,0x0,0x4b48,0x4b38,0x4214,0x0
.long 0x4b4c,0x4b3c,0x4218,0x0,0x4b50,0x4b3c,0x421c,0x0
.long 0x4b04,0x4b40,0x4aa0,0xffffffff,0x4b08,0x4b40,0x4aa4,0xffffffff
.long 0x4b0c,0x4b44,0x4aa8,0x0,0x4b10,0x4b44,0x4aac,0x0
.long 0x4b14,0x4b48,0x4ab0,0x0,0x4b18,0x4b48,0x4ab4,0x0
.long 0x4b1c,0x4b4c,0x4ab8,0x0,0x4b20,0x4b4c,0x4abc,0x0
.long 0x4b24,0x4b50,0x4ac0,0x0,0x4b28,0x4b50,0x4ac4,0x0
.long 0x4b2c,0x4b54,0x4ac8,0x0,0x4b30,0x4b54,0x4acc,0x0
.long 0x4b34,0x4b58,0x4ad0,0x0,0x4b38,0x4b58,0x4ad4,0x0
.long 0x4b3c,0x4b5c,0x4ad8,0x0,0x4b40,0x4b5c,0x4adc,0x0
.long 0x4af4,0x4b60,0x4ae0,0x0,0x4af8,0x4b60,0x4ae4,0x0
.long 0x4afc,0x4b64,0x4ae8,0x0,0x4b00,0x4b64,0x4aec,0x0
.long 0x4b04,0x4b68,0x4af0,0x0,0x4b08,0x4b68,0x4af4,0x0
.long 0x4b0c,0x4b6c,0x4af8,0x0,0x4b10,0x4b6c,0x4afc,0x0
.long 0x4b14,0x4b70,0x4b00,0x0,0x4b18,0x4b70,0x4b04,0x0
.long 0x4b1c,0x4b74,0x4b08,0x0,0x4b20,0x4b74,0x4b0c,0x0
.long 0x4b24,0x4b78,0x4b10,0x0,0x4b28,0x4b78,0x4b14,0x0
.long 0x4b2c,0x4b7c,0x4b18,0x0,0x4b30,0x4b7c,0x4b1c,0x0
.long 0x4ae4,0x4b80,0x4ae0,0x0,0x4ae8,0x4b80,0x4ae4,0x0
.long 0x4aec,0x4b84,0x4ae8,0x0,0x4af0,0x4b84,0x4aec,0x0
.long 0x4af4,0x4b88,0x4af0,0x0,0x4af8,0x4b88,0x4af4,0x0
.long 0x4afc,0x4b8c,0x4af8,0x0,0x4b00,0x4b8c,0x4afc,0x0
.long 0x4b04,0x4b90,0x4b00,0x0,0x4b08,0x4b90,0x4b04,0x0
.long 0x4b0c,0x4b94,0x4b08,0x0,0x4b10,0x4b94,0x4b0c,0x0
.long 0x4b14,0x4b98,0x4b10,0x0,0x4b18,0x4b98,0x4b14,0x0
.long 0x4b1c,0x4b9c,0x4b18,0x0,0x4b20,0x4b9c,0x4b1c,0x0
.long 0x39c0,0x39dc,0x39c0,0x600,0x39d0,0x39d8,0x41d0,0x608
.long 0x39e0,0x39d4,0x39e0,0x610,0x39f0,0x39d0,0x41f0,0x618
.long 0x3a00,0x39cc,0x3a00,0x1940,0x3a10,0x39c8,0x4210,0x1948
.long 0x3a20,0x39c4,0x3a20,0x1950,0x3a30,0x39c0,0x4230,0x1958
.long 0x3a40,0x39c0,0x3a40,0x2c80,0x3a50,0x39c0,0x4250,0x2c88
.long 0x3a60,0x39c0,0x3a60,0x2c90,0x3a70,0x39c0,0x4270,0x2c98
.long 0x3a80,0x39c0,0x3a80,0x3fc0,0x3a90,0x39c0,0x4290,0x3fc8
.long 0x3aa0,0x39c0,0x3aa0,0x3fd0,0x3ab0,0x39c0,0x42b0,0x3fd8
.long 0x3ac0,0x39c0,0x39c8,0x620,0x3ad0,0x39c0,0x41d8,0x628
.long 0x3ae0,0x39c0,0x39e8,0x630,0x3af0,0x39c0,0x41f8,0x638
.long 0x3b00,0x39c0,0x3a08,0x1960,0x3b10,0x39c0,0x4218,0x1968
.long 0x3b20,0x39c0,0x3a28,0x1970,0x3b30,0x39c0,0x4238,0x1978
.long 0x3b40,0x39c0,0x3a48,0x2ca0,0x3b50,0x39c0,0x4258,0x2ca8
.long 0x3b60,0x39c0,0x3a68,0x2cb0,0x3b70,0x39c0,0x4278,0x2cb8
.long 0x3b80,0x39c0,0x3a88,0x3fe0,0x3b90,0x39c0,0x4298,0x3fe8
.long 0x3ba0,0x39c0,0x3aa8,0x3ff0,0x3bb0,0x39c0,0x42b8,0x3ff8
.long 0x3bc0,0x39c0,0x39d0,0x640,0x3bd0,0x39c0,0x41e0,0x648
.long 0x3be0,0x39c0,0x39f0,0x650,0x3bf0,0x39c0,0x4200,0x658
.long 0x3c00,0x39c0,0x3a10,0x1980,0x3c10,0x39c0,0x4220,0x1988
.long 0x3c20,0x39c0,0x3a30,0x1990,0x3c30,0x39c0,0x4240,0x1998
.long 0x3c40,0x39c0,0x3a50,0x2cc0,0x3c50,0x39c0,0x4260,0x2cc8
.long 0x3c60,0x39c0,0x3a70,0x2cd0,0x3c70,0x39c0,0x4280,0x2cd8
.long 0x3c80,0x39c0,0x3a90,0x4000,0x3c90,0x39c0,0x42a0,0x4008
.long 0x3ca0,0x39c0,0x3ab0,0x4010,0x3cb0,0x39c0,0x42c0,0x4018
.long 0x3cc0,0x39c0,0x39d8,0x660,0x3cd0,0x39c0,0x41e8,0x668
.long 0x3ce0,0x39c0,0x39f8,0x670,0x3cf0,0x39c0,0x4208,0x678
.long 0x3d00,0x39c0,0x3a18,0x19a0,0x3d10,0x39c0,0x4228,0x19a8
.long 0x3d20,0x39c0,0x3a38,0x19b0,0x3d30,0x39c0,0x4248,0x19b8
.long 0x3d40,0x39c0,0x3a58,0x2ce0,0x3d50,0x39c0,0x4268,0x2ce8
.long 0x3d60,0x39c0,0x3a78,0x2cf0,0x3d70,0x39c0,0x4288,0x2cf8
.long 0x3d80,0x39c0,0x3a98,0x4020,0x3d90,0x39c0,0x42a8,0x4028
.long 0x3da0,0x39c0,0x3ab8,0x4030,0x3db0,0x39c0,0x42c8,0x4038
.long 0x4280,0x4680,0x4a80,0x7c0,0x39c4,0x3dc4,0x41c4,0x740
.long 0x4284,0x4684,0x4a84,0x6d0,0x39c8,0x3dc8,0x41c8,0x650
.long 0x4288,0x4688,0x4a88,0x5e0,0x39cc,0x3dcc,0x41cc,0x560
.long 0x428c,0x468c,0x4a8c,0x4f0,0x39d0,0x3dd0,0x41d0,0x470
.long 0x4290,0x4690,0x4a90,0x3c0,0x39d4,0x3dd4,0x41d4,0x340
.long 0x4294,0x4694,0x4a94,0x2d0,0x39d8,0x3dd8,0x41d8,0x250
.long 0x4298,0x4698,0x4a98,0x1e0,0x39dc,0x3ddc,0x41dc,0x160
.long 0x429c,0x469c,0x4a9c,0xf0,0x39e0,0x3de0,0x41e0,0x70
.long 0x4290,0x4690,0x4a90,0x830,0x39d4,0x3dd4,0x41d4,0x780
.long 0x4294,0x4694,0x4a94,0x700,0x39d8,0x3dd8,0x41d8,0x690
.long 0x4298,0x4698,0x4a98,0x610,0x39dc,0x3ddc,0x41dc,0x5a0
.long 0x429c,0x469c,0x4a9c,0x520,0x39e0,0x3de0,0x41e0,0x4b0
.long 0x42a0,0x46a0,0x4aa0,0x430,0x39e4,0x3de4,0x41e4,0x380
.long 0x42a4,0x46a4,0x4aa4,0x300,0x39e8,0x3de8,0x41e8,0x290
.long 0x42a8,0x46a8,0x4aa8,0x210,0x39ec,0x3dec,0x41ec,0x1a0
.long 0x42ac,0x46ac,0x4aac,0x120,0x39f0,0x3df0,0x41f0,0xb0
.long 0x42a0,0x46a0,0x4aa0,0x870,0x39e4,0x3de4,0x41e4,0x7c0
.long 0x42a4,0x46a4,0x4aa4,0x740,0x39e8,0x3de8,0x41e8,0x6d0
.long 0x42a8,0x46a8,0x4aa8,0x650,0x39ec,0x3dec,0x41ec,0x5e0
.long 0x42ac,0x46ac,0x4aac,0x560,0x39f0,0x3df0,0x41f0,0x4f0
.long 0x42b0,0x46b0,0x4ab0,0x470,0x39f4,0x3df4,0x41f4,0x3c0
.long 0x42b4,0x46b4,0x4ab4,0x340,0x39f8,0x3df8,0x41f8,0x2d0
.long 0x42b8,0x46b8,0x4ab8,0x250,0x39fc,0x3dfc,0x41fc,0x1e0
.long 0x42bc,0x46bc,0x4abc,0x160,0x3a00,0x3e00,0x4200,0xf0
.long 0x42b0,0x46b0,0x4ab0,0x8b0,0x39f4,0x3df4,0x41f4,0x830
.long 0x42b4,0x46b4,0x4ab4,0x780,0x39f8,0x3df8,0x41f8,0x700
.long 0x42b8,0x46b8,0x4ab8,0x690,0x39fc,0x3dfc,0x41fc,0x610
.long 0x42bc,0x46bc,0x4abc,0x5a0,0x3a00,0x3e00,0x4200,0x520
.long 0x42c0,0x46c0,0x4ac0,0x4b0,0x3a04,0x3e04,0x4204,0x430
.long 0x42c4,0x46c4,0x4ac4,0x380,0x3a08,0x3e08,0x4208,0x300
.long 0x42c8,0x46c8,0x4ac8,0x290,0x3a0c,0x3e0c,0x420c,0x210
.long 0x42cc,0x46cc,0x4acc,0x1a0,0x3a10,0x3e10,0x4210,0x120
.long 0x780,0x8b0,0x9a0,0xa90,0x700,0x830,0x920,0xa10
.long 0x690,0x780,0x8b0,0x9a0,0x610,0x700,0x830,0x920
.long 0x5a0,0x690,0x780,0x8b0,0x520,0x610,0x700,0x830
.long 0x4b0,0x5a0,0x690,0x780,0x430,0x520,0x610,0x700
.long 0x380,0x4b0,0x5a0,0x690,0x300,0x430,0x520,0x610
.long 0x290,0x380,0x4b0,0x5a0,0x210,0x300,0x430,0x520
.long 0x1a0,0x290,0x380,0x4b0,0x120,0x210,0x300,0x430
.long 0xb0,0x1a0,0x290,0x380,0x30,0x120,0x210,0x300
.long 0x7c0,0x8f0,0x9e0,0xad0,0x740,0x870,0x960,0xa50
.long 0x6d0,0x7c0,0x8f0,0x9e0,0x650,0x740,0x870,0x960
.long 0x5e0,0x6d0,0x7c0,0x8f0,0x560,0x650,0x740,0x870
.long 0x4f0,0x5e0,0x6d0,0x7c0,0x470,0x560,0x650,0x740
.long 0x3c0,0x4f0,0x5e0,0x6d0,0x340,0x470,0x560,0x650
.long 0x2d0,0x3c0,0x4f0,0x5e0,0x250,0x340,0x470,0x560
.long 0x1e0,0x2d0,0x3c0,0x4f0,0x160,0x250,0x340,0x470
.long 0xf0,0x1e0,0x2d0,0x3c0,0x70,0x160,0x250,0x340
.long 0x830,0x920,0xa10,0xb00,0x780,0x8b0,0x9a0,0xa90
.long 0x700,0x830,0x920,0xa10,0x690,0x780,0x8b0,0x9a0
.long 0x610,0x700,0x830,0x920,0x5a0,0x690,0x780,0x8b0
.long 0x520,0x610,0x700,0x830,0x4b0,0x5a0,0x690,0x780
.long 0x430,0x520,0x610,0x700,0x380,0x4b0,0x5a0,0x690
.long 0x300,0x430,0x520,0x610,0x290,0x380,0x4b0,0x5a0
.long 0x210,0x300,0x430,0x520,0x1a0,0x290,0x380,0x4b0
.long 0x120,0x210,0x300,0x430,0xb0,0x1a0,0x290,0x380
.long 0x870,0x960,0xa50,0xb40,0x7c0,0x8f0,0x9e0,0xad0
.long 0x740,0x870,0x960,0xa50,0x6d0,0x7c0,0x8f0,0x9e0
.long 0x650,0x740,0x870,0x960,0x5e0,0x6d0,0x7c0,0x8f0
.long 0x560,0x650,0x740,0x870,0x4f0,0x5e0,0x6d0,0x7c0
.long 0x470,0x560,0x650,0x740,0x3c0,0x4f0,0x5e0,0x6d0
.long 0x340,0x470,0x560,0x650,0x2d0,0x3c0,0x4f0,0x5e0
.long 0x250,0x340,0x470,0x560,0x1e0,0x2d0,0x3c0,0x4f0
.long 0x160,0x250,0x340,0x470,0xf0,0x1e0,0x2d0,0x3c0
.long 0x0,0x0,0xf000,0x11400,0x4,0x0,0xf010,0x11410
.long 0x8,0x0,0xf020,0x11420,0xc,0x0,0xf030,0x11430
.long 0x10,0x0,0xf040,0x11440,0x14,0x0,0xf050,0x11450
.long 0x18,0x0,0xf060,0x11460,0x1c,0x0,0xf070,0x11470
.long 0x20,0x0,0xf500,0x11900,0x24,0x0,0xf510,0x11910
.long 0x28,0x0,0xf520,0x11920,0x2c,0x0,0xf530,0x11930
.long 0x7ffff000,0x0,0xf540,0x11940,0x7ffff000,0x0,0xf550,0x11950
.long 0x7ffff000,0x0,0xf560,0x11960,0x7ffff000,0x0,0xf570,0x11970
.long 0x7ffff000,0x8,0xfa20,0x11e20,0x7ffff000,0x8,0xfa30,0x11e30
.long 0x7ffff000,0x8,0xfa00,0x11e00,0x7ffff000,0x8,0xfa10,0x11e10
.long 0x7ffff000,0x8,0xfa60,0x11e60,0x7ffff000,0x8,0xfa70,0x11e70
.long 0x7ffff000,0x8,0xfa40,0x11e40,0x7ffff000,0x8,0xfa50,0x11e50
.long 0x7ffff000,0x8,0xff20,0x12320,0x7ffff000,0x8,0xff30,0x12330
.long 0x7ffff000,0x8,0xff00,0x12300,0x7ffff000,0x8,0xff10,0x12310
.long 0x7ffff000,0x8,0xff60,0x12360,0x7ffff000,0x8,0xff70,0x12370
.long 0x7ffff000,0x8,0xff40,0x12340,0x7ffff000,0x8,0xff50,0x12350
.long 0x7ffff000,0x10,0x10440,0x12840,0x7ffff000,0x10,0x10450,0x12850
.long 0x7ffff000,0x10,0x10460,0x12860,0x7ffff000,0x10,0x10470,0x12870
.long 0x7ffff000,0x10,0x10400,0x12800,0x7ffff000,0x10,0x10410,0x12810
.long 0x7ffff000,0x10,0x10420,0x12820,0x7ffff000,0x10,0x10430,0x12830
.long 0x7ffff000,0x10,0x10940,0x12d40,0x7ffff000,0x10,0x10950,0x12d50
.long 0x7ffff000,0x10,0x10960,0x12d60,0x7ffff000,0x10,0x10970,0x12d70
.long 0x7ffff000,0x10,0x10900,0x12d00,0x7ffff000,0x10,0x10910,0x12d10
.long 0x7ffff000,0x10,0x10920,0x12d20,0x7ffff000,0x10,0x10930,0x12d30
.long 0x7ffff000,0x18,0x10e60,0x13260,0x7ffff000,0x18,0x10e70,0x13270
.long 0x7ffff000,0x18,0x10e40,0x13240,0x7ffff000,0x18,0x10e50,0x13250
.long 0x7ffff000,0x18,0x10e20,0x13220,0x7ffff000,0x18,0x10e30,0x13230
.long 0x7ffff000,0x18,0x10e00,0x13200,0x7ffff000,0x18,0x10e10,0x13210
.long 0x7ffff000,0x18,0x11360,0x13760,0x7ffff000,0x18,0x11370,0x13770
.long 0x7ffff000,0x18,0x11340,0x13740,0x7ffff000,0x18,0x11350,0x13750
.long 0x7ffff000,0x18,0x11320,0x13720,0x7ffff000,0x18,0x11330,0x13730
.long 0x7ffff000,0x18,0x11300,0x13700,0x7ffff000,0x18,0x11310,0x13710
.long 0x0,0x0,0x0,0x0,0x0,0x0,0x0,0x0
.long 0x0,0x0,0x0,0x0,0x0,0x0,0x0,0x0
.long 0x0,0x0,0x0,0x0,0x0,0x0,0x0,0x0
.long 0x0,0x0,0x0,0x0,0x0,0x0,0x0,0x0
.long 0x0,0x0,0x0,0x0,0x0,0x0,0x0,0x0
.long 0x0,0x0,0x0,0x0,0x0,0x0,0x0,0x0
.long 0x0,0x0,0x0,0x0,0x0,0x0,0x0,0x3f800000
.long 0x0,0x0,0x0,0x3f803f80,0x0,0x0,0x3f800000,0x3f803f80
.long 0x0,0x0,0x0,0x0,0x0,0x0,0x0,0x0
.long 0x0,0x0,0x0,0x0,0x0,0x0,0x0,0x0
.long 0x0,0x0,0x0,0x0,0x0,0x0,0x0,0x3f800000
.long 0x0,0x0,0x0,0x3f803f80,0x0,0x0,0x3f800000,0x3f803f80
.long 0x0,0x0,0x3f803f80,0x3f803f80,0x0,0x3f800000,0x3f803f80,0x3f803f80
.long 0x0,0x3f803f80,0x3f803f80,0x3f803f80,0x3f800000,0x3f803f80,0x3f803f80,0x3f803f80
.long 0x3f803f80,0x3f803f80,0x3f803f80,0x3f80,0x3f803f80,0x3f803f80,0x3f803f80,0x0
.long 0x3f803f80,0x3f803f80,0x3f80,0x0,0x3f803f80,0x3f803f80,0x0,0x0
.long 0x0,0x0,0x3f803f80,0x3f803f80,0x0,0x3f800000,0x3f803f80,0x3f803f80
.long 0x0,0x3f803f80,0x3f803f80,0x3f803f80,0x3f800000,0x3f803f80,0x3f803f80,0x3f803f80
.long 0x3f803f80,0x3f803f80,0x3f803f80,0x3f80,0x3f803f80,0x3f803f80,0x3f803f80,0x0
.long 0x3f803f80,0x3f803f80,0x3f80,0x0,0x3f803f80,0x3f803f80,0x0,0x0
.long 0x3f803f80,0x3f80,0x0,0x0,0x3f803f80,0x0,0x0,0x0
.long 0x3f80,0x0,0x0,0x0,0x0,0x0,0x0,0x0
.long 0x0,0x0,0x0,0x0,0x0,0x0,0x0,0x0
.long 0x0,0x0,0x0,0x0,0x0,0x0,0x0,0x0
.long 0x3f803f80,0x3f80,0x0,0x0,0x3f803f80,0x0,0x0,0x0
.long 0x3f80,0x0,0x0,0x0,0x0,0x0,0x0,0x0
.long 0x0,0x0,0x0,0x0,0x0,0x0,0x0,0x0
.long 0x0,0x0,0x0,0x0,0x0,0x0,0x0,0x0
.long 0x0,0x0,0x0,0x0,0x0,0x0,0x0,0x0
.long 0x0,0x0,0x0,0x0,0x0,0x0,0x0,0x0
.long 0x0,0x0,0x0,0x0,0x0,0x0,0x0,0x0
.long 0x0,0x0,0x0,0x0,0x0,0x0,0x0,0x0
.long 0x0,0x0,0x0,0x0,0x0,0x0,0x0,0x0
.long 0x0,0x0,0x0,0x0,0x0,0x0,0x0,0x0
.long 0x0,0x0,0x0,0x0,0x0,0x0,0x0,0x0
.long 0x0,0x0,0x0,0x0,0x0,0x0,0x0,0x0
.long 0x0,0x0,0x0,0x0,0x0,0x0,0x0,0x0
.long 0x0,0x0,0x0,0x0,0x0,0x0,0x0,0x0
.long 0x0,0x0,0x0,0x3f800000,0x0,0x0,0x0,0x3f803f80
.long 0x0,0x0,0x3f800000,0x3f803f80,0x0,0x0,0x3f803f80,0x3f803f80
.long 0x0,0x0,0x0,0x0,0x0,0x0,0x0,0x0
.long 0x0,0x0,0x0,0x0,0x0,0x0,0x0,0x0
.long 0x0,0x0,0x0,0x3f800000,0x0,0x0,0x0,0x3f803f80
.long 0x0,0x0,0x3f800000,0x3f803f80,0x0,0x0,0x3f803f80,0x3f803f80
.long 0x0,0x3f800000,0x3f803f80,0x3f803f80,0x0,0x3f803f80,0x3f803f80,0x3f803f80
.long 0x3f800000,0x3f803f80,0x3f803f80,0x3f803f80,0x3f803f80,0x3f803f80,0x3f803f80,0x3f803f80
.long 0x3f803f80,0x3f803f80,0x3f803f80,0x3f803f80,0x3f803f80,0x3f803f80,0x3f803f80,0x3f80
.long 0x3f803f80,0x3f803f80,0x3f803f80,0x0,0x3f803f80,0x3f803f80,0x3f80,0x0
.long 0x0,0x3f800000,0x3f803f80,0x3f803f80,0x0,0x3f803f80,0x3f803f80,0x3f803f80
.long 0x3f800000,0x3f803f80,0x3f803f80,0x3f803f80,0x3f803f80,0x3f803f80,0x3f803f80,0x3f803f80
.long 0x3f803f80,0x3f803f80,0x3f803f80,0x3f803f80,0x3f803f80,0x3f803f80,0x3f803f80,0x3f80
.long 0x3f803f80,0x3f803f80,0x3f803f80,0x0,0x3f803f80,0x3f803f80,0x3f80,0x0
.long 0x3f803f80,0x3f803f80,0x0,0x0,0x3f803f80,0x3f80,0x0,0x0
.long 0x3f803f80,0x0,0x0,0x0,0x3f80,0x0,0x0,0x0
.long 0x0,0x0,0x0,0x0,0x0,0x0,0x0,0x0
.long 0x0,0x0,0x0,0x0,0x0,0x0,0x0,0x0
.long 0x3f803f80,0x3f803f80,0x0,0x0,0x3f803f80,0x3f80,0x0,0x0
.long 0x3f803f80,0x0,0x0,0x0,0x3f80,0x0,0x0,0x0
.long 0x0,0x0,0x0,0x0,0x0,0x0,0x0,0x0
.long 0x0,0x0,0x0,0x0,0x0,0x0,0x0,0x0
.long 0x0,0x0,0x0,0x0,0x0,0x0,0x0,0x0
.long 0x0,0x0,0x0,0x0,0x0,0x0,0x0,0x0
.long 0x0,0x0,0x0,0x0,0x0,0x0,0x0,0x0
.long 0x0,0x0,0x0,0x0,0x0,0x0,0x0,0x0
.long 0x0,0x20,0x40,0x60,0x8,0x28,0x48,0x68
.long 0x10,0x30,0x50,0x70,0x18,0x38,0x58,0x78
.long 0x80,0xa0,0xc0,0xe0,0x88,0xa8,0xc8,0xe8
.long 0x90,0xb0,0xd0,0xf0,0x98,0xb8,0xd8,0xf8
.long 0x120,0x100,0x160,0x140,0x128,0x108,0x168,0x148
.long 0x130,0x110,0x170,0x150,0x138,0x118,0x178,0x158
.long 0x1a0,0x180,0x1e0,0x1c0,0x1a8,0x188,0x1e8,0x1c8
.long 0x1b0,0x190,0x1f0,0x1d0,0x1b8,0x198,0x1f8,0x1d8
.long 0x240,0x260,0x200,0x220,0x248,0x268,0x208,0x228
.long 0x250,0x270,0x210,0x230,0x258,0x278,0x218,0x238
.long 0x2c0,0x2e0,0x280,0x2a0,0x2c8,0x2e8,0x288,0x2a8
.long 0x2d0,0x2f0,0x290,0x2b0,0x2d8,0x2f8,0x298,0x2b8
.long 0x360,0x340,0x320,0x300,0x368,0x348,0x328,0x308
.long 0x370,0x350,0x330,0x310,0x378,0x358,0x338,0x318
.long 0x3e0,0x3c0,0x3a0,0x380,0x3e8,0x3c8,0x3a8,0x388
.long 0x3f0,0x3d0,0x3b0,0x390,0x3f8,0x3d8,0x3b8,0x398
.long 0x400,0x420,0x440,0x460,0x408,0x428,0x448,0x468
.long 0x410,0x430,0x450,0x470,0x418,0x438,0x458,0x478
.long 0x480,0x4a0,0x4c0,0x4e0,0x488,0x4a8,0x4c8,0x4e8
.long 0x490,0x4b0,0x4d0,0x4f0,0x498,0x4b8,0x4d8,0x4f8
.long 0x520,0x500,0x560,0x540,0x528,0x508,0x568,0x548
.long 0x530,0x510,0x570,0x550,0x538,0x518,0x578,0x558
.long 0x5a0,0x580,0x5e0,0x5c0,0x5a8,0x588,0x5e8,0x5c8
.long 0x5b0,0x590,0x5f0,0x5d0,0x5b8,0x598,0x5f8,0x5d8
.long 0x640,0x660,0x600,0x620,0x648,0x668,0x608,0x628
.long 0x650,0x670,0x610,0x630,0x658,0x678,0x618,0x638
.long 0x6c0,0x6e0,0x680,0x6a0,0x6c8,0x6e8,0x688,0x6a8
.long 0x6d0,0x6f0,0x690,0x6b0,0x6d8,0x6f8,0x698,0x6b8
.long 0x760,0x740,0x720,0x700,0x768,0x748,0x728,0x708
.long 0x770,0x750,0x730,0x710,0x778,0x758,0x738,0x718
.long 0x7e0,0x7c0,0x7a0,0x780,0x7e8,0x7c8,0x7a8,0x788
.long 0x7f0,0x7d0,0x7b0,0x790,0x7f8,0x7d8,0x7b8,0x798
.long 0x20000,0x20020,0x1800,0x11800,0x20040,0x20060,0x1810,0x11810
.long 0x20008,0x20028,0x1820,0x11820,0x20048,0x20068,0x1830,0x11830
.long 0x20080,0x200a0,0x1840,0x11840,0x200c0,0x200e0,0x1850,0x11850
.long 0x20088,0x200a8,0x1860,0x11860,0x200c8,0x200e8,0x1870,0x11870
.long 0x20120,0x20100,0x1880,0x11880,0x20160,0x20140,0x1890,0x11890
.long 0x20128,0x20108,0x18a0,0x118a0,0x20168,0x20148,0x18b0,0x118b0
.long 0x201a0,0x20180,0x18c0,0x118c0,0x201e0,0x201c0,0x18d0,0x118d0
.long 0x201a8,0x20188,0x18e0,0x118e0,0x201e8,0x201c8,0x18f0,0x118f0
.long 0x20010,0x20030,0x1900,0x11900,0x20050,0x20070,0x1910,0x11910
.long 0x20018,0x20038,0x1920,0x11920,0x20058,0x20078,0x1930,0x11930
.long 0x20090,0x200b0,0x1940,0x11940,0x200d0,0x200f0,0x1950,0x11950
.long 0x20098,0x200b8,0x1960,0x11960,0x200d8,0x200f8,0x1970,0x11970
.long 0x20130,0x20110,0x1980,0x11980,0x20170,0x20150,0x1990,0x11990
.long 0x20138,0x20118,0x19a0,0x119a0,0x20178,0x20158,0x19b0,0x119b0
.long 0x201b0,0x20190,0x19c0,0x119c0,0x201f0,0x201d0,0x19d0,0x119d0
.long 0x201b8,0x20198,0x19e0,0x119e0,0x201f8,0x201d8,0x19f0,0x119f0
.long 0x20200,0x20220,0x1a00,0x11a00,0x20240,0x20260,0x1a10,0x11a10
.long 0x20208,0x20228,0x1a20,0x11a20,0x20248,0x20268,0x1a30,0x11a30
.long 0x20280,0x202a0,0x1a40,0x11a40,0x202c0,0x202e0,0x1a50,0x11a50
.long 0x20288,0x202a8,0x1a60,0x11a60,0x202c8,0x202e8,0x1a70,0x11a70
.long 0x20320,0x20300,0x1a80,0x11a80,0x20360,0x20340,0x1a90,0x11a90
.long 0x20328,0x20308,0x1aa0,0x11aa0,0x20368,0x20348,0x1ab0,0x11ab0
.long 0x203a0,0x20380,0x1ac0,0x11ac0,0x203e0,0x203c0,0x1ad0,0x11ad0
.long 0x203a8,0x20388,0x1ae0,0x11ae0,0x203e8,0x203c8,0x1af0,0x11af0
.long 0x20210,0x20230,0x1b00,0x11b00,0x20250,0x20270,0x1b10,0x11b10
.long 0x20218,0x20238,0x1b20,0x11b20,0x20258,0x20278,0x1b30,0x11b30
.long 0x20290,0x202b0,0x1b40,0x11b40,0x202d0,0x202f0,0x1b50,0x11b50
.long 0x20298,0x202b8,0x1b60,0x11b60,0x202d8,0x202f8,0x1b70,0x11b70
.long 0x20330,0x20310,0x1b80,0x11b80,0x20370,0x20350,0x1b90,0x11b90
.long 0x20338,0x20318,0x1ba0,0x11ba0,0x20378,0x20358,0x1bb0,0x11bb0
.long 0x203b0,0x20390,0x1bc0,0x11bc0,0x203f0,0x203d0,0x1bd0,0x11bd0
.long 0x203b8,0x20398,0x1be0,0x11be0,0x203f8,0x203d8,0x1bf0,0x11bf0
.long 0x1d000,0x1e000,0x300,0xc00,0x1d010,0x1e010,0x310,0xc04
.long 0x1d020,0x1e020,0x320,0xc08,0x1d030,0x1e030,0x330,0xc0c
.long 0x1d040,0x1e040,0x340,0xc10,0x1d050,0x1e050,0x350,0xc14
.long 0x1d060,0x1e060,0x360,0xc18,0x1d070,0x1e070,0x370,0xc1c
.long 0x1d090,0x1e500,0x380,0xc20,0x1d080,0x1e510,0x390,0xc24
.long 0x1d0b0,0x1e520,0x3a0,0xc28,0x1d0a0,0x1e530,0x3b0,0xc2c
.long 0x1d0d0,0x1e540,0x3c0,0xc30,0x1d0c0,0x1e550,0x3d0,0xc34
.long 0x1d0f0,0x1e560,0x3e0,0xc38,0x1d0e0,0x1e570,0x3f0,0xc3c
.long 0x1d120,0x1ea00,0x4300,0xc40,0x1d130,0x1ea10,0x4310,0xc44
.long 0x1d100,0x1ea20,0x4320,0xc48,0x1d110,0x1ea30,0x4330,0xc4c
.long 0x1d160,0x1ea40,0x4340,0xc50,0x1d170,0x1ea50,0x4350,0xc54
.long 0x1d140,0x1ea60,0x4360,0xc58,0x1d150,0x1ea70,0x4370,0xc5c
.long 0x1d1b0,0x1ef00,0x4380,0xc60,0x1d1a0,0x1ef10,0x4390,0xc64
.long 0x1d190,0x1ef20,0x43a0,0xc68,0x1d180,0x1ef30,0x43b0,0xc6c
.long 0x1d1f0,0x1ef40,0x43c0,0xc70,0x1d1e0,0x1ef50,0x43d0,0xc74
.long 0x1d1d0,0x1ef60,0x43e0,0xc78,0x1d1c0,0x1ef70,0x43f0,0xc7c
.long 0x1d240,0x1f400,0x8300,0xc80,0x1d250,0x1f410,0x8310,0xc84
.long 0x1d260,0x1f420,0x8320,0xc88,0x1d270,0x1f430,0x8330,0xc8c
.long 0x1d200,0x1f440,0x8340,0xc90,0x1d210,0x1f450,0x8350,0xc94
.long 0x1d220,0x1f460,0x8360,0xc98,0x1d230,0x1f470,0x8370,0xc9c
.long 0x1d2d0,0x1f900,0x8380,0xca0,0x1d2c0,0x1f910,0x8390,0xca4
.long 0x1d2f0,0x1f920,0x83a0,0xca8,0x1d2e0,0x1f930,0x83b0,0xcac
.long 0x1d290,0x1f940,0x83c0,0xcb0,0x1d280,0x1f950,0x83d0,0xcb4
.long 0x1d2b0,0x1f960,0x83e0,0xcb8,0x1d2a0,0x1f970,0x83f0,0xcbc
.long 0x1d360,0x1fe00,0xc300,0xcc0,0x1d370,0x1fe10,0xc310,0xcc4
.long 0x1d340,0x1fe20,0xc320,0xcc8,0x1d350,0x1fe30,0xc330,0xccc
.long 0x1d320,0x1fe40,0xc340,0xcd0,0x1d330,0x1fe50,0xc350,0xcd4
.long 0x1d300,0x1fe60,0xc360,0xcd8,0x1d310,0x1fe70,0xc370,0xcdc
.long 0x1d3f0,0x20300,0xc380,0xce0,0x1d3e0,0x20310,0xc390,0xce4
.long 0x1d3d0,0x20320,0xc3a0,0xce8,0x1d3c0,0x20330,0xc3b0,0xcec
.long 0x1d3b0,0x20340,0xc3c0,0xcf0,0x1d3a0,0x20350,0xc3d0,0xcf4
.long 0x1d390,0x20360,0xc3e0,0xcf8,0x1d380,0x20370,0xc3f0,0xcfc
.long 0x1d000,0x1d020,0x1d040,0x1d060,0x1d090,0x1d0b0,0x1d0d0,0x1d0f0
.long 0x1d120,0x1d100,0x1d160,0x1d140,0x1d1b0,0x1d190,0x1d1f0,0x1d1d0
.long 0x1d240,0x1d260,0x1d200,0x1d220,0x1d2d0,0x1d2f0,0x1d290,0x1d2b0
.long 0x1d360,0x1d340,0x1d320,0x1d300,0x1d3f0,0x1d3d0,0x1d3b0,0x1d390
.long 0x1d400,0x1d420,0x1d440,0x1d460,0x1d490,0x1d4b0,0x1d4d0,0x1d4f0
.long 0x1d520,0x1d500,0x1d560,0x1d540,0x1d5b0,0x1d590,0x1d5f0,0x1d5d0
.long 0x1d640,0x1d660,0x1d600,0x1d620,0x1d6d0,0x1d6f0,0x1d690,0x1d6b0
.long 0x1d760,0x1d740,0x1d720,0x1d700,0x1d7f0,0x1d7d0,0x1d7b0,0x1d790
.long 0x1d008,0x1d028,0x1d048,0x1d068,0x1d098,0x1d0b8,0x1d0d8,0x1d0f8
.long 0x1d128,0x1d108,0x1d168,0x1d148,0x1d1b8,0x1d198,0x1d1f8,0x1d1d8
.long 0x1d248,0x1d268,0x1d208,0x1d228,0x1d2d8,0x1d2f8,0x1d298,0x1d2b8
.long 0x1d368,0x1d348,0x1d328,0x1d308,0x1d3f8,0x1d3d8,0x1d3b8,0x1d398
.long 0x1d408,0x1d428,0x1d448,0x1d468,0x1d498,0x1d4b8,0x1d4d8,0x1d4f8
.long 0x1d528,0x1d508,0x1d568,0x1d548,0x1d5b8,0x1d598,0x1d5f8,0x1d5d8
.long 0x1d648,0x1d668,0x1d608,0x1d628,0x1d6d8,0x1d6f8,0x1d698,0x1d6b8
.long 0x1d768,0x1d748,0x1d728,0x1d708,0x1d7f8,0x1d7d8,0x1d7b8,0x1d798
.long 0x1d010,0x1d030,0x1d050,0x1d070,0x1d080,0x1d0a0,0x1d0c0,0x1d0e0
.long 0x1d130,0x1d110,0x1d170,0x1d150,0x1d1a0,0x1d180,0x1d1e0,0x1d1c0
.long 0x1d250,0x1d270,0x1d210,0x1d230,0x1d2c0,0x1d2e0,0x1d280,0x1d2a0
.long 0x1d370,0x1d350,0x1d330,0x1d310,0x1d3e0,0x1d3c0,0x1d3a0,0x1d380
.long 0x1d410,0x1d430,0x1d450,0x1d470,0x1d480,0x1d4a0,0x1d4c0,0x1d4e0
.long 0x1d530,0x1d510,0x1d570,0x1d550,0x1d5a0,0x1d580,0x1d5e0,0x1d5c0
.long 0x1d650,0x1d670,0x1d610,0x1d630,0x1d6c0,0x1d6e0,0x1d680,0x1d6a0
.long 0x1d770,0x1d750,0x1d730,0x1d710,0x1d7e0,0x1d7c0,0x1d7a0,0x1d780
.long 0x1d018,0x1d038,0x1d058,0x1d078,0x1d088,0x1d0a8,0x1d0c8,0x1d0e8
.long 0x1d138,0x1d118,0x1d178,0x1d158,0x1d1a8,0x1d188,0x1d1e8,0x1d1c8
.long 0x1d258,0x1d278,0x1d218,0x1d238,0x1d2c8,0x1d2e8,0x1d288,0x1d2a8
.long 0x1d378,0x1d358,0x1d338,0x1d318,0x1d3e8,0x1d3c8,0x1d3a8,0x1d388
.long 0x1d418,0x1d438,0x1d458,0x1d478,0x1d488,0x1d4a8,0x1d4c8,0x1d4e8
.long 0x1d538,0x1d518,0x1d578,0x1d558,0x1d5a8,0x1d588,0x1d5e8,0x1d5c8
.long 0x1d658,0x1d678,0x1d618,0x1d638,0x1d6c8,0x1d6e8,0x1d688,0x1d6a8
.long 0x1d778,0x1d758,0x1d738,0x1d718,0x1d7e8,0x1d7c8,0x1d7a8,0x1d788
.long 0x12c0,0x1260,0x1,0x2,0x12c4,0x1264,0x1,0x2
.long 0x12c8,0x1268,0x1,0x2,0x12cc,0x126c,0x1,0x2
.long 0x12d0,0x1270,0x1,0x2,0x12d4,0x1274,0x1,0x2
.long 0x12d8,0x1278,0x1,0x2,0x12dc,0x127c,0x1,0x2
.long 0x12c0,0x1280,0x1,0x2,0x12c4,0x1284,0x1,0x2
.long 0x12c8,0x1288,0x1,0x2,0x12cc,0x128c,0x1,0x2
.long 0x12d0,0x1290,0x1,0x2,0x12d4,0x1294,0x1,0x2
.long 0x12d8,0x1298,0x1,0x2,0x12dc,0x129c,0x1,0x2
.long 0x12c0,0x12a0,0x1,0x2,0x12c4,0x12a4,0x1,0x2
.long 0x12c8,0x12a8,0x1,0x2,0x12cc,0x12ac,0x1,0x2
.long 0x12d0,0x12b0,0x1,0x2,0x12d4,0x12b4,0x1,0x2
.long 0x12d8,0x12b8,0x1,0x2,0x12dc,0x12bc,0x1,0x2
.long 0x12c0,0x12c0,0x1,0x2,0x12c4,0x12c4,0x1,0x2
.long 0x12c8,0x12c8,0x1,0x2,0x12cc,0x12cc,0x1,0x2
.long 0x12d0,0x12d0,0x1,0x2,0x12d4,0x12d4,0x1,0x2
.long 0x12d8,0x12d8,0x1,0x2,0x12dc,0x12dc,0x1,0x2
.long 0x12c0,0x1260,0x1,0x2,0x12c4,0x1264,0x1,0x2
.long 0x12c8,0x1268,0x1,0x2,0x12cc,0x126c,0x1,0x2
.long 0x12d0,0x1270,0x1,0x2,0x12d4,0x1274,0x1,0x2
.long 0x12d8,0x1278,0x1,0x2,0x12dc,0x127c,0x1,0x2
.long 0x12c0,0x1280,0x1,0x2,0x12c4,0x1284,0x1,0x2
.long 0x12c8,0x1288,0x1,0x2,0x12cc,0x128c,0x1,0x2
.long 0x12d0,0x1290,0x1,0x2,0x12d4,0x1294,0x1,0x2
.long 0x12d8,0x1298,0x1,0x2,0x12dc,0x129c,0x1,0x2
.long 0x12c0,0x12a0,0x1,0x2,0x12c4,0x12a4,0x1,0x2
.long 0x12c8,0x12a8,0x1,0x2,0x12cc,0x12ac,0x1,0x2
.long 0x12d0,0x12b0,0x1,0x2,0x12d4,0x12b4,0x1,0x2
.long 0x12d8,0x12b8,0x1,0x2,0x12dc,0x12bc,0x1,0x2
.long 0x12c0,0x12c0,0x1,0x2,0x12c4,0x12c4,0x1,0x2
.long 0x12c8,0x12c8,0x1,0x2,0x12cc,0x12cc,0x1,0x2
.long 0x12d0,0x12d0,0x1,0x2,0x12d4,0x12d4,0x1,0x2
.long 0x12d8,0x12d8,0x1,0x2,0x12dc,0x12dc,0x1,0x2
L_end:
.size L_tab, L_end-L_tab
.section .rodata,"a"
.p2align 6
.amdhsa_kernel gated_mix__ssm_conv_s4__dense_activation_squared_relu__prompt_kernel
  .amdhsa_next_free_vgpr 512
  .amdhsa_next_free_sgpr 102
  .amdhsa_accum_offset 256
  .amdhsa_group_segment_fixed_size 0
  .amdhsa_kernarg_size 144
  .amdhsa_user_sgpr_count 2
  .amdhsa_user_sgpr_kernarg_segment_ptr 1
  .amdhsa_system_sgpr_workgroup_id_x 1
.end_amdhsa_kernel
.text
```
